```python
import torch

def _softmax(x, axis=-1):
    return torch.softmax(x, dim=axis)
def _gelu(x):
    return torch.nn.functional.gelu(x, approximate="tanh")
def _silu(x):
    return torch.nn.functional.silu(x)
def _sigmoid(x):
    return torch.sigmoid(x)
def _layernorm(x, axis=-1, eps=1e-5):
    m = x.mean(dim=axis, keepdim=True)
    v = x.var(dim=axis, keepdim=True, unbiased=False)
    return (x - m) / torch.sqrt(v + eps)
def _scatter_add(tgt, idx, src, axis=0):
    return tgt.clone().index_add_(axis, idx, src)
def _segment_sum(src, seg, n):
    out = torch.zeros((n,) + src.shape[1:], dtype=src.dtype)
    return out.index_add_(0, seg, src)
def _pad(x, pw):
    flat = tuple(v for pair in reversed(pw) for v in pair)
    return torch.nn.functional.pad(x, flat)

kernel_name = 'interleave_layers__sliding_block__mixer_channel_mlp__prompt'

def setup_inputs():

    _w = (lambda a: (lambda t: t.to(torch.bfloat16) if t.is_floating_point() else t)(torch.as_tensor(a)))
    def _A_setup():
        B, S, D = 1, 2048, 448
        return {
            "x": _w((lambda *s: torch.randn(*s, dtype=torch.bfloat16) * 0.05)(B, S, D)),
            "wqkv": _w((lambda *s: torch.randn(*s, dtype=torch.bfloat16) * 0.05)(D, 3 * D)),
            "wo": _w((lambda *s: torch.randn(*s, dtype=torch.bfloat16) * 0.05)(D, D)),
        }
    _A_in = _A_setup()

    def _B_setup():
        B, S, D, F = 1, 2048, 448, 1792
        return {
            "x": _w((lambda *s: torch.randn(*s, dtype=torch.bfloat16) * 0.05)(B, S, D)),
            "w1": _w((lambda *s: torch.randn(*s, dtype=torch.bfloat16) * 0.8)(D, F) * (D ** -0.5)),
            "b1": _w((lambda *s: torch.randn(*s, dtype=torch.bfloat16) * 0.8)(F)),
            "w2": _w((lambda *s: torch.randn(*s, dtype=torch.bfloat16) * 0.8)(F, D) * (F ** -0.5)),
            "b2": _w((lambda *s: torch.randn(*s, dtype=torch.bfloat16) * 0.4)(D)),
        }
    _B_in = _B_setup()

    return {
        "A_x": _A_in["x"],
        "A_wqkv": _A_in["wqkv"],
        "A_wo": _A_in["wo"],
        "B_x": _B_in["x"],
        "B_w1": _B_in["w1"],
        "B_b1": _B_in["b1"],
        "B_w2": _B_in["w2"],
        "B_b2": _B_in["b2"],
    }

def reference(A_x, A_wqkv, A_wo, B_x, B_w1, B_b1, B_w2, B_b2):
    def _A_ref(x, wqkv, wo):
        B, S, D = x.shape
        H = 16; Dh = D // H; W = 256
        qkv = (lambda x, *d: x.permute(*d))((x @ wqkv).reshape(B, S, 3, H, Dh), 2, 0, 3, 1, 4)
        q, k, v = qkv[0], qkv[1], qkv[2]
        scores = torch.einsum("bhqd,bhkd->bhqk", q, k) * (Dh ** -0.5)
        idx = torch.arange(S)
        mask = (idx[:, None] - idx[None, :] >= 0) & (idx[:, None] - idx[None, :] < W)
        scores = torch.where(mask[None, None], scores, -1e9)
        p = _softmax(scores, axis=-1)
        o = torch.einsum("bhqk,bhkd->bhqd", p, v)
        return (lambda x, *d: x.permute(*d))(o, 0, 2, 1, 3).reshape(B, S, D) @ wo

    def _B_ref(x, w1, b1, w2, b2):
        y = _layernorm(x, axis=-1)
        h = _gelu(torch.einsum("bsd,df->bsf", y, w1) + b1)
        return torch.einsum("bsf,fd->bsd", h, w2) + b2

    x = A_x
    x = x + _A_ref(_layernorm(x, axis=-1), A_wqkv, A_wo)
    x = x + _B_ref(_layernorm(x, axis=-1), B_w1, B_b1, B_w2, B_b2)
    x = x + _A_ref(_layernorm(x, axis=-1), A_wqkv, A_wo)
    x = x + _B_ref(_layernorm(x, axis=-1), B_w1, B_b1, B_w2, B_b2)
    return x
```

```asm
; @launch grid=(256,1,1) block=(256,1,1) lds=163840
.amdgcn_target "amdgcn-amd-amdhsa--gfx950"
.text
.p2align 8
.globl interleave_layers__sliding_block__mixer_channel_mlp__prompt_kernel
.type interleave_layers__sliding_block__mixer_channel_mlp__prompt_kernel,@function
interleave_layers__sliding_block__mixer_channel_mlp__prompt_kernel:
    s_cmp_ge_u32 s2, 256
    s_cbranch_scc1 main_done
    s_load_dwordx8 s[64:71], s[0:1], 0
    s_load_dwordx8 s[72:79], s[0:1], 32
    s_load_dwordx4 s[80:83], s[0:1], 64
    s_load_dwordx2 s[84:85], s[0:1], 80
    s_getreg_b32 s57, hwreg(HW_REG_XCC_ID)
    v_lshrrev_b32 v1, 6, v0
    v_and_b32 v0, 63, v0
    v_readfirstlane_b32 s3, v1
    v_lshlrev_b32 v1, 4, v0
    v_and_b32 v2, 31, v0
    v_lshrrev_b32 v3, 5, v0
    v_lshlrev_b32 v4, 3, v0
    v_and_b32 v5, 15, v0
    v_lshrrev_b32 v7, 2, v5
    v_lshl_add_u32 v7, v3, 2, v7
    v_lshlrev_b32 v7, 6, v7
    v_and_b32 v11, 3, v0
    v_lshl_add_u32 v7, v11, 3, v7
    v_bfe_u32 v11, v0, 4, 1
    v_lshl_add_u32 v7, v11, 5, v7
    v_add_u32 v8, 0x10000, v7
    v_add_u32 v254, 0x20000, v7
    v_lshlrev_b32 v5, 2, v5
    v_mov_b32 v6, 0
    v_mov_b32 v10, 1
    v_lshlrev_b32 v252, 7, v0
    v_and_b32 v252, 2047, v252
    s_and_b32 s57, s57, 7
    s_and_b32 s16, s2, 7
    s_lshr_b32 s17, s2, 3
    s_and_b32 s20, s17, 1
    s_lshl_b32 s21, s16, 1
    s_add_u32 s20, s20, s21
    s_lshr_b32 s21, s17, 1
    s_lshl_b32 s22, s20, 2
    s_add_u32 s22, s22, s3
    s_min_u32 s23, s21, 13
    s_lshl_b32 s101, s17, 2
    s_add_u32 s101, s101, s3
    s_getpc_b64 s[44:45]
    s_and_b32 s44, s44, 0xffffff00
    s_and_b32 s45, s45, 0xffff
    s_mov_b32 s46, code_end - interleave_layers__sliding_block__mixer_channel_mlp__prompt_kernel - 256
    s_mov_b32 s47, 0x00020000
    v_and_b32 v9, 3, v0
    v_lshlrev_b32 v9, 7, v9
    s_lshl_b32 s48, s101, 9
    buffer_load_dword v9, v9, s[44:47], s48 offen
    s_mov_b32 s19, 0
    s_mov_b32 s50, 0
    s_lshl_b32 s63, s3, 10
    s_mul_i32 s62, s3, 43008
    s_mul_i32 s40, s21, 56
    s_add_u32 s62, s62, s40
    s_and_b32 s18, s21, 1
    s_lshl_b32 s18, s18, 3
    s_sub_u32 s62, s62, s18
    s_waitcnt lgkmcnt(0)
    s_mov_b32 s4, s84
    s_and_b32 s5, s85, 0xffff
    s_mov_b32 s6, 0x10000000
    s_mov_b32 s7, 0x00020000
    s_mov_b32 s8, s66
    s_and_b32 s9, s67, 0xffff
    s_mov_b32 s10, 0x126000
    s_mov_b32 s11, 0x00020000
    s_mov_b32 s12, s82
    s_and_b32 s13, s83, 0xffff
    s_mov_b32 s14, 0x100
    s_mov_b32 s15, 0x00020000
    s_mov_b32 s24, s72
    s_and_b32 s25, s73, 0xffff
    s_mov_b32 s26, 0x188000
    s_mov_b32 s27, 0x00020000
    s_mov_b64 s[32:33], s[64:65]
    s_mov_b64 s[34:35], s[68:69]
    s_mov_b64 s[36:37], s[76:77]
    s_mov_b64 s[38:39], s[80:81]
    s_lshr_b32 s40, s17, 2
    s_min_u32 s40, s40, 6
    s_lshl_b32 s40, s40, 1
    s_and_b32 s42, s3, 1
    s_add_u32 s44, s40, s42
    s_mov_b64 s[92:93], s[74:75]
    s_mov_b64 s[94:95], s[78:79]
    s_mov_b32 s78, s44
    s_mul_i32 s64, s22, 28672
    s_mul_i32 s65, s22, 3584
    s_lshl_b32 s66, s21, 6
    s_add_u32 s66, s66, s22
    s_lshl_b32 s66, s66, 12
    s_lshl_b32 s67, s22, 7
    s_add_u32 s67, s67, 5242880
    s_mul_i32 s68, s3, 28672
    s_lshl_b32 s40, s23, 8
    s_add_u32 s68, s68, s40
    s_mul_i32 s69, s3, 14336
    s_lshl_b32 s40, s23, 6
    s_add_u32 s69, s69, s40
    s_mul_i32 s70, s22, 14
    s_add_u32 s70, s70, s23
    s_lshl_b32 s71, s70, 8
    s_lshl_b32 s70, s70, 11
    s_lshl_b32 s72, s22, 4
    s_add_u32 s72, s72, s21
    s_lshl_b32 s72, s72, 11
    s_lshl_b32 s73, s22, 15
    s_mul_i32 s74, s22, 86016
    s_lshl_b32 s40, s23, 12
    s_add_u32 s74, s74, s40
    s_and_b32 s41, s21, 1
    s_lshl_b32 s41, s41, 1
    s_lshl_b32 s42, s20, 2
    s_add_u32 s41, s41, s42
    s_xor_b32 s43, s78, 1
    s_lshr_b32 s42, s3, 1
    s_add_u32 s79, s41, s42
    s_xor_b32 s44, s79, 1
    s_sub_u32 s46, s63, 2048
    s_mul_i32 s45, s3, 14336
    s_mul_i32 s80, s79, 86016
    s_add_u32 s80, s80, s63
    s_mul_i32 s81, s44, 86016
    s_add_u32 s81, s81, s63
    s_mul_i32 s82, s78, 64
    s_add_u32 s82, s82, s45
    s_mul_i32 s83, s43, 64
    s_add_u32 s83, s83, s45
    s_mul_i32 s99, s79, 32768
    s_add_u32 s99, s99, s46
    s_mul_i32 s100, s44, 32768
    s_add_u32 s100, s100, s46
    s_mul_i32 s76, s3, 3072
    s_add_u32 s76, s76, 118784
    s_mul_i32 s77, s3, 14336
    s_mul_i32 s84, s79, 14
    s_add_u32 s84, s84, s78
    s_lshl_b32 s85, s84, 8
    s_lshl_b32 s84, s84, 11
    s_lshl_b32 s86, s41, 7
    s_add_u32 s86, s86, 5242880
    s_cmp_ge_u32 s21, 14
    s_cselect_b32 s0, 0x28000, s63
    s_cselect_b32 s1, 0, s26
    v_lshrrev_b32 v251, 2, v0
    v_mul_u32_u24 v251, 2688, v251
    v_and_b32 v11, 3, v0
    v_lshl_add_u32 v251, v11, 4, v251
    s_mov_b32 s28, s32
    s_and_b32 s29, s33, 0xffff
    s_mov_b32 s30, 0x1c0000
    s_mov_b32 s31, 0x00020000
    v_lshrrev_b32 v11, 3, v0
    v_mul_u32_u24 v250, 896, v11
    v_xor_b32 v11, v11, v0
    v_and_b32 v11, 7, v11
    v_lshl_add_u32 v250, v11, 4, v250
    s_mul_i32 s43, s22, 28672
    s_mul_i32 s44, s3, 19456
    s_add_u32 s44, s44, 86016
    v_and_b32 v11, 7, v0
    v_lshlrev_b32 v227, 7, v2
    v_add_u32 v227, s44, v227
    v_xor_b32 v11, v11, v3
    v_xor_b32 v222, 0, v11
    v_lshl_add_u32 v224, v222, 4, v227
    v_xor_b32 v222, 2, v11
    v_lshl_add_u32 v225, v222, 4, v227
    v_xor_b32 v222, 4, v11
    v_lshl_add_u32 v226, v222, 4, v227
    v_xor_b32 v222, 6, v11
    v_lshl_add_u32 v227, v222, 4, v227
    s_add_u32 s41, s43, 0
    s_add_u32 m0, s44, 0
    s_nop 0
    buffer_load_dwordx4 v250, s[28:31], s41 offen lds
    s_add_u32 s41, s43, 7168
    s_add_u32 m0, s44, 1024
    s_nop 0
    buffer_load_dwordx4 v250, s[28:31], s41 offen lds
    s_add_u32 s41, s43, 14336
    s_add_u32 m0, s44, 2048
    s_nop 0
    buffer_load_dwordx4 v250, s[28:31], s41 offen lds
    s_add_u32 s41, s43, 21504
    s_add_u32 m0, s44, 3072
    s_nop 0
    buffer_load_dwordx4 v250, s[28:31], s41 offen lds
    s_add_u32 s41, s43, 128
    s_add_u32 m0, s44, 4096
    s_nop 0
    buffer_load_dwordx4 v250, s[28:31], s41 offen lds
    s_add_u32 s41, s43, 7296
    s_add_u32 m0, s44, 5120
    s_nop 0
    buffer_load_dwordx4 v250, s[28:31], s41 offen lds
    s_add_u32 s41, s43, 14464
    s_add_u32 m0, s44, 6144
    s_nop 0
    buffer_load_dwordx4 v250, s[28:31], s41 offen lds
    s_add_u32 s41, s43, 21632
    s_add_u32 m0, s44, 7168
    s_nop 0
    buffer_load_dwordx4 v250, s[28:31], s41 offen lds
    s_add_u32 s40, s62, 896
    s_add_u32 m0, s63, 0
    s_nop 0
    buffer_load_dwordx4 v251, s[8:11], s40 offen lds
    s_add_u32 s40, s62, 1792
    s_add_u32 m0, s63, 28672
    s_nop 0
    buffer_load_dwordx4 v251, s[8:11], s40 offen lds
    s_add_u32 s40, s62, 172928
    s_add_u32 m0, s63, 4096
    s_nop 0
    buffer_load_dwordx4 v251, s[8:11], s40 offen lds
    s_add_u32 s40, s62, 173824
    s_add_u32 m0, s63, 32768
    s_nop 0
    buffer_load_dwordx4 v251, s[8:11], s40 offen lds
    s_add_u32 s40, s62, 344960
    s_add_u32 m0, s63, 8192
    s_nop 0
    buffer_load_dwordx4 v251, s[8:11], s40 offen lds
    s_add_u32 s40, s62, 345856
    s_add_u32 m0, s63, 36864
    s_nop 0
    buffer_load_dwordx4 v251, s[8:11], s40 offen lds
    s_add_u32 s40, s62, 516992
    s_add_u32 m0, s63, 12288
    s_nop 0
    buffer_load_dwordx4 v251, s[8:11], s40 offen lds
    s_add_u32 s40, s62, 517888
    s_add_u32 m0, s63, 40960
    s_nop 0
    buffer_load_dwordx4 v251, s[8:11], s40 offen lds
    v_mov_b32 v196, -1
    v_mov_b32 v200, 0
    v_mov_b32 v220, 0x3f803f80
    v_mov_b32 v197, -1
    v_mov_b32 v201, 0
    v_mov_b32 v221, 0x3f803f80
    v_mov_b32 v198, -1
    v_mov_b32 v202, 0
    v_mov_b32 v220, 0x3f803f80
    v_mov_b32 v199, -1
    v_mov_b32 v203, 0
    v_mov_b32 v221, 0x3f803f80
    s_cmp_eq_u32 s21, 11
    s_cselect_b32 s41, 15, s21
    s_lshl_b32 s41, s41, 13
    s_add_u32 s41, s41, s67
    s_mov_b64 exec, 0xff
    buffer_store_dwordx4 v[200:203], v1, s[4:7], s41 offen sc1
    s_mov_b64 exec, 1
    s_lshr_b32 s41, s66, 5
    s_add_u32 s41, s41, 5505024
    buffer_store_dword v6, v6, s[4:7], s41 offen sc1
    s_mov_b64 exec, -1
    v_lshlrev_b32 v248, 8, v3
    v_and_b32 v249, 19, v0
    v_cmp_eq_u32 vcc, 19, v249
    v_mov_b32 v249, s18
    s_nop 0
    v_cndmask_b32_e64 v249, v249, 0, vcc
    v_add3_u32 v248, v248, v7, v249
    v_add_u32 v249, 0x10000, v248
    s_waitcnt vmcnt(14)
    ds_read_b128 v[12:15], v224 offset:0
    ds_read_b128 v[16:19], v225 offset:0
    ds_read_b128 v[20:23], v226 offset:0
    ds_read_b128 v[24:27], v227 offset:0
    s_waitcnt lgkmcnt(0)
    s_add_u32 s41, s43, 256
    s_add_u32 m0, s44, 0
    s_nop 0
    buffer_load_dwordx4 v250, s[28:31], s41 offen lds
    s_add_u32 s41, s43, 7424
    s_add_u32 m0, s44, 1024
    s_nop 0
    buffer_load_dwordx4 v250, s[28:31], s41 offen lds
    s_add_u32 s41, s43, 14592
    s_add_u32 m0, s44, 2048
    s_nop 0
    buffer_load_dwordx4 v250, s[28:31], s41 offen lds
    s_add_u32 s41, s43, 21760
    s_add_u32 m0, s44, 3072
    s_nop 0
    buffer_load_dwordx4 v250, s[28:31], s41 offen lds
    s_waitcnt vmcnt(14)
    ds_read_b128 v[28:31], v224 offset:4096
    ds_read_b128 v[32:35], v225 offset:4096
    ds_read_b128 v[36:39], v226 offset:4096
    ds_read_b128 v[40:43], v227 offset:4096
    s_waitcnt lgkmcnt(0)
    s_add_u32 s41, s43, 384
    s_add_u32 m0, s44, 4096
    s_nop 0
    buffer_load_dwordx4 v250, s[28:31], s41 offen lds
    s_add_u32 s41, s43, 7552
    s_add_u32 m0, s44, 5120
    s_nop 0
    buffer_load_dwordx4 v250, s[28:31], s41 offen lds
    s_add_u32 s41, s43, 14720
    s_add_u32 m0, s44, 6144
    s_nop 0
    buffer_load_dwordx4 v250, s[28:31], s41 offen lds
    s_add_u32 s41, s43, 21888
    s_add_u32 m0, s44, 7168
    s_nop 0
    buffer_load_dwordx4 v250, s[28:31], s41 offen lds
    v_mfma_f32_4x4x4_16b_bf16 v[212:215], v[220:221], v[12:13], 0
    v_mfma_f32_4x4x4_16b_bf16 v[228:231], v[12:13], v[12:13], 0
    v_mfma_f32_4x4x4_16b_bf16 v[216:219], v[220:221], v[14:15], 0
    v_mfma_f32_4x4x4_16b_bf16 v[232:235], v[14:15], v[14:15], 0
    v_mfma_f32_4x4x4_16b_bf16 v[212:215], v[220:221], v[16:17], v[212:215]
    v_mfma_f32_4x4x4_16b_bf16 v[228:231], v[16:17], v[16:17], v[228:231]
    v_mfma_f32_4x4x4_16b_bf16 v[216:219], v[220:221], v[18:19], v[216:219]
    v_mfma_f32_4x4x4_16b_bf16 v[232:235], v[18:19], v[18:19], v[232:235]
    v_mfma_f32_4x4x4_16b_bf16 v[212:215], v[220:221], v[20:21], v[212:215]
    v_mfma_f32_4x4x4_16b_bf16 v[228:231], v[20:21], v[20:21], v[228:231]
    v_mfma_f32_4x4x4_16b_bf16 v[216:219], v[220:221], v[22:23], v[216:219]
    v_mfma_f32_4x4x4_16b_bf16 v[232:235], v[22:23], v[22:23], v[232:235]
    v_mfma_f32_4x4x4_16b_bf16 v[212:215], v[220:221], v[24:25], v[212:215]
    v_mfma_f32_4x4x4_16b_bf16 v[228:231], v[24:25], v[24:25], v[228:231]
    v_mfma_f32_4x4x4_16b_bf16 v[216:219], v[220:221], v[26:27], v[216:219]
    v_mfma_f32_4x4x4_16b_bf16 v[232:235], v[26:27], v[26:27], v[232:235]
    v_mfma_f32_4x4x4_16b_bf16 v[212:215], v[220:221], v[28:29], v[212:215]
    v_mfma_f32_4x4x4_16b_bf16 v[228:231], v[28:29], v[28:29], v[228:231]
    v_mfma_f32_4x4x4_16b_bf16 v[216:219], v[220:221], v[30:31], v[216:219]
    v_mfma_f32_4x4x4_16b_bf16 v[232:235], v[30:31], v[30:31], v[232:235]
    v_mfma_f32_4x4x4_16b_bf16 v[212:215], v[220:221], v[32:33], v[212:215]
    v_mfma_f32_4x4x4_16b_bf16 v[228:231], v[32:33], v[32:33], v[228:231]
    v_mfma_f32_4x4x4_16b_bf16 v[216:219], v[220:221], v[34:35], v[216:219]
    v_mfma_f32_4x4x4_16b_bf16 v[232:235], v[34:35], v[34:35], v[232:235]
    v_mfma_f32_4x4x4_16b_bf16 v[212:215], v[220:221], v[36:37], v[212:215]
    v_mfma_f32_4x4x4_16b_bf16 v[228:231], v[36:37], v[36:37], v[228:231]
    v_mfma_f32_4x4x4_16b_bf16 v[216:219], v[220:221], v[38:39], v[216:219]
    v_mfma_f32_4x4x4_16b_bf16 v[232:235], v[38:39], v[38:39], v[232:235]
    v_mfma_f32_4x4x4_16b_bf16 v[212:215], v[220:221], v[40:41], v[212:215]
    v_mfma_f32_4x4x4_16b_bf16 v[228:231], v[40:41], v[40:41], v[228:231]
    v_mfma_f32_4x4x4_16b_bf16 v[216:219], v[220:221], v[42:43], v[216:219]
    v_mfma_f32_4x4x4_16b_bf16 v[232:235], v[42:43], v[42:43], v[232:235]
    s_waitcnt vmcnt(14)
    s_barrier
    ds_read_b64_tr_b16 v[172:173], v248 offset:0
    ds_read_b64_tr_b16 v[174:175], v248 offset:256
    ds_read_b64_tr_b16 v[176:177], v248 offset:28672
    ds_read_b64_tr_b16 v[178:179], v248 offset:28928
    ds_read_b64_tr_b16 v[180:181], v248 offset:1024
    ds_read_b64_tr_b16 v[182:183], v248 offset:1280
    ds_read_b64_tr_b16 v[184:185], v248 offset:29696
    ds_read_b64_tr_b16 v[186:187], v248 offset:29952
    s_waitcnt lgkmcnt(4)
    v_mfma_f32_32x32x16_bf16 v[124:139], v[172:175], v[12:15], 0
    ds_read_b64_tr_b16 v[188:189], v248 offset:2048
    ds_read_b64_tr_b16 v[190:191], v248 offset:2304
    v_mfma_f32_32x32x16_bf16 v[140:155], v[12:15], v[176:179], 0
    ds_read_b64_tr_b16 v[192:193], v248 offset:30720
    ds_read_b64_tr_b16 v[194:195], v248 offset:30976
    v_mfma_f32_4x4x4_16b_bf16 v[156:159], v[220:221], v[172:173], 0
    v_mfma_f32_4x4x4_16b_bf16 v[164:167], v[220:221], v[176:177], 0
    v_mfma_f32_4x4x4_16b_bf16 v[160:163], v[220:221], v[174:175], 0
    v_mfma_f32_4x4x4_16b_bf16 v[168:171], v[220:221], v[178:179], 0
    s_add_u32 s40, s62, 689024
    s_add_u32 m0, s63, 16384
    s_nop 0
    buffer_load_dwordx4 v251, s[8:11], s40 offen lds
    s_waitcnt lgkmcnt(4)
    v_mfma_f32_32x32x16_bf16 v[124:139], v[180:183], v[16:19], v[124:139]
    ds_read_b64_tr_b16 v[172:173], v248 offset:3072
    ds_read_b64_tr_b16 v[174:175], v248 offset:3328
    v_mfma_f32_32x32x16_bf16 v[140:155], v[16:19], v[184:187], v[140:155]
    ds_read_b64_tr_b16 v[176:177], v248 offset:31744
    ds_read_b64_tr_b16 v[178:179], v248 offset:32000
    v_mfma_f32_4x4x4_16b_bf16 v[156:159], v[220:221], v[180:181], v[156:159]
    v_mfma_f32_4x4x4_16b_bf16 v[164:167], v[220:221], v[184:185], v[164:167]
    v_mfma_f32_4x4x4_16b_bf16 v[160:163], v[220:221], v[182:183], v[160:163]
    v_mfma_f32_4x4x4_16b_bf16 v[168:171], v[220:221], v[186:187], v[168:171]
    s_add_u32 s40, s62, 689920
    s_add_u32 m0, s63, 45056
    s_nop 0
    buffer_load_dwordx4 v251, s[8:11], s40 offen lds
    s_waitcnt lgkmcnt(4)
    v_mfma_f32_32x32x16_bf16 v[124:139], v[188:191], v[20:23], v[124:139]
    ds_read_b64_tr_b16 v[180:181], v248 offset:4096
    ds_read_b64_tr_b16 v[182:183], v248 offset:4352
    v_mfma_f32_32x32x16_bf16 v[140:155], v[20:23], v[192:195], v[140:155]
    ds_read_b64_tr_b16 v[184:185], v248 offset:32768
    ds_read_b64_tr_b16 v[186:187], v248 offset:33024
    v_mfma_f32_4x4x4_16b_bf16 v[156:159], v[220:221], v[188:189], v[156:159]
    v_mfma_f32_4x4x4_16b_bf16 v[164:167], v[220:221], v[192:193], v[164:167]
    v_mfma_f32_4x4x4_16b_bf16 v[160:163], v[220:221], v[190:191], v[160:163]
    v_mfma_f32_4x4x4_16b_bf16 v[168:171], v[220:221], v[194:195], v[168:171]
    s_waitcnt vmcnt(6)
    ds_read_b128 v[44:47], v224 offset:0
    ds_read_b128 v[48:51], v225 offset:0
    ds_read_b128 v[52:55], v226 offset:0
    ds_read_b128 v[56:59], v227 offset:0
    s_waitcnt lgkmcnt(0)
    s_add_u32 s41, s43, 512
    s_add_u32 m0, s44, 0
    s_nop 0
    buffer_load_dwordx4 v250, s[28:31], s41 offen lds
    s_add_u32 s41, s43, 7680
    s_add_u32 m0, s44, 1024
    s_nop 0
    buffer_load_dwordx4 v250, s[28:31], s41 offen lds
    s_add_u32 s41, s43, 14848
    s_add_u32 m0, s44, 2048
    s_nop 0
    buffer_load_dwordx4 v250, s[28:31], s41 offen lds
    s_add_u32 s41, s43, 22016
    s_add_u32 m0, s44, 3072
    s_nop 0
    buffer_load_dwordx4 v250, s[28:31], s41 offen lds
    v_mfma_f32_4x4x4_16b_bf16 v[212:215], v[220:221], v[44:45], v[212:215]
    v_mfma_f32_4x4x4_16b_bf16 v[228:231], v[44:45], v[44:45], v[228:231]
    v_mfma_f32_4x4x4_16b_bf16 v[216:219], v[220:221], v[46:47], v[216:219]
    v_mfma_f32_4x4x4_16b_bf16 v[232:235], v[46:47], v[46:47], v[232:235]
    v_mfma_f32_4x4x4_16b_bf16 v[212:215], v[220:221], v[48:49], v[212:215]
    v_mfma_f32_4x4x4_16b_bf16 v[228:231], v[48:49], v[48:49], v[228:231]
    v_mfma_f32_4x4x4_16b_bf16 v[216:219], v[220:221], v[50:51], v[216:219]
    v_mfma_f32_4x4x4_16b_bf16 v[232:235], v[50:51], v[50:51], v[232:235]
    v_mfma_f32_4x4x4_16b_bf16 v[212:215], v[220:221], v[52:53], v[212:215]
    v_mfma_f32_4x4x4_16b_bf16 v[228:231], v[52:53], v[52:53], v[228:231]
    v_mfma_f32_4x4x4_16b_bf16 v[216:219], v[220:221], v[54:55], v[216:219]
    v_mfma_f32_4x4x4_16b_bf16 v[232:235], v[54:55], v[54:55], v[232:235]
    v_mfma_f32_4x4x4_16b_bf16 v[212:215], v[220:221], v[56:57], v[212:215]
    v_mfma_f32_4x4x4_16b_bf16 v[228:231], v[56:57], v[56:57], v[228:231]
    v_mfma_f32_4x4x4_16b_bf16 v[216:219], v[220:221], v[58:59], v[216:219]
    v_mfma_f32_4x4x4_16b_bf16 v[232:235], v[58:59], v[58:59], v[232:235]
    s_add_u32 s40, s62, 861056
    s_add_u32 m0, s63, 20480
    s_nop 0
    buffer_load_dwordx4 v251, s[8:11], s40 offen lds
    v_mfma_f32_32x32x16_bf16 v[124:139], v[172:175], v[24:27], v[124:139]
    ds_read_b64_tr_b16 v[188:189], v248 offset:5120
    ds_read_b64_tr_b16 v[190:191], v248 offset:5376
    v_mfma_f32_32x32x16_bf16 v[140:155], v[24:27], v[176:179], v[140:155]
    ds_read_b64_tr_b16 v[192:193], v248 offset:33792
    ds_read_b64_tr_b16 v[194:195], v248 offset:34048
    v_mfma_f32_4x4x4_16b_bf16 v[156:159], v[220:221], v[172:173], v[156:159]
    v_mfma_f32_4x4x4_16b_bf16 v[164:167], v[220:221], v[176:177], v[164:167]
    v_mfma_f32_4x4x4_16b_bf16 v[160:163], v[220:221], v[174:175], v[160:163]
    v_mfma_f32_4x4x4_16b_bf16 v[168:171], v[220:221], v[178:179], v[168:171]
    s_add_u32 s40, s62, 861952
    s_add_u32 m0, s63, 49152
    s_nop 0
    buffer_load_dwordx4 v251, s[8:11], s40 offen lds
    v_mfma_f32_32x32x16_bf16 v[124:139], v[180:183], v[28:31], v[124:139]
    ds_read_b64_tr_b16 v[172:173], v248 offset:6144
    ds_read_b64_tr_b16 v[174:175], v248 offset:6400
    v_mfma_f32_32x32x16_bf16 v[140:155], v[28:31], v[184:187], v[140:155]
    ds_read_b64_tr_b16 v[176:177], v248 offset:34816
    ds_read_b64_tr_b16 v[178:179], v248 offset:35072
    v_mfma_f32_4x4x4_16b_bf16 v[156:159], v[220:221], v[180:181], v[156:159]
    v_mfma_f32_4x4x4_16b_bf16 v[164:167], v[220:221], v[184:185], v[164:167]
    v_mfma_f32_4x4x4_16b_bf16 v[160:163], v[220:221], v[182:183], v[160:163]
    v_mfma_f32_4x4x4_16b_bf16 v[168:171], v[220:221], v[186:187], v[168:171]
    s_add_u32 s40, s62, 1033088
    s_add_u32 m0, s63, 24576
    s_nop 0
    buffer_load_dwordx4 v251, s[8:11], s40 offen lds
    s_waitcnt lgkmcnt(4)
    v_mfma_f32_32x32x16_bf16 v[124:139], v[188:191], v[32:35], v[124:139]
    ds_read_b64_tr_b16 v[180:181], v248 offset:7168
    ds_read_b64_tr_b16 v[182:183], v248 offset:7424
    v_mfma_f32_32x32x16_bf16 v[140:155], v[32:35], v[192:195], v[140:155]
    ds_read_b64_tr_b16 v[184:185], v248 offset:35840
    ds_read_b64_tr_b16 v[186:187], v248 offset:36096
    v_mfma_f32_4x4x4_16b_bf16 v[156:159], v[220:221], v[188:189], v[156:159]
    v_mfma_f32_4x4x4_16b_bf16 v[164:167], v[220:221], v[192:193], v[164:167]
    v_mfma_f32_4x4x4_16b_bf16 v[160:163], v[220:221], v[190:191], v[160:163]
    v_mfma_f32_4x4x4_16b_bf16 v[168:171], v[220:221], v[194:195], v[168:171]
    s_waitcnt vmcnt(9)
    ds_read_b128 v[60:63], v224 offset:4096
    ds_read_b128 v[64:67], v225 offset:4096
    ds_read_b128 v[68:71], v226 offset:4096
    ds_read_b128 v[72:75], v227 offset:4096
    s_waitcnt lgkmcnt(0)
    s_add_u32 s41, s43, 640
    s_add_u32 m0, s44, 4096
    s_nop 0
    buffer_load_dwordx4 v250, s[28:31], s41 offen lds
    s_add_u32 s41, s43, 7808
    s_add_u32 m0, s44, 5120
    s_nop 0
    buffer_load_dwordx4 v250, s[28:31], s41 offen lds
    s_add_u32 s41, s43, 14976
    s_add_u32 m0, s44, 6144
    s_nop 0
    buffer_load_dwordx4 v250, s[28:31], s41 offen lds
    s_add_u32 s41, s43, 22144
    s_add_u32 m0, s44, 7168
    s_nop 0
    buffer_load_dwordx4 v250, s[28:31], s41 offen lds
    v_mfma_f32_4x4x4_16b_bf16 v[212:215], v[220:221], v[60:61], v[212:215]
    v_mfma_f32_4x4x4_16b_bf16 v[228:231], v[60:61], v[60:61], v[228:231]
    v_mfma_f32_4x4x4_16b_bf16 v[216:219], v[220:221], v[62:63], v[216:219]
    v_mfma_f32_4x4x4_16b_bf16 v[232:235], v[62:63], v[62:63], v[232:235]
    v_mfma_f32_4x4x4_16b_bf16 v[212:215], v[220:221], v[64:65], v[212:215]
    v_mfma_f32_4x4x4_16b_bf16 v[228:231], v[64:65], v[64:65], v[228:231]
    v_mfma_f32_4x4x4_16b_bf16 v[216:219], v[220:221], v[66:67], v[216:219]
    v_mfma_f32_4x4x4_16b_bf16 v[232:235], v[66:67], v[66:67], v[232:235]
    v_mfma_f32_4x4x4_16b_bf16 v[212:215], v[220:221], v[68:69], v[212:215]
    v_mfma_f32_4x4x4_16b_bf16 v[228:231], v[68:69], v[68:69], v[228:231]
    v_mfma_f32_4x4x4_16b_bf16 v[216:219], v[220:221], v[70:71], v[216:219]
    v_mfma_f32_4x4x4_16b_bf16 v[232:235], v[70:71], v[70:71], v[232:235]
    v_mfma_f32_4x4x4_16b_bf16 v[212:215], v[220:221], v[72:73], v[212:215]
    v_mfma_f32_4x4x4_16b_bf16 v[228:231], v[72:73], v[72:73], v[228:231]
    v_mfma_f32_4x4x4_16b_bf16 v[216:219], v[220:221], v[74:75], v[216:219]
    v_mfma_f32_4x4x4_16b_bf16 v[232:235], v[74:75], v[74:75], v[232:235]
    s_add_u32 s40, s62, 1033984
    s_add_u32 m0, s63, 53248
    s_nop 0
    buffer_load_dwordx4 v251, s[8:11], s40 offen lds
    v_mfma_f32_32x32x16_bf16 v[124:139], v[172:175], v[36:39], v[124:139]
    s_barrier
    s_cmp_eq_u32 s3, 0
    s_cbranch_scc0 reg_1
    s_lshl_b32 s40, s57, 3
    s_lshl_b64 s[52:53], 1, s40
    v_mov_b32 v222, s52
    v_mov_b32 v223, s53
    s_lshl_b32 s41, s16, 5
    s_mov_b64 exec, 1
    buffer_atomic_add_x2 v[222:223], v6, s[12:15], s41 offen offset:0 sc1
    s_mov_b64 exec, -1
reg_1:
    ds_read_b64_tr_b16 v[188:189], v248 offset:8192
    ds_read_b64_tr_b16 v[190:191], v248 offset:8448
    v_mfma_f32_32x32x16_bf16 v[140:155], v[36:39], v[176:179], v[140:155]
    ds_read_b64_tr_b16 v[192:193], v248 offset:36864
    ds_read_b64_tr_b16 v[194:195], v248 offset:37120
    v_mfma_f32_4x4x4_16b_bf16 v[156:159], v[220:221], v[172:173], v[156:159]
    v_mfma_f32_4x4x4_16b_bf16 v[164:167], v[220:221], v[176:177], v[164:167]
    v_mfma_f32_4x4x4_16b_bf16 v[160:163], v[220:221], v[174:175], v[160:163]
    v_mfma_f32_4x4x4_16b_bf16 v[168:171], v[220:221], v[178:179], v[168:171]
    v_mfma_f32_32x32x16_bf16 v[124:139], v[180:183], v[40:43], v[124:139]
    ds_read_b64_tr_b16 v[172:173], v248 offset:9216
    ds_read_b64_tr_b16 v[174:175], v248 offset:9472
    v_mfma_f32_32x32x16_bf16 v[140:155], v[40:43], v[184:187], v[140:155]
    ds_read_b64_tr_b16 v[176:177], v248 offset:37888
    ds_read_b64_tr_b16 v[178:179], v248 offset:38144
    v_mfma_f32_4x4x4_16b_bf16 v[156:159], v[220:221], v[180:181], v[156:159]
    v_mfma_f32_4x4x4_16b_bf16 v[164:167], v[220:221], v[184:185], v[164:167]
    v_mfma_f32_4x4x4_16b_bf16 v[160:163], v[220:221], v[182:183], v[160:163]
    v_mfma_f32_4x4x4_16b_bf16 v[168:171], v[220:221], v[186:187], v[168:171]
    s_waitcnt lgkmcnt(4)
    v_mfma_f32_32x32x16_bf16 v[124:139], v[188:191], v[44:47], v[124:139]
    ds_read_b64_tr_b16 v[180:181], v248 offset:10240
    ds_read_b64_tr_b16 v[182:183], v248 offset:10496
    v_mfma_f32_32x32x16_bf16 v[140:155], v[44:47], v[192:195], v[140:155]
    ds_read_b64_tr_b16 v[184:185], v248 offset:38912
    ds_read_b64_tr_b16 v[186:187], v248 offset:39168
    v_mfma_f32_4x4x4_16b_bf16 v[156:159], v[220:221], v[188:189], v[156:159]
    v_mfma_f32_4x4x4_16b_bf16 v[164:167], v[220:221], v[192:193], v[164:167]
    v_mfma_f32_4x4x4_16b_bf16 v[160:163], v[220:221], v[190:191], v[160:163]
    v_mfma_f32_4x4x4_16b_bf16 v[168:171], v[220:221], v[194:195], v[168:171]
    s_waitcnt vmcnt(8)
    ds_read_b128 v[76:79], v224 offset:0
    ds_read_b128 v[80:83], v225 offset:0
    ds_read_b128 v[84:87], v226 offset:0
    ds_read_b128 v[88:91], v227 offset:0
    s_waitcnt lgkmcnt(0)
    s_add_u32 s41, s43, 768
    s_add_u32 m0, s44, 0
    s_nop 0
    buffer_load_dwordx4 v250, s[28:31], s41 offen lds
    s_add_u32 s41, s43, 7936
    s_add_u32 m0, s44, 1024
    s_nop 0
    buffer_load_dwordx4 v250, s[28:31], s41 offen lds
    s_add_u32 s41, s43, 15104
    s_add_u32 m0, s44, 2048
    s_nop 0
    buffer_load_dwordx4 v250, s[28:31], s41 offen lds
    s_add_u32 s41, s43, 22272
    s_add_u32 m0, s44, 3072
    s_nop 0
    buffer_load_dwordx4 v250, s[28:31], s41 offen lds
    v_mfma_f32_4x4x4_16b_bf16 v[212:215], v[220:221], v[76:77], v[212:215]
    v_mfma_f32_4x4x4_16b_bf16 v[228:231], v[76:77], v[76:77], v[228:231]
    v_mfma_f32_4x4x4_16b_bf16 v[216:219], v[220:221], v[78:79], v[216:219]
    v_mfma_f32_4x4x4_16b_bf16 v[232:235], v[78:79], v[78:79], v[232:235]
    v_mfma_f32_4x4x4_16b_bf16 v[212:215], v[220:221], v[80:81], v[212:215]
    v_mfma_f32_4x4x4_16b_bf16 v[228:231], v[80:81], v[80:81], v[228:231]
    v_mfma_f32_4x4x4_16b_bf16 v[216:219], v[220:221], v[82:83], v[216:219]
    v_mfma_f32_4x4x4_16b_bf16 v[232:235], v[82:83], v[82:83], v[232:235]
    v_mfma_f32_4x4x4_16b_bf16 v[212:215], v[220:221], v[84:85], v[212:215]
    v_mfma_f32_4x4x4_16b_bf16 v[228:231], v[84:85], v[84:85], v[228:231]
    v_mfma_f32_4x4x4_16b_bf16 v[216:219], v[220:221], v[86:87], v[216:219]
    v_mfma_f32_4x4x4_16b_bf16 v[232:235], v[86:87], v[86:87], v[232:235]
    v_mfma_f32_4x4x4_16b_bf16 v[212:215], v[220:221], v[88:89], v[212:215]
    v_mfma_f32_4x4x4_16b_bf16 v[228:231], v[88:89], v[88:89], v[228:231]
    v_mfma_f32_4x4x4_16b_bf16 v[216:219], v[220:221], v[90:91], v[216:219]
    v_mfma_f32_4x4x4_16b_bf16 v[232:235], v[90:91], v[90:91], v[232:235]
    v_mfma_f32_32x32x16_bf16 v[124:139], v[172:175], v[48:51], v[124:139]
    ds_read_b64_tr_b16 v[188:189], v248 offset:11264
    ds_read_b64_tr_b16 v[190:191], v248 offset:11520
    v_mfma_f32_32x32x16_bf16 v[140:155], v[48:51], v[176:179], v[140:155]
    ds_read_b64_tr_b16 v[192:193], v248 offset:39936
    ds_read_b64_tr_b16 v[194:195], v248 offset:40192
    v_mfma_f32_4x4x4_16b_bf16 v[156:159], v[220:221], v[172:173], v[156:159]
    v_mfma_f32_4x4x4_16b_bf16 v[164:167], v[220:221], v[176:177], v[164:167]
    v_mfma_f32_4x4x4_16b_bf16 v[160:163], v[220:221], v[174:175], v[160:163]
    v_mfma_f32_4x4x4_16b_bf16 v[168:171], v[220:221], v[178:179], v[168:171]
    v_mfma_f32_32x32x16_bf16 v[124:139], v[180:183], v[52:55], v[124:139]
    ds_read_b64_tr_b16 v[172:173], v248 offset:12288
    ds_read_b64_tr_b16 v[174:175], v248 offset:12544
    v_mfma_f32_32x32x16_bf16 v[140:155], v[52:55], v[184:187], v[140:155]
    ds_read_b64_tr_b16 v[176:177], v248 offset:40960
    ds_read_b64_tr_b16 v[178:179], v248 offset:41216
    v_mfma_f32_4x4x4_16b_bf16 v[156:159], v[220:221], v[180:181], v[156:159]
    v_mfma_f32_4x4x4_16b_bf16 v[164:167], v[220:221], v[184:185], v[164:167]
    v_mfma_f32_4x4x4_16b_bf16 v[160:163], v[220:221], v[182:183], v[160:163]
    v_mfma_f32_4x4x4_16b_bf16 v[168:171], v[220:221], v[186:187], v[168:171]
    s_waitcnt lgkmcnt(4)
    v_mfma_f32_32x32x16_bf16 v[124:139], v[188:191], v[56:59], v[124:139]
    ds_read_b64_tr_b16 v[180:181], v248 offset:13312
    ds_read_b64_tr_b16 v[182:183], v248 offset:13568
    v_mfma_f32_32x32x16_bf16 v[140:155], v[56:59], v[192:195], v[140:155]
    ds_read_b64_tr_b16 v[184:185], v248 offset:41984
    ds_read_b64_tr_b16 v[186:187], v248 offset:42240
    v_mfma_f32_4x4x4_16b_bf16 v[156:159], v[220:221], v[188:189], v[156:159]
    v_mfma_f32_4x4x4_16b_bf16 v[164:167], v[220:221], v[192:193], v[164:167]
    v_mfma_f32_4x4x4_16b_bf16 v[160:163], v[220:221], v[190:191], v[160:163]
    v_mfma_f32_4x4x4_16b_bf16 v[168:171], v[220:221], v[194:195], v[168:171]
    s_waitcnt vmcnt(5)
    ds_read_b128 v[92:95], v224 offset:4096
    ds_read_b128 v[96:99], v225 offset:4096
    ds_read_b128 v[100:103], v226 offset:4096
    ds_read_b128 v[104:107], v227 offset:4096
    s_waitcnt lgkmcnt(0)
    v_mfma_f32_4x4x4_16b_bf16 v[212:215], v[220:221], v[92:93], v[212:215]
    v_mfma_f32_4x4x4_16b_bf16 v[228:231], v[92:93], v[92:93], v[228:231]
    v_mfma_f32_4x4x4_16b_bf16 v[216:219], v[220:221], v[94:95], v[216:219]
    v_mfma_f32_4x4x4_16b_bf16 v[232:235], v[94:95], v[94:95], v[232:235]
    v_mfma_f32_4x4x4_16b_bf16 v[212:215], v[220:221], v[96:97], v[212:215]
    v_mfma_f32_4x4x4_16b_bf16 v[228:231], v[96:97], v[96:97], v[228:231]
    v_mfma_f32_4x4x4_16b_bf16 v[216:219], v[220:221], v[98:99], v[216:219]
    v_mfma_f32_4x4x4_16b_bf16 v[232:235], v[98:99], v[98:99], v[232:235]
    v_mfma_f32_4x4x4_16b_bf16 v[212:215], v[220:221], v[100:101], v[212:215]
    v_mfma_f32_4x4x4_16b_bf16 v[228:231], v[100:101], v[100:101], v[228:231]
    v_mfma_f32_4x4x4_16b_bf16 v[216:219], v[220:221], v[102:103], v[216:219]
    v_mfma_f32_4x4x4_16b_bf16 v[232:235], v[102:103], v[102:103], v[232:235]
    v_mfma_f32_4x4x4_16b_bf16 v[212:215], v[220:221], v[104:105], v[212:215]
    v_mfma_f32_4x4x4_16b_bf16 v[228:231], v[104:105], v[104:105], v[228:231]
    v_mfma_f32_4x4x4_16b_bf16 v[216:219], v[220:221], v[106:107], v[216:219]
    v_mfma_f32_4x4x4_16b_bf16 v[232:235], v[106:107], v[106:107], v[232:235]
    v_mfma_f32_32x32x16_bf16 v[124:139], v[172:175], v[60:63], v[124:139]
    ds_read_b64_tr_b16 v[188:189], v248 offset:14336
    ds_read_b64_tr_b16 v[190:191], v248 offset:14592
    v_mfma_f32_32x32x16_bf16 v[140:155], v[60:63], v[176:179], v[140:155]
    ds_read_b64_tr_b16 v[192:193], v248 offset:43008
    ds_read_b64_tr_b16 v[194:195], v248 offset:43264
    v_mfma_f32_4x4x4_16b_bf16 v[156:159], v[220:221], v[172:173], v[156:159]
    v_mfma_f32_4x4x4_16b_bf16 v[164:167], v[220:221], v[176:177], v[164:167]
    v_mfma_f32_4x4x4_16b_bf16 v[160:163], v[220:221], v[174:175], v[160:163]
    v_mfma_f32_4x4x4_16b_bf16 v[168:171], v[220:221], v[178:179], v[168:171]
    s_add_u32 s40, s62, 0
    s_add_u32 m0, s63, 57344
    s_nop 0
    buffer_load_dwordx4 v251, s[8:11], s40 offen lds
    v_mfma_f32_32x32x16_bf16 v[124:139], v[180:183], v[64:67], v[124:139]
    ds_read_b64_tr_b16 v[172:173], v248 offset:15360
    ds_read_b64_tr_b16 v[174:175], v248 offset:15616
    v_mfma_f32_32x32x16_bf16 v[140:155], v[64:67], v[184:187], v[140:155]
    ds_read_b64_tr_b16 v[176:177], v248 offset:44032
    ds_read_b64_tr_b16 v[178:179], v248 offset:44288
    v_mfma_f32_4x4x4_16b_bf16 v[156:159], v[220:221], v[180:181], v[156:159]
    v_mfma_f32_4x4x4_16b_bf16 v[164:167], v[220:221], v[184:185], v[164:167]
    v_mfma_f32_4x4x4_16b_bf16 v[160:163], v[220:221], v[182:183], v[160:163]
    v_mfma_f32_4x4x4_16b_bf16 v[168:171], v[220:221], v[186:187], v[168:171]
    s_add_u32 s40, s62, 172032
    s_add_u32 m0, s63, 61440
    s_nop 0
    buffer_load_dwordx4 v251, s[8:11], s40 offen lds
    s_waitcnt lgkmcnt(4)
    v_mfma_f32_32x32x16_bf16 v[124:139], v[188:191], v[68:71], v[124:139]
    s_barrier
    ds_read_b64_tr_b16 v[180:181], v248 offset:16384
    ds_read_b64_tr_b16 v[182:183], v248 offset:16640
    v_mfma_f32_32x32x16_bf16 v[140:155], v[68:71], v[192:195], v[140:155]
    ds_read_b64_tr_b16 v[184:185], v248 offset:45056
    ds_read_b64_tr_b16 v[186:187], v248 offset:45312
    v_mfma_f32_4x4x4_16b_bf16 v[156:159], v[220:221], v[188:189], v[156:159]
    v_mfma_f32_4x4x4_16b_bf16 v[164:167], v[220:221], v[192:193], v[164:167]
    v_mfma_f32_4x4x4_16b_bf16 v[160:163], v[220:221], v[190:191], v[160:163]
    v_mfma_f32_4x4x4_16b_bf16 v[168:171], v[220:221], v[194:195], v[168:171]
    s_waitcnt vmcnt(2)
    ds_read_b128 v[108:111], v224 offset:0
    ds_read_b128 v[112:115], v225 offset:0
    ds_read_b128 v[116:119], v226 offset:0
    ds_read_b128 v[120:123], v227 offset:0
    s_waitcnt lgkmcnt(0)
    v_mfma_f32_4x4x4_16b_bf16 v[212:215], v[220:221], v[108:109], v[212:215]
    v_mfma_f32_4x4x4_16b_bf16 v[228:231], v[108:109], v[108:109], v[228:231]
    v_mfma_f32_4x4x4_16b_bf16 v[216:219], v[220:221], v[110:111], v[216:219]
    v_mfma_f32_4x4x4_16b_bf16 v[232:235], v[110:111], v[110:111], v[232:235]
    v_mfma_f32_4x4x4_16b_bf16 v[212:215], v[220:221], v[112:113], v[212:215]
    v_mfma_f32_4x4x4_16b_bf16 v[228:231], v[112:113], v[112:113], v[228:231]
    v_mfma_f32_4x4x4_16b_bf16 v[216:219], v[220:221], v[114:115], v[216:219]
    v_mfma_f32_4x4x4_16b_bf16 v[232:235], v[114:115], v[114:115], v[232:235]
    v_mfma_f32_4x4x4_16b_bf16 v[212:215], v[220:221], v[116:117], v[212:215]
    v_mfma_f32_4x4x4_16b_bf16 v[228:231], v[116:117], v[116:117], v[228:231]
    v_mfma_f32_4x4x4_16b_bf16 v[216:219], v[220:221], v[118:119], v[216:219]
    v_mfma_f32_4x4x4_16b_bf16 v[232:235], v[118:119], v[118:119], v[232:235]
    v_mfma_f32_4x4x4_16b_bf16 v[212:215], v[220:221], v[120:121], v[212:215]
    v_mfma_f32_4x4x4_16b_bf16 v[228:231], v[120:121], v[120:121], v[228:231]
    v_mfma_f32_4x4x4_16b_bf16 v[216:219], v[220:221], v[122:123], v[216:219]
    v_mfma_f32_4x4x4_16b_bf16 v[232:235], v[122:123], v[122:123], v[232:235]
    s_add_u32 s40, s62, 344064
    s_add_u32 m0, s63, 65536
    s_nop 0
    buffer_load_dwordx4 v251, s[8:11], s40 offen lds
    v_mfma_f32_32x32x16_bf16 v[124:139], v[172:175], v[72:75], v[124:139]
    ds_read_b64_tr_b16 v[188:189], v248 offset:17408
    ds_read_b64_tr_b16 v[190:191], v248 offset:17664
    v_mfma_f32_32x32x16_bf16 v[140:155], v[72:75], v[176:179], v[140:155]
    ds_read_b64_tr_b16 v[192:193], v248 offset:46080
    ds_read_b64_tr_b16 v[194:195], v248 offset:46336
    v_mfma_f32_4x4x4_16b_bf16 v[156:159], v[220:221], v[172:173], v[156:159]
    v_mfma_f32_4x4x4_16b_bf16 v[164:167], v[220:221], v[176:177], v[164:167]
    v_mfma_f32_4x4x4_16b_bf16 v[160:163], v[220:221], v[174:175], v[160:163]
    v_mfma_f32_4x4x4_16b_bf16 v[168:171], v[220:221], v[178:179], v[168:171]
    s_add_u32 s40, s62, 516096
    s_add_u32 m0, s63, 69632
    s_nop 0
    buffer_load_dwordx4 v251, s[8:11], s40 offen lds
    v_mfma_f32_32x32x16_bf16 v[124:139], v[180:183], v[76:79], v[124:139]
    ds_read_b64_tr_b16 v[172:173], v248 offset:18432
    ds_read_b64_tr_b16 v[174:175], v248 offset:18688
    v_mfma_f32_32x32x16_bf16 v[140:155], v[76:79], v[184:187], v[140:155]
    ds_read_b64_tr_b16 v[176:177], v248 offset:47104
    ds_read_b64_tr_b16 v[178:179], v248 offset:47360
    v_mfma_f32_4x4x4_16b_bf16 v[156:159], v[220:221], v[180:181], v[156:159]
    v_mfma_f32_4x4x4_16b_bf16 v[164:167], v[220:221], v[184:185], v[164:167]
    v_mfma_f32_4x4x4_16b_bf16 v[160:163], v[220:221], v[182:183], v[160:163]
    v_mfma_f32_4x4x4_16b_bf16 v[168:171], v[220:221], v[186:187], v[168:171]
    s_add_u32 s40, s62, 688128
    s_add_u32 m0, s63, 73728
    s_nop 0
    buffer_load_dwordx4 v251, s[8:11], s40 offen lds
    s_waitcnt lgkmcnt(4)
    v_mfma_f32_32x32x16_bf16 v[124:139], v[188:191], v[80:83], v[124:139]
    ds_read_b64_tr_b16 v[180:181], v248 offset:19456
    ds_read_b64_tr_b16 v[182:183], v248 offset:19712
    v_mfma_f32_32x32x16_bf16 v[140:155], v[80:83], v[192:195], v[140:155]
    ds_read_b64_tr_b16 v[184:185], v248 offset:48128
    ds_read_b64_tr_b16 v[186:187], v248 offset:48384
    v_mfma_f32_4x4x4_16b_bf16 v[156:159], v[220:221], v[188:189], v[156:159]
    v_mfma_f32_4x4x4_16b_bf16 v[164:167], v[220:221], v[192:193], v[164:167]
    v_mfma_f32_4x4x4_16b_bf16 v[160:163], v[220:221], v[190:191], v[160:163]
    v_mfma_f32_4x4x4_16b_bf16 v[168:171], v[220:221], v[194:195], v[168:171]
    s_add_u32 s40, s62, 860160
    s_add_u32 m0, s63, 77824
    s_nop 0
    buffer_load_dwordx4 v251, s[8:11], s40 offen lds
    s_waitcnt lgkmcnt(4)
    v_mfma_f32_32x32x16_bf16 v[124:139], v[172:175], v[84:87], v[124:139]
    ds_read_b64_tr_b16 v[188:189], v248 offset:20480
    ds_read_b64_tr_b16 v[190:191], v248 offset:20736
    v_mfma_f32_32x32x16_bf16 v[140:155], v[84:87], v[176:179], v[140:155]
    ds_read_b64_tr_b16 v[192:193], v248 offset:49152
    ds_read_b64_tr_b16 v[194:195], v248 offset:49408
    v_mfma_f32_4x4x4_16b_bf16 v[156:159], v[220:221], v[172:173], v[156:159]
    v_mfma_f32_4x4x4_16b_bf16 v[164:167], v[220:221], v[176:177], v[164:167]
    v_mfma_f32_4x4x4_16b_bf16 v[160:163], v[220:221], v[174:175], v[160:163]
    v_mfma_f32_4x4x4_16b_bf16 v[168:171], v[220:221], v[178:179], v[168:171]
    s_add_u32 s40, s62, 1032192
    s_add_u32 m0, s63, 81920
    s_nop 0
    buffer_load_dwordx4 v251, s[8:11], s40 offen lds
    s_waitcnt lgkmcnt(4)
    v_mfma_f32_32x32x16_bf16 v[124:139], v[180:183], v[88:91], v[124:139]
    ds_read_b64_tr_b16 v[172:173], v248 offset:21504
    ds_read_b64_tr_b16 v[174:175], v248 offset:21760
    v_mfma_f32_32x32x16_bf16 v[140:155], v[88:91], v[184:187], v[140:155]
    ds_read_b64_tr_b16 v[176:177], v248 offset:50176
    ds_read_b64_tr_b16 v[178:179], v248 offset:50432
    v_mfma_f32_4x4x4_16b_bf16 v[156:159], v[220:221], v[180:181], v[156:159]
    v_mfma_f32_4x4x4_16b_bf16 v[164:167], v[220:221], v[184:185], v[164:167]
    v_mfma_f32_4x4x4_16b_bf16 v[160:163], v[220:221], v[182:183], v[160:163]
    v_mfma_f32_4x4x4_16b_bf16 v[168:171], v[220:221], v[186:187], v[168:171]
    s_waitcnt lgkmcnt(4)
    v_mfma_f32_32x32x16_bf16 v[124:139], v[188:191], v[92:95], v[124:139]
    ds_read_b64_tr_b16 v[180:181], v248 offset:22528
    ds_read_b64_tr_b16 v[182:183], v248 offset:22784
    v_mfma_f32_32x32x16_bf16 v[140:155], v[92:95], v[192:195], v[140:155]
    ds_read_b64_tr_b16 v[184:185], v248 offset:51200
    ds_read_b64_tr_b16 v[186:187], v248 offset:51456
    v_mfma_f32_4x4x4_16b_bf16 v[156:159], v[220:221], v[188:189], v[156:159]
    v_mfma_f32_4x4x4_16b_bf16 v[164:167], v[220:221], v[192:193], v[164:167]
    v_mfma_f32_4x4x4_16b_bf16 v[160:163], v[220:221], v[190:191], v[160:163]
    v_mfma_f32_4x4x4_16b_bf16 v[168:171], v[220:221], v[194:195], v[168:171]
    s_cmp_eq_u32 s3, 0
    s_cselect_b32 s88, s24, s36
    s_cselect_b32 s89, s25, s37
    s_cmp_lt_u32 s3, 2
    s_cselect_b32 s88, s88, s34
    s_cselect_b32 s89, s89, s35
    s_mov_b32 s90, 1605632
    s_cselect_b32 s90, s90, 401408
    s_movk_i32 s45, 6272
    s_cselect_b32 s45, s45, 896
    s_cselect_b32 s46, 48, 6
    s_and_b32 s89, s89, 0xffff
    s_mov_b32 s91, 0x00020000
    s_and_b32 s47, s3, 1
    s_lshl_b32 s47, s47, 8
    s_cmp_lt_u32 s3, 2
    s_cselect_b32 s47, 0, s47
    s_add_u32 s47, s47, s2
    s_mul_i32 s45, s45, s47
    v_min_u32 v11, s46, v0
    v_lshlrev_b32 v11, 7, v11
    buffer_load_dword v9, v11, s[88:91], s45 offen
    s_waitcnt lgkmcnt(4)
    v_mfma_f32_32x32x16_bf16 v[124:139], v[172:175], v[96:99], v[124:139]
    ds_read_b64_tr_b16 v[188:189], v248 offset:23552
    ds_read_b64_tr_b16 v[190:191], v248 offset:23808
    v_mfma_f32_32x32x16_bf16 v[140:155], v[96:99], v[176:179], v[140:155]
    ds_read_b64_tr_b16 v[192:193], v248 offset:52224
    ds_read_b64_tr_b16 v[194:195], v248 offset:52480
    v_mfma_f32_4x4x4_16b_bf16 v[156:159], v[220:221], v[172:173], v[156:159]
    v_mfma_f32_4x4x4_16b_bf16 v[164:167], v[220:221], v[176:177], v[164:167]
    v_mfma_f32_4x4x4_16b_bf16 v[160:163], v[220:221], v[174:175], v[160:163]
    v_mfma_f32_4x4x4_16b_bf16 v[168:171], v[220:221], v[178:179], v[168:171]
    s_waitcnt lgkmcnt(4)
    v_mfma_f32_32x32x16_bf16 v[124:139], v[180:183], v[100:103], v[124:139]
    s_barrier
    ds_read_b64_tr_b16 v[172:173], v248 offset:24576
    ds_read_b64_tr_b16 v[174:175], v248 offset:24832
    v_mfma_f32_32x32x16_bf16 v[140:155], v[100:103], v[184:187], v[140:155]
    ds_read_b64_tr_b16 v[176:177], v248 offset:53248
    ds_read_b64_tr_b16 v[178:179], v248 offset:53504
    v_mfma_f32_4x4x4_16b_bf16 v[156:159], v[220:221], v[180:181], v[156:159]
    v_and_b32 v223, 3, v0
    v_add_f32 v228, v228, v232
    v_add_f32 v229, v229, v233
    v_add_f32 v230, v230, v234
    v_add_f32 v231, v231, v235
    v_add_f32 v212, v212, v216
    v_cmp_eq_u32 vcc, 1, v223
    s_nop 1
    v_cndmask_b32 v228, v228, v229, vcc
    v_cmp_eq_u32 vcc, 2, v223
    s_nop 1
    v_cndmask_b32 v228, v228, v230, vcc
    v_cmp_eq_u32 vcc, 3, v223
    s_nop 1
    v_cndmask_b32 v228, v228, v231, vcc
    v_mov_b32 v223, v212
    v_mov_b32 v222, v228
    s_nop 0
    v_permlane32_swap_b32 v223, v212
    v_permlane32_swap_b32 v222, v228
    v_add_f32 v223, v223, v212
    v_add_f32 v222, v222, v228
    v_mul_f32 v240, 0xbb124925, v223
    v_mul_f32 v241, 0x3b124925, v222
    v_fma_f32 v241, -v240, v240, v241
    v_max_f32 v241, 0, v241
    v_mfma_f32_4x4x4_16b_bf16 v[164:167], v[220:221], v[184:185], v[164:167]
    v_add_f32 v241, 0x3727c5ac, v241
    v_rsq_f32 v242, v241
    v_mfma_f32_4x4x4_16b_bf16 v[160:163], v[220:221], v[182:183], v[160:163]
    v_sqrt_f32 v243, v241
    v_cmp_eq_u32 vcc, 0, v3
    v_mfma_f32_4x4x4_16b_bf16 v[168:171], v[220:221], v[186:187], v[168:171]
    v_mul_f32 v246, 0x3e8b97f6, v242
    v_cvt_pk_bf16_f32 v237, v240, v243
    s_waitcnt lgkmcnt(4)
    v_mfma_f32_32x32x16_bf16 v[124:139], v[188:191], v[104:107], v[124:139]
    v_mov_b32 v239, 0
    v_lshlrev_b32 v244, 16, v237
    ds_read_b64_tr_b16 v[180:181], v248 offset:25600
    ds_read_b64_tr_b16 v[182:183], v248 offset:25856
    v_mfma_f32_32x32x16_bf16 v[140:155], v[104:107], v[192:195], v[140:155]
    v_and_b32 v245, 0xffff0000, v237
    v_sub_f32 v236, v240, v244
    ds_read_b64_tr_b16 v[184:185], v248 offset:54272
    ds_read_b64_tr_b16 v[186:187], v248 offset:54528
    v_mfma_f32_4x4x4_16b_bf16 v[156:159], v[220:221], v[188:189], v[156:159]
    v_sub_f32 v245, v243, v245
    v_cvt_pk_bf16_f32 v236, v244, v236
    v_mfma_f32_4x4x4_16b_bf16 v[164:167], v[220:221], v[192:193], v[164:167]
    v_cvt_pk_bf16_f32 v238, v245, v239
    v_cndmask_b32 v247, 0, v246, vcc
    v_mfma_f32_4x4x4_16b_bf16 v[160:163], v[220:221], v[190:191], v[160:163]
    s_lshl_b32 s46, s3, 13
    s_add_u32 s46, s46, 86016
    v_mfma_f32_4x4x4_16b_bf16 v[168:171], v[220:221], v[194:195], v[168:171]
    v_lshl_add_u32 v244, v2, 2, s46
    ds_write_b32 v244, v242
    s_waitcnt lgkmcnt(5)
    v_mfma_f32_32x32x16_bf16 v[124:139], v[172:175], v[108:111], v[124:139]
    ds_write_b32 v244, v6 offset:128
    v_lshl_add_u32 v245, v3, 4, s46
    v_cmp_lt_u32 vcc, 27, v2
    v_add_u32 v244, 128, v245
    s_nop 0
    v_cndmask_b32 v245, v245, v244, vcc
    ds_read_b64_tr_b16 v[188:189], v248 offset:26624
    ds_read_b64_tr_b16 v[190:191], v248 offset:26880
    v_mfma_f32_32x32x16_bf16 v[140:155], v[108:111], v[176:179], v[140:155]
    s_waitcnt lgkmcnt(2)
    ds_read_b128 v[196:199], v245 offset:0
    ds_read_b64_tr_b16 v[192:193], v248 offset:55296
    ds_read_b64_tr_b16 v[194:195], v248 offset:55552
    v_mfma_f32_4x4x4_16b_bf16 v[156:159], v[220:221], v[172:173], v[156:159]
    ds_read_b128 v[200:203], v245 offset:32
    ds_read_b128 v[204:207], v245 offset:64
    v_mfma_f32_4x4x4_16b_bf16 v[164:167], v[220:221], v[176:177], v[164:167]
    ds_read_b128 v[208:211], v245 offset:96
    v_mfma_f32_4x4x4_16b_bf16 v[160:163], v[220:221], v[174:175], v[160:163]
    v_mfma_f32_4x4x4_16b_bf16 v[168:171], v[220:221], v[178:179], v[168:171]
    v_mfma_f32_32x32x16_bf16 v[124:139], v[180:183], v[112:115], v[124:139]
    ds_read_b64_tr_b16 v[172:173], v248 offset:27648
    ds_read_b64_tr_b16 v[174:175], v248 offset:27904
    v_mfma_f32_32x32x16_bf16 v[140:155], v[112:115], v[184:187], v[140:155]
    ds_read_b64_tr_b16 v[176:177], v248 offset:56320
    ds_read_b64_tr_b16 v[178:179], v248 offset:56576
    v_mfma_f32_4x4x4_16b_bf16 v[156:159], v[220:221], v[180:181], v[156:159]
    v_mfma_f32_4x4x4_16b_bf16 v[164:167], v[220:221], v[184:185], v[164:167]
    v_mfma_f32_4x4x4_16b_bf16 v[160:163], v[220:221], v[182:183], v[160:163]
    v_mfma_f32_4x4x4_16b_bf16 v[168:171], v[220:221], v[186:187], v[168:171]
    s_mov_b32 s28, s92
    s_and_b32 s29, s93, 0xffff
    s_mov_b32 s30, 0xe00
    s_mov_b32 s31, 0x00020000
    v_lshlrev_b32 v11, 1, v2
    s_lshl_b32 s41, s23, 8
    s_lshl_b32 s42, s3, 6
    s_add_u32 s41, s41, s42
    buffer_load_ushort a252, v11, s[28:31], s41 offen
    s_mov_b32 s28, s94
    s_and_b32 s29, s95, 0xffff
    s_mov_b32 s30, 0x380
    s_mov_b32 s31, 0x00020000
    s_lshl_b32 s41, s78, 6
    buffer_load_ushort v253, v11, s[28:31], s41 offen
    s_waitcnt lgkmcnt(7)
    v_mfma_f32_32x32x16_bf16 v[124:139], v[188:191], v[116:119], v[124:139]
    v_mfma_f32_32x32x16_bf16 v[140:155], v[116:119], v[192:195], v[140:155]
    v_mfma_f32_4x4x4_16b_bf16 v[156:159], v[220:221], v[188:189], v[156:159]
    v_mfma_f32_4x4x4_16b_bf16 v[164:167], v[220:221], v[192:193], v[164:167]
    v_mfma_f32_4x4x4_16b_bf16 v[160:163], v[220:221], v[190:191], v[160:163]
    v_mfma_f32_4x4x4_16b_bf16 v[168:171], v[220:221], v[194:195], v[168:171]
    s_waitcnt lgkmcnt(0)
    v_mfma_f32_32x32x16_bf16 v[124:139], v[172:175], v[120:123], v[124:139]
    v_mfma_f32_32x32x16_bf16 v[140:155], v[120:123], v[176:179], v[140:155]
    v_mfma_f32_4x4x4_16b_bf16 v[156:159], v[220:221], v[172:173], v[156:159]
    v_mfma_f32_4x4x4_16b_bf16 v[164:167], v[220:221], v[176:177], v[164:167]
    v_mfma_f32_4x4x4_16b_bf16 v[160:163], v[220:221], v[174:175], v[160:163]
    v_mfma_f32_4x4x4_16b_bf16 v[168:171], v[220:221], v[178:179], v[168:171]
    s_nop 3
    v_add_f32 v156, v156, v160
    v_mov_b32 v157, v156
    s_nop 1
    v_permlane32_swap_b32 v156, v157
    v_add_f32 v156, v156, v157
    v_cmp_eq_u32 vcc, 0, v3
    v_cvt_pk_bf16_f32 v172, v156, v156
    v_lshlrev_b32 v158, 16, v172
    v_sub_f32 v158, v156, v158
    v_cvt_pk_bf16_f32 v173, v158, v158
    v_and_b32 v173, 0xffff, v173
    v_mov_b32 v174, 0
    v_mov_b32 v175, 0
    v_cndmask_b32 v172, 0, v172, vcc
    v_cndmask_b32 v173, 0, v173, vcc
    v_add_f32 v164, v164, v168
    v_mov_b32 v165, v164
    s_nop 1
    v_permlane32_swap_b32 v164, v165
    v_add_f32 v164, v164, v165
    v_cmp_eq_u32 vcc, 0, v3
    v_cvt_pk_bf16_f32 v176, v164, v164
    v_lshlrev_b32 v166, 16, v176
    v_sub_f32 v166, v164, v166
    v_cvt_pk_bf16_f32 v177, v166, v166
    v_and_b32 v177, 0xffff, v177
    v_mov_b32 v178, 0
    v_mov_b32 v179, 0
    v_cndmask_b32 v176, 0, v176, vcc
    v_cndmask_b32 v177, 0, v177, vcc
    v_accvgpr_write_b32 a244, v172
    v_accvgpr_write_b32 a245, v173
    v_accvgpr_write_b32 a246, v174
    v_accvgpr_write_b32 a247, v175
    v_accvgpr_write_b32 a248, v176
    v_accvgpr_write_b32 a249, v177
    v_accvgpr_write_b32 a250, v178
    v_accvgpr_write_b32 a251, v179
    v_mfma_f32_32x32x16_bf16 v[124:139], a[244:247], v[236:239], v[124:139]
    s_nop 0
    v_mfma_f32_32x32x16_bf16 v[140:155], v[236:239], a[248:251], v[140:155]
    s_nop 9
    v_mul_f32 v124, v242, v124
    v_mul_f32 v125, v242, v125
    v_mul_f32 v126, v242, v126
    v_mul_f32 v127, v242, v127
    v_mul_f32 v128, v242, v128
    v_mul_f32 v129, v242, v129
    v_mul_f32 v130, v242, v130
    v_mul_f32 v131, v242, v131
    v_mul_f32 v132, v242, v132
    v_mul_f32 v133, v242, v133
    v_mul_f32 v134, v242, v134
    v_mul_f32 v135, v242, v135
    v_mul_f32 v136, v242, v136
    v_mul_f32 v137, v242, v137
    v_mul_f32 v138, v242, v138
    v_mul_f32 v139, v242, v139
    v_cvt_pk_bf16_f32 v212, v124, v125
    v_cvt_pk_bf16_f32 v213, v126, v127
    v_cvt_pk_bf16_f32 v214, v128, v129
    v_cvt_pk_bf16_f32 v215, v130, v131
    v_cvt_pk_bf16_f32 v216, v132, v133
    v_cvt_pk_bf16_f32 v217, v134, v135
    v_cvt_pk_bf16_f32 v218, v136, v137
    v_cvt_pk_bf16_f32 v219, v138, v139
    s_add_u32 s47, s66, 16777216
    buffer_store_dwordx4 v[212:215], v1, s[4:7], s47 offen sc1
    buffer_store_dwordx4 v[216:219], v1, s[4:7], s47 offen offset:1024 sc1
    v_cmp_eq_u32 vcc, 28, v2
    s_nop 1
    v_cndmask_b32_e64 v245, 0, 1.0, vcc
    v_fma_f32 v140, v196, v140, v245
    v_fma_f32 v141, v197, v141, v245
    v_fma_f32 v142, v198, v142, v245
    v_fma_f32 v143, v199, v143, v245
    v_fma_f32 v144, v200, v144, v245
    v_fma_f32 v145, v201, v145, v245
    v_fma_f32 v146, v202, v146, v245
    v_fma_f32 v147, v203, v147, v245
    v_fma_f32 v148, v204, v148, v245
    v_fma_f32 v149, v205, v149, v245
    v_fma_f32 v150, v206, v150, v245
    v_fma_f32 v151, v207, v151, v245
    v_fma_f32 v152, v208, v152, v245
    v_fma_f32 v153, v209, v153, v245
    v_fma_f32 v154, v210, v154, v245
    v_fma_f32 v155, v211, v155, v245
    v_cvt_pk_bf16_f32 v228, v140, v141
    v_cvt_pk_bf16_f32 v229, v142, v143
    v_cvt_pk_bf16_f32 v230, v144, v145
    v_cvt_pk_bf16_f32 v231, v146, v147
    v_cvt_pk_bf16_f32 v232, v148, v149
    v_cvt_pk_bf16_f32 v233, v150, v151
    v_cvt_pk_bf16_f32 v234, v152, v153
    v_cvt_pk_bf16_f32 v235, v154, v155
    buffer_store_dwordx4 v[228:231], v1, s[4:7], s47 offen offset:2048 sc1
    buffer_store_dwordx4 v[232:235], v1, s[4:7], s47 offen offset:3072 sc1
    s_add_u32 s48, s3, 8
    s_cmp_eq_u32 s3, 3
    s_cselect_b32 s48, 6, s48
    s_lshl_b32 s48, s48, 12
    s_add_u32 s48, s48, 86016
    v_add_u32 v244, s48, v1
    ds_write_b128 v244, v[212:215]
    ds_write_b128 v244, v[216:219] offset:1024
    ds_write_b128 v244, v[228:231] offset:2048
    ds_write_b128 v244, v[232:235] offset:3072
    s_lshl_b32 s42, s20, 2
    s_lshl_b32 s43, s3, 1
    s_add_u32 s42, s42, s43
    s_sub_i32 s42, s42, 8
    s_max_i32 s45, s42, 0
    s_lshl_b32 s43, s21, 6
    s_add_u32 s43, s43, s45
    s_lshl_b32 s43, s43, 12
    s_add_u32 s43, s43, 16777216
    s_add_u32 s44, s43, 4096
    s_sub_u32 s45, s43, 16777216
    s_lshr_b32 s45, s45, 5
    s_add_u32 s45, s45, 5505024
    v_and_b32 v11, 128, v252
    s_waitcnt vmcnt(7)
    s_barrier
    ds_read_b64_tr_b16 v[172:173], v248 offset:57344
    ds_read_b64_tr_b16 v[174:175], v248 offset:57600
    ds_read_b64_tr_b16 v[176:177], v248 offset:58368
    ds_read_b64_tr_b16 v[178:179], v248 offset:58624
    ds_read_b64_tr_b16 v[180:181], v248 offset:59392
    ds_read_b64_tr_b16 v[182:183], v248 offset:59648
    ds_read_b64_tr_b16 v[184:185], v248 offset:60416
    ds_read_b64_tr_b16 v[186:187], v248 offset:60672
    ds_read_b64_tr_b16 v[188:189], v248 offset:61440
    ds_read_b64_tr_b16 v[190:191], v248 offset:61696
    s_waitcnt lgkmcnt(8)
    v_mfma_f32_32x32x16_bf16 v[156:171], v[172:175], v[12:15], 0
    v_mfma_f32_4x4x4_16b_bf16 v[124:127], v[220:221], v[172:173], 0
    v_mfma_f32_4x4x4_16b_bf16 v[128:131], v[220:221], v[174:175], 0
    s_nop 0
    ds_read_b64_tr_b16 v[192:193], v248 offset:62464
    ds_read_b64_tr_b16 v[194:195], v248 offset:62720
    s_waitcnt lgkmcnt(8)
    v_mfma_f32_32x32x16_bf16 v[156:171], v[176:179], v[16:19], v[156:171]
    v_mfma_f32_4x4x4_16b_bf16 v[124:127], v[220:221], v[176:177], v[124:127]
    v_mfma_f32_4x4x4_16b_bf16 v[128:131], v[220:221], v[178:179], v[128:131]
    s_nop 0
    ds_read_b64_tr_b16 v[172:173], v248 offset:63488
    ds_read_b64_tr_b16 v[174:175], v248 offset:63744
    s_waitcnt lgkmcnt(8)
    v_mfma_f32_32x32x16_bf16 v[156:171], v[180:183], v[20:23], v[156:171]
    v_mfma_f32_4x4x4_16b_bf16 v[124:127], v[220:221], v[180:181], v[124:127]
    v_mfma_f32_4x4x4_16b_bf16 v[128:131], v[220:221], v[182:183], v[128:131]
    s_waitcnt vmcnt(0)
    s_lshr_b32 s48, s66, 5
    s_add_u32 s48, s48, 5505024
    s_mov_b64 exec, 1
    buffer_store_dword v10, v6, s[4:7], s48 offen sc1
    s_mov_b64 exec, -1
    ds_read_b64_tr_b16 v[176:177], v248 offset:64512
    ds_read_b64_tr_b16 v[178:179], v248 offset:64768
    s_waitcnt lgkmcnt(8)
    v_mfma_f32_32x32x16_bf16 v[156:171], v[184:187], v[24:27], v[156:171]
    v_mfma_f32_4x4x4_16b_bf16 v[124:127], v[220:221], v[184:185], v[124:127]
    v_mfma_f32_4x4x4_16b_bf16 v[128:131], v[220:221], v[186:187], v[128:131]
    s_mov_b32 s28, s34
    s_and_b32 s29, s35, 0xffff
    s_mov_b32 s30, 0x62000
    s_mov_b32 s31, 0x00020000
    v_lshrrev_b32 v250, 2, v0
    v_mul_u32_u24 v250, 896, v250
    v_and_b32 v11, 3, v0
    v_lshl_add_u32 v250, v11, 4, v250
    s_add_u32 s40, s69, 0
    s_add_u32 m0, s63, 131072
    s_nop 0
    buffer_load_dwordx4 v250, s[28:31], s40 offen lds
    ds_read_b64_tr_b16 v[180:181], v249 offset:0
    ds_read_b64_tr_b16 v[182:183], v249 offset:256
    s_waitcnt lgkmcnt(8)
    v_mfma_f32_32x32x16_bf16 v[156:171], v[188:191], v[28:31], v[156:171]
    v_mfma_f32_4x4x4_16b_bf16 v[124:127], v[220:221], v[188:189], v[124:127]
    v_mfma_f32_4x4x4_16b_bf16 v[128:131], v[220:221], v[190:191], v[128:131]
    s_add_u32 s40, s69, 57344
    s_add_u32 m0, s63, 135168
    s_nop 0
    buffer_load_dwordx4 v250, s[28:31], s40 offen lds
    ds_read_b64_tr_b16 v[184:185], v249 offset:1024
    ds_read_b64_tr_b16 v[186:187], v249 offset:1280
    s_waitcnt lgkmcnt(8)
    v_mfma_f32_32x32x16_bf16 v[156:171], v[192:195], v[32:35], v[156:171]
    v_mfma_f32_4x4x4_16b_bf16 v[124:127], v[220:221], v[192:193], v[124:127]
    v_mfma_f32_4x4x4_16b_bf16 v[128:131], v[220:221], v[194:195], v[128:131]
    s_add_u32 s40, s69, 114688
    s_add_u32 m0, s63, 139264
    s_nop 0
    buffer_load_dwordx4 v250, s[28:31], s40 offen lds
    ds_read_b64_tr_b16 v[188:189], v249 offset:2048
    ds_read_b64_tr_b16 v[190:191], v249 offset:2304
    s_waitcnt lgkmcnt(8)
    v_mfma_f32_32x32x16_bf16 v[156:171], v[172:175], v[36:39], v[156:171]
    v_mfma_f32_4x4x4_16b_bf16 v[124:127], v[220:221], v[172:173], v[124:127]
    v_mfma_f32_4x4x4_16b_bf16 v[128:131], v[220:221], v[174:175], v[128:131]
    s_add_u32 s40, s69, 172032
    s_add_u32 m0, s63, 143360
    s_nop 0
    buffer_load_dwordx4 v250, s[28:31], s40 offen lds
    ds_read_b64_tr_b16 v[192:193], v249 offset:3072
    ds_read_b64_tr_b16 v[194:195], v249 offset:3328
    s_waitcnt lgkmcnt(8)
    v_mfma_f32_32x32x16_bf16 v[156:171], v[176:179], v[40:43], v[156:171]
    v_mfma_f32_4x4x4_16b_bf16 v[124:127], v[220:221], v[176:177], v[124:127]
    v_mfma_f32_4x4x4_16b_bf16 v[128:131], v[220:221], v[178:179], v[128:131]
    s_add_u32 s40, s69, 229376
    s_add_u32 m0, s63, 147456
    s_nop 0
    buffer_load_dwordx4 v250, s[28:31], s40 offen lds
    ds_read_b64_tr_b16 v[172:173], v249 offset:4096
    ds_read_b64_tr_b16 v[174:175], v249 offset:4352
    s_waitcnt lgkmcnt(8)
    v_mfma_f32_32x32x16_bf16 v[156:171], v[180:183], v[44:47], v[156:171]
    v_mfma_f32_4x4x4_16b_bf16 v[124:127], v[220:221], v[180:181], v[124:127]
    v_mfma_f32_4x4x4_16b_bf16 v[128:131], v[220:221], v[182:183], v[128:131]
    s_add_u32 s40, s69, 286720
    s_add_u32 m0, s63, 151552
    s_nop 0
    buffer_load_dwordx4 v250, s[28:31], s40 offen lds
    ds_read_b64_tr_b16 v[176:177], v249 offset:5120
    ds_read_b64_tr_b16 v[178:179], v249 offset:5376
    s_waitcnt lgkmcnt(8)
    v_mfma_f32_32x32x16_bf16 v[156:171], v[184:187], v[48:51], v[156:171]
    v_mfma_f32_4x4x4_16b_bf16 v[124:127], v[220:221], v[184:185], v[124:127]
    v_mfma_f32_4x4x4_16b_bf16 v[128:131], v[220:221], v[186:187], v[128:131]
    s_add_u32 s40, s69, 344064
    s_add_u32 m0, s63, 155648
    s_nop 0
    buffer_load_dwordx4 v250, s[28:31], s40 offen lds
    ds_read_b64_tr_b16 v[180:181], v249 offset:6144
    ds_read_b64_tr_b16 v[182:183], v249 offset:6400
    s_waitcnt lgkmcnt(8)
    v_mfma_f32_32x32x16_bf16 v[156:171], v[188:191], v[52:55], v[156:171]
    v_mfma_f32_4x4x4_16b_bf16 v[124:127], v[220:221], v[188:189], v[124:127]
    v_mfma_f32_4x4x4_16b_bf16 v[128:131], v[220:221], v[190:191], v[128:131]
    s_add_u32 s40, s69, 401408
    s_add_u32 m0, s63, 159744
    s_nop 0
    buffer_load_dwordx4 v250, s[28:31], s40 offen lds
    ds_read_b64_tr_b16 v[184:185], v249 offset:7168
    ds_read_b64_tr_b16 v[186:187], v249 offset:7424
    s_waitcnt lgkmcnt(8)
    v_mfma_f32_32x32x16_bf16 v[156:171], v[192:195], v[56:59], v[156:171]
    v_mfma_f32_4x4x4_16b_bf16 v[124:127], v[220:221], v[192:193], v[124:127]
    v_mfma_f32_4x4x4_16b_bf16 v[128:131], v[220:221], v[194:195], v[128:131]
    s_add_u32 s58, s16, 7
    s_and_b32 s58, s58, 7
    s_lshl_b32 s58, s58, 5
    s_lshl_b32 s59, s16, 5
    buffer_load_dwordx2 v[224:225], v6, s[12:15], s59 offen sc1
    buffer_load_dwordx2 v[226:227], v6, s[12:15], s58 offen sc1
    ds_read_b64_tr_b16 v[188:189], v249 offset:8192
    ds_read_b64_tr_b16 v[190:191], v249 offset:8448
    s_waitcnt lgkmcnt(8)
    v_mfma_f32_32x32x16_bf16 v[156:171], v[172:175], v[60:63], v[156:171]
    v_mfma_f32_4x4x4_16b_bf16 v[124:127], v[220:221], v[172:173], v[124:127]
    v_mfma_f32_4x4x4_16b_bf16 v[128:131], v[220:221], v[174:175], v[128:131]
    ds_read_b64_tr_b16 v[192:193], v249 offset:9216
    ds_read_b64_tr_b16 v[194:195], v249 offset:9472
    s_waitcnt lgkmcnt(8)
    v_mfma_f32_32x32x16_bf16 v[156:171], v[176:179], v[64:67], v[156:171]
    v_mfma_f32_4x4x4_16b_bf16 v[124:127], v[220:221], v[176:177], v[124:127]
    v_mfma_f32_4x4x4_16b_bf16 v[128:131], v[220:221], v[178:179], v[128:131]
    ds_read_b64_tr_b16 v[172:173], v249 offset:10240
    ds_read_b64_tr_b16 v[174:175], v249 offset:10496
    s_waitcnt lgkmcnt(8)
    v_mfma_f32_32x32x16_bf16 v[156:171], v[180:183], v[68:71], v[156:171]
    v_mfma_f32_4x4x4_16b_bf16 v[124:127], v[220:221], v[180:181], v[124:127]
    v_mfma_f32_4x4x4_16b_bf16 v[128:131], v[220:221], v[182:183], v[128:131]
    ds_read_b64_tr_b16 v[176:177], v249 offset:11264
    ds_read_b64_tr_b16 v[178:179], v249 offset:11520
    s_waitcnt lgkmcnt(8)
    v_mfma_f32_32x32x16_bf16 v[156:171], v[184:187], v[72:75], v[156:171]
    v_mfma_f32_4x4x4_16b_bf16 v[124:127], v[220:221], v[184:185], v[124:127]
    v_mfma_f32_4x4x4_16b_bf16 v[128:131], v[220:221], v[186:187], v[128:131]
    ds_read_b64_tr_b16 v[180:181], v249 offset:12288
    ds_read_b64_tr_b16 v[182:183], v249 offset:12544
    s_waitcnt lgkmcnt(8)
    v_mfma_f32_32x32x16_bf16 v[156:171], v[188:191], v[76:79], v[156:171]
    v_mfma_f32_4x4x4_16b_bf16 v[124:127], v[220:221], v[188:189], v[124:127]
    v_mfma_f32_4x4x4_16b_bf16 v[128:131], v[220:221], v[190:191], v[128:131]
    ds_read_b64_tr_b16 v[184:185], v249 offset:13312
    ds_read_b64_tr_b16 v[186:187], v249 offset:13568
    s_waitcnt lgkmcnt(8)
    v_mfma_f32_32x32x16_bf16 v[156:171], v[192:195], v[80:83], v[156:171]
    v_mfma_f32_4x4x4_16b_bf16 v[124:127], v[220:221], v[192:193], v[124:127]
    v_mfma_f32_4x4x4_16b_bf16 v[128:131], v[220:221], v[194:195], v[128:131]
    ds_read_b64_tr_b16 v[188:189], v249 offset:14336
    ds_read_b64_tr_b16 v[190:191], v249 offset:14592
    s_waitcnt lgkmcnt(8)
    v_mfma_f32_32x32x16_bf16 v[156:171], v[172:175], v[84:87], v[156:171]
    v_mfma_f32_4x4x4_16b_bf16 v[124:127], v[220:221], v[172:173], v[124:127]
    v_mfma_f32_4x4x4_16b_bf16 v[128:131], v[220:221], v[174:175], v[128:131]
    ds_read_b64_tr_b16 v[192:193], v249 offset:15360
    ds_read_b64_tr_b16 v[194:195], v249 offset:15616
    s_waitcnt lgkmcnt(8)
    v_mfma_f32_32x32x16_bf16 v[156:171], v[176:179], v[88:91], v[156:171]
    v_mfma_f32_4x4x4_16b_bf16 v[124:127], v[220:221], v[176:177], v[124:127]
    v_mfma_f32_4x4x4_16b_bf16 v[128:131], v[220:221], v[178:179], v[128:131]
    ds_read_b64_tr_b16 v[172:173], v249 offset:16384
    ds_read_b64_tr_b16 v[174:175], v249 offset:16640
    s_waitcnt lgkmcnt(8)
    v_mfma_f32_32x32x16_bf16 v[156:171], v[180:183], v[92:95], v[156:171]
    v_mfma_f32_4x4x4_16b_bf16 v[124:127], v[220:221], v[180:181], v[124:127]
    v_mfma_f32_4x4x4_16b_bf16 v[128:131], v[220:221], v[182:183], v[128:131]
    ds_read_b64_tr_b16 v[176:177], v249 offset:17408
    ds_read_b64_tr_b16 v[178:179], v249 offset:17664
    s_waitcnt lgkmcnt(8)
    v_mfma_f32_32x32x16_bf16 v[156:171], v[184:187], v[96:99], v[156:171]
    v_mfma_f32_4x4x4_16b_bf16 v[124:127], v[220:221], v[184:185], v[124:127]
    v_mfma_f32_4x4x4_16b_bf16 v[128:131], v[220:221], v[186:187], v[128:131]
    ds_read_b64_tr_b16 v[180:181], v249 offset:18432
    ds_read_b64_tr_b16 v[182:183], v249 offset:18688
    s_waitcnt lgkmcnt(8)
    v_mfma_f32_32x32x16_bf16 v[156:171], v[188:191], v[100:103], v[156:171]
    v_mfma_f32_4x4x4_16b_bf16 v[124:127], v[220:221], v[188:189], v[124:127]
    v_mfma_f32_4x4x4_16b_bf16 v[128:131], v[220:221], v[190:191], v[128:131]
    ds_read_b64_tr_b16 v[184:185], v249 offset:19456
    ds_read_b64_tr_b16 v[186:187], v249 offset:19712
    s_waitcnt lgkmcnt(8)
    v_mfma_f32_32x32x16_bf16 v[156:171], v[192:195], v[104:107], v[156:171]
    v_mfma_f32_4x4x4_16b_bf16 v[124:127], v[220:221], v[192:193], v[124:127]
    v_mfma_f32_4x4x4_16b_bf16 v[128:131], v[220:221], v[194:195], v[128:131]
    s_waitcnt lgkmcnt(6)
    v_mfma_f32_32x32x16_bf16 v[156:171], v[172:175], v[108:111], v[156:171]
    v_mfma_f32_4x4x4_16b_bf16 v[124:127], v[220:221], v[172:173], v[124:127]
    v_mfma_f32_4x4x4_16b_bf16 v[128:131], v[220:221], v[174:175], v[128:131]
    s_waitcnt lgkmcnt(4)
    v_mfma_f32_32x32x16_bf16 v[156:171], v[176:179], v[112:115], v[156:171]
    v_mfma_f32_4x4x4_16b_bf16 v[124:127], v[220:221], v[176:177], v[124:127]
    v_mfma_f32_4x4x4_16b_bf16 v[128:131], v[220:221], v[178:179], v[128:131]
    s_waitcnt lgkmcnt(2)
    v_mfma_f32_32x32x16_bf16 v[156:171], v[180:183], v[116:119], v[156:171]
    v_mfma_f32_4x4x4_16b_bf16 v[124:127], v[220:221], v[180:181], v[124:127]
    v_mfma_f32_4x4x4_16b_bf16 v[128:131], v[220:221], v[182:183], v[128:131]
    s_waitcnt lgkmcnt(0)
    v_mfma_f32_32x32x16_bf16 v[156:171], v[184:187], v[120:123], v[156:171]
    v_mfma_f32_4x4x4_16b_bf16 v[124:127], v[220:221], v[184:185], v[124:127]
    v_mfma_f32_4x4x4_16b_bf16 v[128:131], v[220:221], v[186:187], v[128:131]
    s_nop 4
    v_add_f32 v124, v124, v128
    v_mov_b32 v125, v124
    s_nop 1
    v_permlane32_swap_b32 v124, v125
    v_add_f32 v124, v124, v125
    v_cmp_eq_u32 vcc, 0, v3
    v_cvt_pk_bf16_f32 v132, v124, v124
    v_lshlrev_b32 v126, 16, v132
    v_sub_f32 v126, v124, v126
    v_cvt_pk_bf16_f32 v133, v126, v126
    v_and_b32 v133, 0xffff, v133
    v_mov_b32 v134, 0
    v_mov_b32 v135, 0
    v_cndmask_b32 v132, 0, v132, vcc
    v_cndmask_b32 v133, 0, v133, vcc
    v_accvgpr_write_b32 a240, v132
    v_accvgpr_write_b32 a241, v133
    v_accvgpr_write_b32 a242, v134
    v_accvgpr_write_b32 a243, v135
    s_nop 1
    v_mfma_f32_32x32x16_bf16 v[156:171], a[240:243], v[236:239], v[156:171]
    s_waitcnt vmcnt(0)
    s_branch regc_3
regp_2:
    s_add_u32 s50, s50, 1
    s_cmp_gt_u32 s50, 0x40000
    s_cbranch_scc1 regx_4
    s_sleep 16
    buffer_load_dwordx2 v[224:225], v6, s[12:15], s59 offen sc1
    buffer_load_dwordx2 v[226:227], v6, s[12:15], s58 offen sc1
    s_waitcnt vmcnt(0)
regc_3:
    v_sad_u8 v222, v224, 0, 0
    v_sad_u8 v222, v225, 0, v222
    v_sad_u8 v222, v226, 0, v222
    v_sad_u8 v222, v227, 0, v222
    s_nop 0
    v_readfirstlane_b32 s47, v222
    s_nop 0
    s_cmp_ge_u32 s47, 64
    s_cbranch_scc0 regp_2
regx_4:
    v_readfirstlane_b32 s52, v224
    v_readfirstlane_b32 s53, v225
    s_lshl_b32 s40, s57, 3
    s_lshl_b64 s[54:55], 32, s40
    s_cmp_eq_u64 s[52:53], s[54:55]
    s_cselect_b32 s19, 0, 1
    s_cmp_eq_u32 s19, 0
    s_mov_b32 s40, 0x800000
    s_cselect_b32 s87, 0x600000, s40
    s_mov_b32 s40, 0xa00000
    s_cselect_b32 s88, 0x600000, s40
    s_mov_b32 s40, 0xc00000
    s_cselect_b32 s89, 0x600000, s40
    s_mov_b32 s40, 0xe80000
    s_cselect_b32 s90, 0xe00000, s40
    s_mov_b32 s40, 0xf00000
    s_cselect_b32 s91, 0xe00000, s40
    s_mov_b32 s40, 0xf80000
    s_cselect_b32 s92, 0xe00000, s40
    s_mov_b32 s40, 0x1800000
    s_cselect_b32 s93, 0x1800000, s40
    s_mov_b32 s40, 0x1a00000
    s_cselect_b32 s94, 0x1800000, s40
    s_mov_b32 s40, 0x2000000
    s_cselect_b32 s95, 0x2000000, s40
    s_mov_b32 s40, 0x2800000
    s_cselect_b32 s96, 0x2000000, s40
    s_mov_b32 s40, 0x1c00000
    s_cselect_b32 s97, 0x1800000, s40
    s_mov_b32 s40, 0x1e00000
    s_cselect_b32 s98, 0x1800000, s40
    v_and_b32 v11, 128, v252
    buffer_load_dword v9, v11, s[4:7], s45 offen sc1
    s_mov_b32 s46, 0xf149f2ca
    v_mov_b32 v220, s46
    s_cmp_ge_u32 s22, 8
    s_cselect_b32 s47, 0, s46
    v_mov_b32 v248, s47
    v_lshlrev_b32 v245, 2, v3
    v_sub_u32 v245, v2, v245
    v_cmp_le_i32 vcc, 0, v245
    s_nop 1
    v_cndmask_b32_e64 v140, v220, 0, vcc
    v_cndmask_b32 v12, v248, v220, vcc
    v_cmp_le_i32 vcc, 1, v245
    s_nop 1
    v_cndmask_b32_e64 v141, v220, 0, vcc
    v_cndmask_b32 v13, v248, v220, vcc
    v_cmp_le_i32 vcc, 2, v245
    s_nop 1
    v_cndmask_b32_e64 v142, v220, 0, vcc
    v_cndmask_b32 v14, v248, v220, vcc
    v_cmp_le_i32 vcc, 3, v245
    s_nop 1
    v_cndmask_b32_e64 v143, v220, 0, vcc
    v_cndmask_b32 v15, v248, v220, vcc
    v_cmp_le_i32 vcc, 8, v245
    s_nop 1
    v_cndmask_b32_e64 v144, v220, 0, vcc
    v_cndmask_b32 v16, v248, v220, vcc
    v_cmp_le_i32 vcc, 9, v245
    s_nop 1
    v_cndmask_b32_e64 v145, v220, 0, vcc
    v_cndmask_b32 v17, v248, v220, vcc
    v_cmp_le_i32 vcc, 10, v245
    s_nop 1
    v_cndmask_b32_e64 v146, v220, 0, vcc
    v_cndmask_b32 v18, v248, v220, vcc
    v_cmp_le_i32 vcc, 11, v245
    s_nop 1
    v_cndmask_b32_e64 v147, v220, 0, vcc
    v_cndmask_b32 v19, v248, v220, vcc
    v_cmp_le_i32 vcc, 16, v245
    s_nop 1
    v_cndmask_b32_e64 v148, v220, 0, vcc
    v_cndmask_b32 v20, v248, v220, vcc
    v_cmp_le_i32 vcc, 17, v245
    s_nop 1
    v_cndmask_b32_e64 v149, v220, 0, vcc
    v_cndmask_b32 v21, v248, v220, vcc
    v_cmp_le_i32 vcc, 18, v245
    s_nop 1
    v_cndmask_b32_e64 v150, v220, 0, vcc
    v_cndmask_b32 v22, v248, v220, vcc
    v_cmp_le_i32 vcc, 19, v245
    s_nop 1
    v_cndmask_b32_e64 v151, v220, 0, vcc
    v_cndmask_b32 v23, v248, v220, vcc
    v_cmp_le_i32 vcc, 24, v245
    s_nop 1
    v_cndmask_b32_e64 v152, v220, 0, vcc
    v_cndmask_b32 v24, v248, v220, vcc
    v_cmp_le_i32 vcc, 25, v245
    s_nop 1
    v_cndmask_b32_e64 v153, v220, 0, vcc
    v_cndmask_b32 v25, v248, v220, vcc
    v_cmp_le_i32 vcc, 26, v245
    s_nop 1
    v_cndmask_b32_e64 v154, v220, 0, vcc
    v_cndmask_b32 v26, v248, v220, vcc
    v_cmp_le_i32 vcc, 27, v245
    s_nop 1
    v_cndmask_b32_e64 v155, v220, 0, vcc
    v_cndmask_b32 v27, v248, v220, vcc
    s_cmp_lt_i32 s42, 0
    s_cbranch_scc0 hl_6
    v_mov_b32 v172, 0
    v_mov_b32 v173, 0
    v_mov_b32 v174, 0
    v_mov_b32 v175, 0
    v_mov_b32 v176, 0
    v_mov_b32 v177, 0
    v_mov_b32 v178, 0
    v_mov_b32 v179, 0
    v_mov_b32 v180, 0
    v_mov_b32 v181, 0
    v_mov_b32 v182, 0
    v_mov_b32 v183, 0
    v_mov_b32 v184, 0
    v_mov_b32 v185, 0
    v_mov_b32 v186, 0
    v_mov_b32 v187, 0
    v_mov_b32 v188, 0
    v_mov_b32 v189, 0
    v_mov_b32 v190, 0
    v_mov_b32 v191, 0
    v_mov_b32 v192, 0
    v_mov_b32 v193, 0
    v_mov_b32 v194, 0
    v_mov_b32 v195, 0
    v_mov_b32 v196, 0
    v_mov_b32 v197, 0
    v_mov_b32 v198, 0
    v_mov_b32 v199, 0
    v_mov_b32 v200, 0
    v_mov_b32 v201, 0
    v_mov_b32 v202, 0
    v_mov_b32 v203, 0
    s_branch hm_9
hr_8:
    s_add_u32 s50, s50, 1
    s_cmp_gt_u32 s50, 0x40000
    s_cbranch_scc1 hx_10
    buffer_load_dword v9, v11, s[4:7], s45 offen sc1
hl_6:
    s_waitcnt vmcnt(0)
    v_cmp_eq_u32 vcc, 1, v9
    s_nop 0
    s_cmp_eq_u64 vcc, -1
    s_cbranch_scc0 hr_8
hx_10:
    buffer_load_dwordx4 v[172:175], v1, s[4:7], s43 offen offset:0 sc1
    buffer_load_dwordx4 v[176:179], v1, s[4:7], s43 offen offset:1024 sc1
    buffer_load_dwordx4 v[180:183], v1, s[4:7], s43 offen offset:2048 sc1
    buffer_load_dwordx4 v[184:187], v1, s[4:7], s43 offen offset:3072 sc1
    buffer_load_dwordx4 v[188:191], v1, s[4:7], s44 offen offset:0 sc1
    buffer_load_dwordx4 v[192:195], v1, s[4:7], s44 offen offset:1024 sc1
    buffer_load_dwordx4 v[196:199], v1, s[4:7], s44 offen offset:2048 sc1
    buffer_load_dwordx4 v[200:203], v1, s[4:7], s44 offen offset:3072 sc1
hm_9:
    s_cmp_ge_u32 s22, 8
    s_cbranch_scc1 mski_5
    s_cmp_ge_u32 s22, 7
    s_cselect_b32 s47, 0, s46
    v_mov_b32 v28, s47
    v_mov_b32 v29, s47
    v_mov_b32 v30, s47
    v_mov_b32 v31, s47
    v_mov_b32 v32, s47
    v_mov_b32 v33, s47
    v_mov_b32 v34, s47
    v_mov_b32 v35, s47
    v_mov_b32 v36, s47
    v_mov_b32 v37, s47
    v_mov_b32 v38, s47
    v_mov_b32 v39, s47
    v_mov_b32 v40, s47
    v_mov_b32 v41, s47
    v_mov_b32 v42, s47
    v_mov_b32 v43, s47
    s_cmp_ge_u32 s22, 6
    s_cselect_b32 s47, 0, s46
    v_mov_b32 v44, s47
    v_mov_b32 v45, s47
    v_mov_b32 v46, s47
    v_mov_b32 v47, s47
    v_mov_b32 v48, s47
    v_mov_b32 v49, s47
    v_mov_b32 v50, s47
    v_mov_b32 v51, s47
    v_mov_b32 v52, s47
    v_mov_b32 v53, s47
    v_mov_b32 v54, s47
    v_mov_b32 v55, s47
    v_mov_b32 v56, s47
    v_mov_b32 v57, s47
    v_mov_b32 v58, s47
    v_mov_b32 v59, s47
    s_cmp_ge_u32 s22, 5
    s_cselect_b32 s47, 0, s46
    v_mov_b32 v60, s47
    v_mov_b32 v61, s47
    v_mov_b32 v62, s47
    v_mov_b32 v63, s47
    v_mov_b32 v64, s47
    v_mov_b32 v65, s47
    v_mov_b32 v66, s47
    v_mov_b32 v67, s47
    v_mov_b32 v68, s47
    v_mov_b32 v69, s47
    v_mov_b32 v70, s47
    v_mov_b32 v71, s47
    v_mov_b32 v72, s47
    v_mov_b32 v73, s47
    v_mov_b32 v74, s47
    v_mov_b32 v75, s47
    s_cmp_ge_u32 s22, 4
    s_cselect_b32 s47, 0, s46
    v_mov_b32 v76, s47
    v_mov_b32 v77, s47
    v_mov_b32 v78, s47
    v_mov_b32 v79, s47
    v_mov_b32 v80, s47
    v_mov_b32 v81, s47
    v_mov_b32 v82, s47
    v_mov_b32 v83, s47
    v_mov_b32 v84, s47
    v_mov_b32 v85, s47
    v_mov_b32 v86, s47
    v_mov_b32 v87, s47
    v_mov_b32 v88, s47
    v_mov_b32 v89, s47
    v_mov_b32 v90, s47
    v_mov_b32 v91, s47
    s_cmp_ge_u32 s22, 3
    s_cselect_b32 s47, 0, s46
    v_mov_b32 v92, s47
    v_mov_b32 v93, s47
    v_mov_b32 v94, s47
    v_mov_b32 v95, s47
    v_mov_b32 v96, s47
    v_mov_b32 v97, s47
    v_mov_b32 v98, s47
    v_mov_b32 v99, s47
    v_mov_b32 v100, s47
    v_mov_b32 v101, s47
    v_mov_b32 v102, s47
    v_mov_b32 v103, s47
    v_mov_b32 v104, s47
    v_mov_b32 v105, s47
    v_mov_b32 v106, s47
    v_mov_b32 v107, s47
    s_cmp_ge_u32 s22, 2
    s_cselect_b32 s47, 0, s46
    v_mov_b32 v108, s47
    v_mov_b32 v109, s47
    v_mov_b32 v110, s47
    v_mov_b32 v111, s47
    v_mov_b32 v112, s47
    v_mov_b32 v113, s47
    v_mov_b32 v114, s47
    v_mov_b32 v115, s47
    v_mov_b32 v116, s47
    v_mov_b32 v117, s47
    v_mov_b32 v118, s47
    v_mov_b32 v119, s47
    v_mov_b32 v120, s47
    v_mov_b32 v121, s47
    v_mov_b32 v122, s47
    v_mov_b32 v123, s47
    s_cmp_ge_u32 s22, 1
    s_cselect_b32 s47, 0, s46
    v_mov_b32 v124, s47
    v_mov_b32 v125, s47
    v_mov_b32 v126, s47
    v_mov_b32 v127, s47
    v_mov_b32 v128, s47
    v_mov_b32 v129, s47
    v_mov_b32 v130, s47
    v_mov_b32 v131, s47
    v_mov_b32 v132, s47
    v_mov_b32 v133, s47
    v_mov_b32 v134, s47
    v_mov_b32 v135, s47
    v_mov_b32 v136, s47
    v_mov_b32 v137, s47
    v_mov_b32 v138, s47
    v_mov_b32 v139, s47
mski_5:
    v_cmp_eq_u32 vcc, 0, v3
    v_mov_b32 v209, 0x3f803f80
    v_mov_b32 v206, 0
    v_mov_b32 v207, 0
    v_cndmask_b32 v208, 0, v209, vcc
    v_mov_b32 v209, 0x3f80
    v_mov_b32 v210, 0
    v_mov_b32 v211, 0
    v_cndmask_b32 v209, 0, v209, vcc
    v_mul_f32 v156, v246, v156
    v_mul_f32 v157, v246, v157
    v_mul_f32 v158, v246, v158
    v_mul_f32 v159, v246, v159
    v_mul_f32 v160, v246, v160
    v_mul_f32 v161, v246, v161
    v_mul_f32 v162, v246, v162
    v_mul_f32 v163, v246, v163
    v_mul_f32 v164, v246, v164
    v_mul_f32 v165, v246, v165
    v_mul_f32 v166, v246, v166
    v_mul_f32 v167, v246, v167
    v_mul_f32 v168, v247, v168
    v_mul_f32 v169, v247, v169
    v_mul_f32 v170, v247, v170
    v_mul_f32 v171, v247, v171
    v_cvt_pk_bf16_f32 v236, v156, v157
    v_cvt_pk_bf16_f32 v237, v158, v159
    v_cvt_pk_bf16_f32 v238, v160, v161
    v_cvt_pk_bf16_f32 v239, v162, v163
    v_cvt_pk_bf16_f32 v240, v164, v165
    v_cvt_pk_bf16_f32 v241, v166, v167
    v_cvt_pk_bf16_f32 v242, v168, v169
    v_cvt_pk_bf16_f32 v243, v170, v171
    v_mfma_f32_32x32x16_bf16 v[140:155], v[212:215], v[236:239], v[140:155]
    s_nop 0
    v_mfma_f32_32x32x16_bf16 v[140:155], v[216:219], v[240:243], v[140:155]
    v_bfe_u32 v251, v0, 2, 3
    v_mul_u32_u24 v251, 3584, v251
    v_and_b32 v11, 3, v0
    v_lshl_add_u32 v251, v11, 4, v251
    v_lshl_add_u32 v251, v3, 6, v251
    s_mov_b32 s26, s1
    s_waitcnt vmcnt(0)
hd_7:
    s_lshl_b32 s42, s3, 13
    s_add_u32 s42, s42, 86016
    v_add_u32 v249, s42, v1
    ds_write_b128 v249, v[172:175] offset:0
    ds_write_b128 v249, v[176:179] offset:1024
    ds_write_b128 v249, v[180:183] offset:2048
    ds_write_b128 v249, v[184:187] offset:3072
    ds_write_b128 v249, v[188:191] offset:4096
    ds_write_b128 v249, v[192:195] offset:5120
    ds_write_b128 v249, v[196:199] offset:6144
    ds_write_b128 v249, v[200:203] offset:7168
    s_lshl_b32 s42, s3, 12
    s_add_u32 s42, s42, 86016
    v_add_u32 v250, s42, v1
    v_max_f32 v244, v140, v141
    v_max3_f32 v244, v142, v143, v244
    v_max3_f32 v244, v144, v145, v244
    v_max3_f32 v244, v146, v147, v244
    v_max3_f32 v244, v148, v149, v244
    v_max3_f32 v244, v150, v151, v244
    v_max3_f32 v244, v152, v153, v244
    v_max3_f32 v244, v154, v155, v244
    s_waitcnt lgkmcnt(0)
    s_barrier
    v_and_b32 v11, 15, v0
    v_lshlrev_b32 v11, 13, v11
    s_add_u32 s49, s72, s93
    buffer_load_dword v9, v252, s[4:7], s49 offen sc1
    s_add_u32 s49, s67, 0
    buffer_load_dword v9, v11, s[4:7], s49 offen sc1
    s_cmp_ge_u32 s22, 8
    s_cbranch_scc0 qks_11
    ds_read_b128 v[172:175], v250 offset:0
    ds_read_b128 v[176:179], v250 offset:1024
    ds_read_b128 v[180:183], v250 offset:4096
    ds_read_b128 v[184:187], v250 offset:5120
    ds_read_b128 v[188:191], v250 offset:8192
    ds_read_b128 v[192:195], v250 offset:9216
    ds_read_b128 v[196:199], v250 offset:12288
    ds_read_b128 v[200:203], v250 offset:13312
    s_waitcnt lgkmcnt(6)
    v_mfma_f32_32x32x16_bf16 v[12:27], v[172:175], v[236:239], v[12:27]
    v_mfma_f32_32x32x16_bf16 v[12:27], v[176:179], v[240:243], v[12:27]
    ds_read_b128 v[172:175], v250 offset:16384
    ds_read_b128 v[176:179], v250 offset:17408
    s_waitcnt lgkmcnt(6)
    v_mfma_f32_32x32x16_bf16 v[28:43], v[180:183], v[236:239], 0
    v_mfma_f32_32x32x16_bf16 v[28:43], v[184:187], v[240:243], v[28:43]
    ds_read_b128 v[180:183], v250 offset:20480
    ds_read_b128 v[184:187], v250 offset:21504
    s_waitcnt lgkmcnt(6)
    v_mfma_f32_32x32x16_bf16 v[44:59], v[188:191], v[236:239], 0
    v_mfma_f32_32x32x16_bf16 v[44:59], v[192:195], v[240:243], v[44:59]
    s_nop 1
    v_max3_f32 v244, v12, v13, v244
    v_max3_f32 v244, v14, v15, v244
    v_max3_f32 v244, v16, v17, v244
    v_max3_f32 v244, v18, v19, v244
    v_max3_f32 v244, v20, v21, v244
    v_max3_f32 v244, v22, v23, v244
    v_max3_f32 v244, v24, v25, v244
    v_max3_f32 v244, v26, v27, v244
    ds_read_b128 v[188:191], v250 offset:24576
    ds_read_b128 v[192:195], v250 offset:25600
    s_waitcnt lgkmcnt(6)
    v_mfma_f32_32x32x16_bf16 v[60:75], v[196:199], v[236:239], 0
    v_mfma_f32_32x32x16_bf16 v[60:75], v[200:203], v[240:243], v[60:75]
    v_max3_f32 v244, v28, v29, v244
    v_max3_f32 v244, v30, v31, v244
    v_max3_f32 v244, v32, v33, v244
    v_max3_f32 v244, v34, v35, v244
    v_max3_f32 v244, v36, v37, v244
    v_max3_f32 v244, v38, v39, v244
    v_max3_f32 v244, v40, v41, v244
    v_max3_f32 v244, v42, v43, v244
    ds_read_b128 v[196:199], v250 offset:28672
    ds_read_b128 v[200:203], v250 offset:29696
    s_waitcnt lgkmcnt(6)
    v_mfma_f32_32x32x16_bf16 v[76:91], v[172:175], v[236:239], 0
    v_mfma_f32_32x32x16_bf16 v[76:91], v[176:179], v[240:243], v[76:91]
    v_max3_f32 v244, v44, v45, v244
    v_max3_f32 v244, v46, v47, v244
    v_max3_f32 v244, v48, v49, v244
    v_max3_f32 v244, v50, v51, v244
    v_max3_f32 v244, v52, v53, v244
    v_max3_f32 v244, v54, v55, v244
    v_max3_f32 v244, v56, v57, v244
    v_max3_f32 v244, v58, v59, v244
    s_waitcnt lgkmcnt(4)
    v_mfma_f32_32x32x16_bf16 v[92:107], v[180:183], v[236:239], 0
    v_mfma_f32_32x32x16_bf16 v[92:107], v[184:187], v[240:243], v[92:107]
    v_max3_f32 v244, v60, v61, v244
    v_max3_f32 v244, v62, v63, v244
    v_max3_f32 v244, v64, v65, v244
    v_max3_f32 v244, v66, v67, v244
    v_max3_f32 v244, v68, v69, v244
    v_max3_f32 v244, v70, v71, v244
    v_max3_f32 v244, v72, v73, v244
    v_max3_f32 v244, v74, v75, v244
    s_waitcnt lgkmcnt(2)
    v_mfma_f32_32x32x16_bf16 v[108:123], v[188:191], v[236:239], 0
    v_mfma_f32_32x32x16_bf16 v[108:123], v[192:195], v[240:243], v[108:123]
    v_max3_f32 v244, v76, v77, v244
    v_max3_f32 v244, v78, v79, v244
    v_max3_f32 v244, v80, v81, v244
    v_max3_f32 v244, v82, v83, v244
    v_max3_f32 v244, v84, v85, v244
    v_max3_f32 v244, v86, v87, v244
    v_max3_f32 v244, v88, v89, v244
    v_max3_f32 v244, v90, v91, v244
    s_waitcnt lgkmcnt(0)
    v_mfma_f32_32x32x16_bf16 v[124:139], v[196:199], v[236:239], 0
    v_mfma_f32_32x32x16_bf16 v[124:139], v[200:203], v[240:243], v[124:139]
    v_max3_f32 v244, v92, v93, v244
    v_max3_f32 v244, v94, v95, v244
    v_max3_f32 v244, v96, v97, v244
    v_max3_f32 v244, v98, v99, v244
    v_max3_f32 v244, v100, v101, v244
    v_max3_f32 v244, v102, v103, v244
    v_max3_f32 v244, v104, v105, v244
    v_max3_f32 v244, v106, v107, v244
    s_branch qkd_12
qks_11:
    ds_read_b128 v[172:175], v250 offset:0
    ds_read_b128 v[176:179], v250 offset:1024
    ds_read_b128 v[180:183], v250 offset:4096
    ds_read_b128 v[184:187], v250 offset:5120
    ds_read_b128 v[188:191], v250 offset:8192
    ds_read_b128 v[192:195], v250 offset:9216
    ds_read_b128 v[196:199], v250 offset:12288
    ds_read_b128 v[200:203], v250 offset:13312
    s_waitcnt lgkmcnt(6)
    v_mfma_f32_32x32x16_bf16 v[12:27], v[172:175], v[236:239], v[12:27]
    v_mfma_f32_32x32x16_bf16 v[12:27], v[176:179], v[240:243], v[12:27]
    ds_read_b128 v[172:175], v250 offset:16384
    ds_read_b128 v[176:179], v250 offset:17408
    s_waitcnt lgkmcnt(6)
    v_mfma_f32_32x32x16_bf16 v[28:43], v[180:183], v[236:239], v[28:43]
    v_mfma_f32_32x32x16_bf16 v[28:43], v[184:187], v[240:243], v[28:43]
    ds_read_b128 v[180:183], v250 offset:20480
    ds_read_b128 v[184:187], v250 offset:21504
    s_waitcnt lgkmcnt(6)
    v_mfma_f32_32x32x16_bf16 v[44:59], v[188:191], v[236:239], v[44:59]
    v_mfma_f32_32x32x16_bf16 v[44:59], v[192:195], v[240:243], v[44:59]
    s_nop 1
    v_max3_f32 v244, v12, v13, v244
    v_max3_f32 v244, v14, v15, v244
    v_max3_f32 v244, v16, v17, v244
    v_max3_f32 v244, v18, v19, v244
    v_max3_f32 v244, v20, v21, v244
    v_max3_f32 v244, v22, v23, v244
    v_max3_f32 v244, v24, v25, v244
    v_max3_f32 v244, v26, v27, v244
    ds_read_b128 v[188:191], v250 offset:24576
    ds_read_b128 v[192:195], v250 offset:25600
    s_waitcnt lgkmcnt(6)
    v_mfma_f32_32x32x16_bf16 v[60:75], v[196:199], v[236:239], v[60:75]
    v_mfma_f32_32x32x16_bf16 v[60:75], v[200:203], v[240:243], v[60:75]
    v_max3_f32 v244, v28, v29, v244
    v_max3_f32 v244, v30, v31, v244
    v_max3_f32 v244, v32, v33, v244
    v_max3_f32 v244, v34, v35, v244
    v_max3_f32 v244, v36, v37, v244
    v_max3_f32 v244, v38, v39, v244
    v_max3_f32 v244, v40, v41, v244
    v_max3_f32 v244, v42, v43, v244
    ds_read_b128 v[196:199], v250 offset:28672
    ds_read_b128 v[200:203], v250 offset:29696
    s_waitcnt lgkmcnt(6)
    v_mfma_f32_32x32x16_bf16 v[76:91], v[172:175], v[236:239], v[76:91]
    v_mfma_f32_32x32x16_bf16 v[76:91], v[176:179], v[240:243], v[76:91]
    v_max3_f32 v244, v44, v45, v244
    v_max3_f32 v244, v46, v47, v244
    v_max3_f32 v244, v48, v49, v244
    v_max3_f32 v244, v50, v51, v244
    v_max3_f32 v244, v52, v53, v244
    v_max3_f32 v244, v54, v55, v244
    v_max3_f32 v244, v56, v57, v244
    v_max3_f32 v244, v58, v59, v244
    s_waitcnt lgkmcnt(4)
    v_mfma_f32_32x32x16_bf16 v[92:107], v[180:183], v[236:239], v[92:107]
    v_mfma_f32_32x32x16_bf16 v[92:107], v[184:187], v[240:243], v[92:107]
    v_max3_f32 v244, v60, v61, v244
    v_max3_f32 v244, v62, v63, v244
    v_max3_f32 v244, v64, v65, v244
    v_max3_f32 v244, v66, v67, v244
    v_max3_f32 v244, v68, v69, v244
    v_max3_f32 v244, v70, v71, v244
    v_max3_f32 v244, v72, v73, v244
    v_max3_f32 v244, v74, v75, v244
    s_waitcnt lgkmcnt(2)
    v_mfma_f32_32x32x16_bf16 v[108:123], v[188:191], v[236:239], v[108:123]
    v_mfma_f32_32x32x16_bf16 v[108:123], v[192:195], v[240:243], v[108:123]
    v_max3_f32 v244, v76, v77, v244
    v_max3_f32 v244, v78, v79, v244
    v_max3_f32 v244, v80, v81, v244
    v_max3_f32 v244, v82, v83, v244
    v_max3_f32 v244, v84, v85, v244
    v_max3_f32 v244, v86, v87, v244
    v_max3_f32 v244, v88, v89, v244
    v_max3_f32 v244, v90, v91, v244
    s_waitcnt lgkmcnt(0)
    v_mfma_f32_32x32x16_bf16 v[124:139], v[196:199], v[236:239], v[124:139]
    v_mfma_f32_32x32x16_bf16 v[124:139], v[200:203], v[240:243], v[124:139]
    v_max3_f32 v244, v92, v93, v244
    v_max3_f32 v244, v94, v95, v244
    v_max3_f32 v244, v96, v97, v244
    v_max3_f32 v244, v98, v99, v244
    v_max3_f32 v244, v100, v101, v244
    v_max3_f32 v244, v102, v103, v244
    v_max3_f32 v244, v104, v105, v244
    v_max3_f32 v244, v106, v107, v244
qkd_12:
    ds_read_b128 v[172:175], v250 offset:2048
    ds_read_b128 v[176:179], v250 offset:3072
    ds_read_b128 v[180:183], v250 offset:6144
    ds_read_b128 v[184:187], v250 offset:7168
    ds_read_b128 v[188:191], v250 offset:10240
    ds_read_b128 v[192:195], v250 offset:11264
    v_max3_f32 v244, v108, v109, v244
    v_max3_f32 v244, v110, v111, v244
    v_max3_f32 v244, v112, v113, v244
    v_max3_f32 v244, v114, v115, v244
    s_add_u32 s49, s70, s87
    buffer_load_dword v9, v252, s[4:7], s49 offen sc1
    v_max3_f32 v244, v116, v117, v244
    v_max3_f32 v244, v118, v119, v244
    v_max3_f32 v244, v120, v121, v244
    v_max3_f32 v244, v122, v123, v244
    v_max3_f32 v244, v124, v125, v244
    v_max3_f32 v244, v126, v127, v244
    v_max3_f32 v244, v128, v129, v244
    v_max3_f32 v244, v130, v131, v244
    v_max3_f32 v244, v132, v133, v244
    v_max3_f32 v244, v134, v135, v244
    v_and_b32 v11, 128, v252
    s_add_u32 s49, s71, s90
    buffer_load_dword v9, v11, s[4:7], s49 offen sc1
    v_max3_f32 v244, v136, v137, v244
    v_max3_f32 v244, v138, v139, v244
    v_mov_b32 v245, v244
    s_nop 1
    v_permlane32_swap_b32 v244, v245
    v_max_f32 v244, v244, v245
    v_sub_f32 v244, 0, v244
    v_and_b32 v245, 0xffff0000, v244
    v_sub_f32 v244, v244, v245
    v_and_b32 v249, 0xffff0000, v244
    v_sub_f32 v244, v244, v249
    s_add_u32 s40, s68, 0
    s_add_u32 m0, s0, 0
    s_nop 0
    buffer_load_dwordx4 v251, s[24:27], s40 offen lds
    v_lshrrev_b32 v245, 16, v245
    v_or_b32 v204, v245, v249
    v_lshrrev_b32 v205, 16, v244
    s_nop 1
    v_mfma_f32_32x32x16_bf16 v[140:155], v[208:211], v[204:207], v[140:155]
    v_mfma_f32_32x32x16_bf16 v[12:27], v[208:211], v[204:207], v[12:27]
    s_nop 10
    v_exp_f32 v140, v140
    v_exp_f32 v141, v141
    v_exp_f32 v142, v142
    v_exp_f32 v143, v143
    v_exp_f32 v144, v144
    s_add_u32 s40, s68, 114688
    s_add_u32 m0, s0, 4096
    s_nop 0
    buffer_load_dwordx4 v251, s[24:27], s40 offen lds
    v_exp_f32 v145, v145
    v_exp_f32 v146, v146
    v_exp_f32 v147, v147
    v_mfma_f32_32x32x16_bf16 v[28:43], v[208:211], v[204:207], v[28:43]
    v_exp_f32 v148, v148
    v_exp_f32 v149, v149
    v_exp_f32 v150, v150
    v_exp_f32 v151, v151
    v_cvt_pk_bf16_f32 v140, v140, v141
    v_cvt_pk_bf16_f32 v141, v142, v143
    s_add_u32 s40, s68, 229376
    s_add_u32 m0, s0, 8192
    s_nop 0
    buffer_load_dwordx4 v251, s[24:27], s40 offen lds
    v_cvt_pk_bf16_f32 v142, v144, v145
    v_cvt_pk_bf16_f32 v143, v146, v147
    v_exp_f32 v152, v152
    v_exp_f32 v153, v153
    v_exp_f32 v154, v154
    v_exp_f32 v155, v155
    v_mfma_f32_32x32x16_bf16 v[156:171], v[228:231], v[140:143], 0
    v_cvt_pk_bf16_f32 v144, v148, v149
    v_cvt_pk_bf16_f32 v145, v150, v151
    v_cvt_pk_bf16_f32 v146, v152, v153
    s_add_u32 s40, s68, 344064
    s_add_u32 m0, s0, 12288
    s_nop 0
    buffer_load_dwordx4 v251, s[24:27], s40 offen lds
    v_cvt_pk_bf16_f32 v147, v154, v155
    s_nop 1
    v_mfma_f32_32x32x16_bf16 v[156:171], v[232:235], v[144:147], v[156:171]
    v_exp_f32 v12, v12
    v_exp_f32 v13, v13
    v_exp_f32 v14, v14
    v_exp_f32 v15, v15
    v_exp_f32 v16, v16
    v_exp_f32 v17, v17
    v_exp_f32 v18, v18
    v_exp_f32 v19, v19
    s_add_u32 s40, s68, 458752
    s_add_u32 m0, s0, 16384
    s_nop 0
    buffer_load_dwordx4 v251, s[24:27], s40 offen lds
    v_mfma_f32_32x32x16_bf16 v[44:59], v[208:211], v[204:207], v[44:59]
    v_exp_f32 v20, v20
    v_exp_f32 v21, v21
    v_exp_f32 v22, v22
    v_exp_f32 v23, v23
    v_cvt_pk_bf16_f32 v12, v12, v13
    v_cvt_pk_bf16_f32 v13, v14, v15
    v_cvt_pk_bf16_f32 v14, v16, v17
    v_cvt_pk_bf16_f32 v15, v18, v19
    v_exp_f32 v24, v24
    s_add_u32 s40, s68, 573440
    s_add_u32 m0, s0, 20480
    s_nop 0
    buffer_load_dwordx4 v251, s[24:27], s40 offen lds
    v_exp_f32 v25, v25
    v_exp_f32 v26, v26
    v_exp_f32 v27, v27
    s_waitcnt lgkmcnt(4)
    v_mfma_f32_32x32x16_bf16 v[156:171], v[172:175], v[12:15], v[156:171]
    v_cvt_pk_bf16_f32 v16, v20, v21
    v_cvt_pk_bf16_f32 v17, v22, v23
    v_cvt_pk_bf16_f32 v18, v24, v25
    v_cvt_pk_bf16_f32 v19, v26, v27
    s_nop 1
    v_mfma_f32_32x32x16_bf16 v[156:171], v[176:179], v[16:19], v[156:171]
    s_add_u32 s40, s68, 688128
    s_add_u32 m0, s0, 24576
    s_nop 0
    buffer_load_dwordx4 v251, s[24:27], s40 offen lds
    ds_read_b128 v[196:199], v250 offset:14336
    ds_read_b128 v[200:203], v250 offset:15360
    v_exp_f32 v28, v28
    v_exp_f32 v29, v29
    v_exp_f32 v30, v30
    v_exp_f32 v31, v31
    v_exp_f32 v32, v32
    v_exp_f32 v33, v33
    v_exp_f32 v34, v34
    v_exp_f32 v35, v35
    s_add_u32 s40, s68, 802816
    s_add_u32 m0, s0, 28672
    s_nop 0
    buffer_load_dwordx4 v251, s[24:27], s40 offen lds
    v_mfma_f32_32x32x16_bf16 v[60:75], v[208:211], v[204:207], v[60:75]
    v_exp_f32 v36, v36
    v_exp_f32 v37, v37
    v_exp_f32 v38, v38
    v_exp_f32 v39, v39
    v_cvt_pk_bf16_f32 v28, v28, v29
    v_cvt_pk_bf16_f32 v29, v30, v31
    v_cvt_pk_bf16_f32 v30, v32, v33
    v_cvt_pk_bf16_f32 v31, v34, v35
    v_exp_f32 v40, v40
    s_add_u32 s40, s68, 917504
    s_add_u32 m0, s0, 32768
    s_nop 0
    buffer_load_dwordx4 v251, s[24:27], s40 offen lds
    v_exp_f32 v41, v41
    v_exp_f32 v42, v42
    v_exp_f32 v43, v43
    s_waitcnt lgkmcnt(4)
    v_mfma_f32_32x32x16_bf16 v[156:171], v[180:183], v[28:31], v[156:171]
    v_cvt_pk_bf16_f32 v32, v36, v37
    v_cvt_pk_bf16_f32 v33, v38, v39
    v_cvt_pk_bf16_f32 v34, v40, v41
    v_cvt_pk_bf16_f32 v35, v42, v43
    s_nop 1
    v_mfma_f32_32x32x16_bf16 v[156:171], v[184:187], v[32:35], v[156:171]
    s_add_u32 s40, s68, 1032192
    s_add_u32 m0, s0, 36864
    s_nop 0
    buffer_load_dwordx4 v251, s[24:27], s40 offen lds
    ds_read_b128 v[172:175], v250 offset:18432
    ds_read_b128 v[176:179], v250 offset:19456
    v_exp_f32 v44, v44
    v_exp_f32 v45, v45
    v_exp_f32 v46, v46
    v_exp_f32 v47, v47
    v_exp_f32 v48, v48
    v_exp_f32 v49, v49
    v_exp_f32 v50, v50
    v_exp_f32 v51, v51
    s_add_u32 s40, s68, 1146880
    s_add_u32 m0, s0, 40960
    s_nop 0
    buffer_load_dwordx4 v251, s[24:27], s40 offen lds
    v_mfma_f32_32x32x16_bf16 v[76:91], v[208:211], v[204:207], v[76:91]
    v_exp_f32 v52, v52
    v_exp_f32 v53, v53
    v_exp_f32 v54, v54
    v_exp_f32 v55, v55
    v_cvt_pk_bf16_f32 v44, v44, v45
    v_cvt_pk_bf16_f32 v45, v46, v47
    v_cvt_pk_bf16_f32 v46, v48, v49
    v_cvt_pk_bf16_f32 v47, v50, v51
    v_exp_f32 v56, v56
    s_add_u32 s40, s68, 1261568
    s_add_u32 m0, s0, 45056
    s_nop 0
    buffer_load_dwordx4 v251, s[24:27], s40 offen lds
    v_exp_f32 v57, v57
    v_exp_f32 v58, v58
    v_exp_f32 v59, v59
    s_waitcnt lgkmcnt(4)
    v_mfma_f32_32x32x16_bf16 v[156:171], v[188:191], v[44:47], v[156:171]
    v_cvt_pk_bf16_f32 v48, v52, v53
    v_cvt_pk_bf16_f32 v49, v54, v55
    v_cvt_pk_bf16_f32 v50, v56, v57
    v_cvt_pk_bf16_f32 v51, v58, v59
    s_nop 1
    v_mfma_f32_32x32x16_bf16 v[156:171], v[192:195], v[48:51], v[156:171]
    s_add_u32 s40, s68, 1376256
    s_add_u32 m0, s0, 49152
    s_nop 0
    buffer_load_dwordx4 v251, s[24:27], s40 offen lds
    ds_read_b128 v[180:183], v250 offset:22528
    ds_read_b128 v[184:187], v250 offset:23552
    v_exp_f32 v60, v60
    v_exp_f32 v61, v61
    v_exp_f32 v62, v62
    v_exp_f32 v63, v63
    v_exp_f32 v64, v64
    v_exp_f32 v65, v65
    v_exp_f32 v66, v66
    v_exp_f32 v67, v67
    s_add_u32 s40, s68, 1490944
    s_add_u32 m0, s0, 53248
    s_nop 0
    buffer_load_dwordx4 v251, s[24:27], s40 offen lds
    v_mfma_f32_32x32x16_bf16 v[92:107], v[208:211], v[204:207], v[92:107]
    v_exp_f32 v68, v68
    v_exp_f32 v69, v69
    v_exp_f32 v70, v70
    v_exp_f32 v71, v71
    v_cvt_pk_bf16_f32 v60, v60, v61
    v_cvt_pk_bf16_f32 v61, v62, v63
    v_cvt_pk_bf16_f32 v62, v64, v65
    v_cvt_pk_bf16_f32 v63, v66, v67
    v_exp_f32 v72, v72
    s_add_u32 s40, s68, 128
    s_add_u32 m0, s0, 57344
    s_nop 0
    buffer_load_dwordx4 v251, s[24:27], s40 offen lds
    v_exp_f32 v73, v73
    v_exp_f32 v74, v74
    v_exp_f32 v75, v75
    s_waitcnt lgkmcnt(4)
    v_mfma_f32_32x32x16_bf16 v[156:171], v[196:199], v[60:63], v[156:171]
    v_cvt_pk_bf16_f32 v64, v68, v69
    v_cvt_pk_bf16_f32 v65, v70, v71
    v_cvt_pk_bf16_f32 v66, v72, v73
    v_cvt_pk_bf16_f32 v67, v74, v75
    s_nop 1
    v_mfma_f32_32x32x16_bf16 v[156:171], v[200:203], v[64:67], v[156:171]
    s_add_u32 s40, s68, 114816
    s_add_u32 m0, s0, 61440
    s_nop 0
    buffer_load_dwordx4 v251, s[24:27], s40 offen lds
    ds_read_b128 v[188:191], v250 offset:26624
    ds_read_b128 v[192:195], v250 offset:27648
    v_exp_f32 v76, v76
    v_exp_f32 v77, v77
    v_exp_f32 v78, v78
    v_exp_f32 v79, v79
    v_exp_f32 v80, v80
    v_exp_f32 v81, v81
    v_exp_f32 v82, v82
    v_exp_f32 v83, v83
    s_add_u32 s40, s68, 229504
    s_add_u32 m0, s0, 65536
    s_nop 0
    buffer_load_dwordx4 v251, s[24:27], s40 offen lds
    v_mfma_f32_32x32x16_bf16 v[108:123], v[208:211], v[204:207], v[108:123]
    v_exp_f32 v84, v84
    v_exp_f32 v85, v85
    v_exp_f32 v86, v86
    v_exp_f32 v87, v87
    v_cvt_pk_bf16_f32 v76, v76, v77
    v_cvt_pk_bf16_f32 v77, v78, v79
    v_cvt_pk_bf16_f32 v78, v80, v81
    v_cvt_pk_bf16_f32 v79, v82, v83
    v_exp_f32 v88, v88
    s_add_u32 s40, s68, 344192
    s_add_u32 m0, s0, 69632
    s_nop 0
    buffer_load_dwordx4 v251, s[24:27], s40 offen lds
    v_exp_f32 v89, v89
    v_exp_f32 v90, v90
    v_exp_f32 v91, v91
    s_waitcnt lgkmcnt(4)
    v_mfma_f32_32x32x16_bf16 v[156:171], v[172:175], v[76:79], v[156:171]
    v_cvt_pk_bf16_f32 v80, v84, v85
    v_cvt_pk_bf16_f32 v81, v86, v87
    v_cvt_pk_bf16_f32 v82, v88, v89
    v_cvt_pk_bf16_f32 v83, v90, v91
    s_nop 1
    v_mfma_f32_32x32x16_bf16 v[156:171], v[176:179], v[80:83], v[156:171]
    s_add_u32 s40, s68, 458880
    s_add_u32 m0, s0, 73728
    s_nop 0
    buffer_load_dwordx4 v251, s[24:27], s40 offen lds
    ds_read_b128 v[196:199], v250 offset:30720
    ds_read_b128 v[200:203], v250 offset:31744
    v_exp_f32 v92, v92
    v_exp_f32 v93, v93
    v_exp_f32 v94, v94
    v_exp_f32 v95, v95
    v_exp_f32 v96, v96
    v_exp_f32 v97, v97
    v_exp_f32 v98, v98
    v_exp_f32 v99, v99
    s_add_u32 s40, s68, 573568
    s_add_u32 m0, s0, 77824
    s_nop 0
    buffer_load_dwordx4 v251, s[24:27], s40 offen lds
    v_mfma_f32_32x32x16_bf16 v[124:139], v[208:211], v[204:207], v[124:139]
    v_exp_f32 v100, v100
    v_exp_f32 v101, v101
    v_exp_f32 v102, v102
    v_exp_f32 v103, v103
    v_cvt_pk_bf16_f32 v92, v92, v93
    v_cvt_pk_bf16_f32 v93, v94, v95
    v_cvt_pk_bf16_f32 v94, v96, v97
    v_cvt_pk_bf16_f32 v95, v98, v99
    v_exp_f32 v104, v104
    s_add_u32 s40, s68, 688256
    s_add_u32 m0, s0, 81920
    s_nop 0
    buffer_load_dwordx4 v251, s[24:27], s40 offen lds
    v_exp_f32 v105, v105
    v_exp_f32 v106, v106
    v_exp_f32 v107, v107
    s_waitcnt lgkmcnt(4)
    v_mfma_f32_32x32x16_bf16 v[156:171], v[180:183], v[92:95], v[156:171]
    v_cvt_pk_bf16_f32 v96, v100, v101
    v_cvt_pk_bf16_f32 v97, v102, v103
    v_cvt_pk_bf16_f32 v98, v104, v105
    v_cvt_pk_bf16_f32 v99, v106, v107
    s_nop 1
    v_mfma_f32_32x32x16_bf16 v[156:171], v[184:187], v[96:99], v[156:171]
    v_exp_f32 v108, v108
    v_exp_f32 v109, v109
    v_exp_f32 v110, v110
    v_exp_f32 v111, v111
    v_exp_f32 v112, v112
    v_exp_f32 v113, v113
    v_exp_f32 v114, v114
    v_exp_f32 v115, v115
    v_exp_f32 v116, v116
    v_exp_f32 v117, v117
    v_exp_f32 v118, v118
    v_exp_f32 v119, v119
    v_cvt_pk_bf16_f32 v108, v108, v109
    v_cvt_pk_bf16_f32 v109, v110, v111
    v_cvt_pk_bf16_f32 v110, v112, v113
    v_cvt_pk_bf16_f32 v111, v114, v115
    v_exp_f32 v120, v120
    v_exp_f32 v121, v121
    v_exp_f32 v122, v122
    v_exp_f32 v123, v123
    s_waitcnt lgkmcnt(2)
    v_mfma_f32_32x32x16_bf16 v[156:171], v[188:191], v[108:111], v[156:171]
    v_cvt_pk_bf16_f32 v112, v116, v117
    v_cvt_pk_bf16_f32 v113, v118, v119
    v_cvt_pk_bf16_f32 v114, v120, v121
    v_cvt_pk_bf16_f32 v115, v122, v123
    s_nop 1
    v_mfma_f32_32x32x16_bf16 v[156:171], v[192:195], v[112:115], v[156:171]
    v_exp_f32 v124, v124
    v_exp_f32 v125, v125
    v_exp_f32 v126, v126
    v_exp_f32 v127, v127
    v_exp_f32 v128, v128
    v_exp_f32 v129, v129
    v_exp_f32 v130, v130
    v_exp_f32 v131, v131
    v_exp_f32 v132, v132
    v_exp_f32 v133, v133
    v_exp_f32 v134, v134
    v_exp_f32 v135, v135
    v_cvt_pk_bf16_f32 v124, v124, v125
    v_cvt_pk_bf16_f32 v125, v126, v127
    v_cvt_pk_bf16_f32 v126, v128, v129
    v_cvt_pk_bf16_f32 v127, v130, v131
    v_exp_f32 v136, v136
    v_exp_f32 v137, v137
    v_exp_f32 v138, v138
    v_exp_f32 v139, v139
    s_waitcnt lgkmcnt(0)
    v_mfma_f32_32x32x16_bf16 v[156:171], v[196:199], v[124:127], v[156:171]
    v_cvt_pk_bf16_f32 v128, v132, v133
    v_cvt_pk_bf16_f32 v129, v134, v135
    v_cvt_pk_bf16_f32 v130, v136, v137
    v_cvt_pk_bf16_f32 v131, v138, v139
    s_nop 1
    v_mfma_f32_32x32x16_bf16 v[156:171], v[200:203], v[128:131], v[156:171]
    s_nop 11
    v_mov_b32 v245, v168
    v_mov_b32 v249, v168
    s_nop 1
    v_permlane32_swap_b32 v245, v249
    v_rcp_f32 v249, v249
    v_cmp_eq_u32 vcc, 0, v3
    s_nop 1
    v_cndmask_b32 v245, 0, v249, vcc
    v_mul_f32 v156, v249, v156
    v_mul_f32 v157, v249, v157
    v_mul_f32 v158, v249, v158
    v_mul_f32 v159, v249, v159
    v_mul_f32 v160, v249, v160
    v_mul_f32 v161, v249, v161
    v_mul_f32 v162, v249, v162
    v_mul_f32 v163, v249, v163
    v_mul_f32 v164, v249, v164
    v_mul_f32 v165, v249, v165
    v_mul_f32 v166, v249, v166
    v_mul_f32 v167, v249, v167
    v_mul_f32 v168, v245, v168
    v_mul_f32 v169, v245, v169
    v_mul_f32 v170, v245, v170
    v_mul_f32 v171, v245, v171
    v_cvt_pk_bf16_f32 v172, v156, v157
    v_cvt_pk_bf16_f32 v173, v158, v159
    v_cvt_pk_bf16_f32 v174, v160, v161
    v_cvt_pk_bf16_f32 v175, v162, v163
    v_cvt_pk_bf16_f32 v176, v164, v165
    v_cvt_pk_bf16_f32 v177, v166, v167
    v_cvt_pk_bf16_f32 v178, v168, v169
    v_cvt_pk_bf16_f32 v179, v170, v171
    s_add_u32 s42, s72, s93
    buffer_store_dwordx4 v[172:175], v1, s[4:7], s42 offen
    buffer_store_dwordx4 v[176:179], v1, s[4:7], s42 offen offset:1024
    s_lshl_b32 s43, s21, 2
    s_add_u32 s75, s43, s67
    s_add_u32 s43, s75, 0
    s_waitcnt vmcnt(0)
    s_mov_b64 exec, 1
    s_cmp_eq_u32 s19, 0
    s_cbranch_scc0 pubs_13
    buffer_store_dword v10, v6, s[4:7], s43 offen
    s_branch pubd_14
pubs_13:
    buffer_wbl2 sc1
    s_waitcnt vmcnt(0)
    buffer_store_dword v10, v6, s[4:7], s43 offen sc1
pubd_14:
    s_mov_b64 exec, -1
    s_nop 0
    s_waitcnt lgkmcnt(0)
    s_barrier
    s_cmp_ge_u32 s21, 14
    s_cbranch_scc1 idle0
    s_add_u32 s40, s68, 802944
    s_add_u32 m0, s0, 86016
    s_nop 0
    buffer_load_dwordx4 v251, s[24:27], s40 offen lds
    s_add_u32 s40, s68, 917632
    s_add_u32 m0, s0, 90112
    s_nop 0
    buffer_load_dwordx4 v251, s[24:27], s40 offen lds
    s_add_u32 s40, s68, 1032320
    s_add_u32 m0, s0, 94208
    s_nop 0
    buffer_load_dwordx4 v251, s[24:27], s40 offen lds
    s_add_u32 s40, s68, 1147008
    s_add_u32 m0, s0, 98304
    s_nop 0
    buffer_load_dwordx4 v251, s[24:27], s40 offen lds
    s_add_u32 s40, s68, 1261696
    s_add_u32 m0, s0, 102400
    s_nop 0
    buffer_load_dwordx4 v251, s[24:27], s40 offen lds
    s_add_u32 s40, s68, 1376384
    s_add_u32 m0, s0, 106496
    s_nop 0
    buffer_load_dwordx4 v251, s[24:27], s40 offen lds
    s_add_u32 s40, s68, 1491072
    s_add_u32 m0, s0, 110592
    s_nop 0
    buffer_load_dwordx4 v251, s[24:27], s40 offen lds
    s_mov_b32 s52, s36
    s_and_b32 s53, s37, 0xffff
    s_mov_b32 s54, 0x188000
    s_mov_b32 s55, 0x00020000
    v_lshrrev_b32 v238, 2, v0
    v_mul_u32_u24 v238, 896, v238
    v_and_b32 v11, 3, v0
    v_lshl_add_u32 v238, v11, 4, v238
    v_add_u32 v236, s76, v7
    v_add_u32 v237, s77, v7
    s_add_u32 s40, s82, 0
    s_add_u32 m0, s76, 0
    s_nop 0
    buffer_load_dwordx4 v238, s[52:55], s40 offen lds
    s_add_u32 s40, s83, 0
    s_add_u32 m0, s76, 1024
    s_nop 0
    buffer_load_dwordx4 v238, s[52:55], s40 offen lds
    s_add_u32 s40, s82, 114688
    s_add_u32 m0, s76, 2048
    s_nop 0
    buffer_load_dwordx4 v238, s[52:55], s40 offen lds
    s_mov_b32 s28, s32
    s_and_b32 s29, s33, 0xffff
    s_mov_b32 s30, 0x1c0000
    s_mov_b32 s31, 0x00020000
    v_mul_u32_u24 v11, 896, v2
    v_lshl_add_u32 v11, v3, 3, v11
    s_mul_i32 s45, s22, 28672
    s_lshl_b32 s46, s21, 6
    s_add_u32 s45, s45, s46
    buffer_load_dwordx2 v[172:173], v11, s[28:31], s45 offen offset:0
    buffer_load_dwordx2 v[174:175], v11, s[28:31], s45 offen offset:16
    buffer_load_dwordx2 v[176:177], v11, s[28:31], s45 offen offset:32
    buffer_load_dwordx2 v[178:179], v11, s[28:31], s45 offen offset:48
    s_add_u32 s42, s67, 0
poll_15:
    s_add_u32 s50, s50, 1
    s_cmp_gt_u32 s50, 0x40000
    s_cbranch_scc1 pollx_16
    buffer_load_dword v9, v5, s[4:7], s42 offen sc1
    s_waitcnt vmcnt(0)
    v_cmp_eq_u32 vcc, 1, v9
    s_nop 0
    s_and_b32 s51, vcc_lo, 0xffff
    s_cmp_eq_u32 s51, 0xffff
    s_cbranch_scc0 poll_15
pollx_16:
    s_cmp_eq_u32 s19, 0
    s_cbranch_scc1 acq_17
    buffer_inv sc1
    s_waitcnt vmcnt(0)
acq_17:
    s_add_u32 s43, s73, s93
    s_add_u32 s41, s43, 0
    buffer_load_dwordx4 v[12:15], v1, s[4:7], s41 offen sc1
    s_add_u32 s41, s43, 1024
    buffer_load_dwordx4 v[16:19], v1, s[4:7], s41 offen sc1
    s_add_u32 s41, s43, 2048
    buffer_load_dwordx4 v[20:23], v1, s[4:7], s41 offen sc1
    s_add_u32 s41, s43, 3072
    buffer_load_dwordx4 v[24:27], v1, s[4:7], s41 offen sc1
    s_add_u32 s41, s43, 4096
    buffer_load_dwordx4 v[28:31], v1, s[4:7], s41 offen sc1
    s_add_u32 s41, s43, 5120
    buffer_load_dwordx4 v[32:35], v1, s[4:7], s41 offen sc1
    s_add_u32 s41, s43, 6144
    buffer_load_dwordx4 v[36:39], v1, s[4:7], s41 offen sc1
    s_add_u32 s41, s43, 7168
    buffer_load_dwordx4 v[40:43], v1, s[4:7], s41 offen sc1
    ds_read_b64_tr_b16 v[156:157], v254 offset:0
    ds_read_b64_tr_b16 v[158:159], v254 offset:512
    ds_read_b64_tr_b16 v[160:161], v254 offset:1024
    ds_read_b64_tr_b16 v[162:163], v254 offset:1536
    ds_read_b64_tr_b16 v[164:165], v254 offset:1792
    ds_read_b64_tr_b16 v[166:167], v254 offset:2304
    v_lshlrev_b32 v140, 16, v172
    v_and_b32 v141, 0xffff0000, v172
    v_lshlrev_b32 v142, 16, v173
    v_and_b32 v143, 0xffff0000, v173
    v_lshlrev_b32 v144, 16, v174
    v_and_b32 v145, 0xffff0000, v174
    v_lshlrev_b32 v146, 16, v175
    v_and_b32 v147, 0xffff0000, v175
    v_lshlrev_b32 v148, 16, v176
    v_and_b32 v149, 0xffff0000, v176
    v_lshlrev_b32 v150, 16, v177
    v_and_b32 v151, 0xffff0000, v177
    v_lshlrev_b32 v152, 16, v178
    v_and_b32 v153, 0xffff0000, v178
    v_lshlrev_b32 v154, 16, v179
    v_and_b32 v155, 0xffff0000, v179
    s_waitcnt vmcnt(7) lgkmcnt(4)
    s_nop 0
    v_mfma_f32_32x32x16_bf16 v[140:155], v[156:159], v[12:15], v[140:155]
    ds_read_b64_tr_b16 v[168:169], v254 offset:2816
    ds_read_b64_tr_b16 v[170:171], v254 offset:3328
    s_add_u32 s41, s43, 8192
    buffer_load_dwordx4 v[44:47], v1, s[4:7], s41 offen sc1
    s_waitcnt vmcnt(7) lgkmcnt(4)
    v_mfma_f32_32x32x16_bf16 v[140:155], v[160:163], v[16:19], v[140:155]
    ds_read_b64_tr_b16 v[156:157], v254 offset:3584
    ds_read_b64_tr_b16 v[158:159], v254 offset:4096
    s_add_u32 s41, s43, 9216
    buffer_load_dwordx4 v[48:51], v1, s[4:7], s41 offen sc1
    s_waitcnt vmcnt(7) lgkmcnt(4)
    v_mfma_f32_32x32x16_bf16 v[140:155], v[164:167], v[20:23], v[140:155]
    ds_read_b64_tr_b16 v[160:161], v254 offset:4608
    ds_read_b64_tr_b16 v[162:163], v254 offset:5120
    s_add_u32 s41, s43, 10240
    buffer_load_dwordx4 v[52:55], v1, s[4:7], s41 offen sc1
    s_waitcnt vmcnt(7) lgkmcnt(4)
    v_mfma_f32_32x32x16_bf16 v[140:155], v[168:171], v[24:27], v[140:155]
    ds_read_b64_tr_b16 v[164:165], v254 offset:5376
    ds_read_b64_tr_b16 v[166:167], v254 offset:5888
    s_add_u32 s41, s43, 11264
    buffer_load_dwordx4 v[56:59], v1, s[4:7], s41 offen sc1
    s_waitcnt vmcnt(7) lgkmcnt(4)
    v_mfma_f32_32x32x16_bf16 v[140:155], v[156:159], v[28:31], v[140:155]
    ds_read_b64_tr_b16 v[168:169], v254 offset:6400
    ds_read_b64_tr_b16 v[170:171], v254 offset:6912
    s_add_u32 s41, s43, 12288
    buffer_load_dwordx4 v[60:63], v1, s[4:7], s41 offen sc1
    s_waitcnt vmcnt(7) lgkmcnt(4)
    v_mfma_f32_32x32x16_bf16 v[140:155], v[160:163], v[32:35], v[140:155]
    ds_read_b64_tr_b16 v[156:157], v254 offset:7168
    ds_read_b64_tr_b16 v[158:159], v254 offset:7680
    s_add_u32 s41, s43, 13312
    buffer_load_dwordx4 v[64:67], v1, s[4:7], s41 offen sc1
    s_waitcnt vmcnt(7) lgkmcnt(4)
    v_mfma_f32_32x32x16_bf16 v[140:155], v[164:167], v[36:39], v[140:155]
    ds_read_b64_tr_b16 v[160:161], v254 offset:8192
    ds_read_b64_tr_b16 v[162:163], v254 offset:8704
    s_add_u32 s41, s43, 14336
    buffer_load_dwordx4 v[68:71], v1, s[4:7], s41 offen sc1
    s_waitcnt vmcnt(7) lgkmcnt(4)
    v_mfma_f32_32x32x16_bf16 v[140:155], v[168:171], v[40:43], v[140:155]
    ds_read_b64_tr_b16 v[164:165], v254 offset:8960
    ds_read_b64_tr_b16 v[166:167], v254 offset:9472
    s_add_u32 s41, s43, 15360
    buffer_load_dwordx4 v[72:75], v1, s[4:7], s41 offen sc1
    s_waitcnt vmcnt(7) lgkmcnt(4)
    v_mfma_f32_32x32x16_bf16 v[140:155], v[156:159], v[44:47], v[140:155]
    ds_read_b64_tr_b16 v[168:169], v254 offset:9984
    ds_read_b64_tr_b16 v[170:171], v254 offset:10496
    s_add_u32 s41, s43, 16384
    buffer_load_dwordx4 v[76:79], v1, s[4:7], s41 offen sc1
    s_waitcnt vmcnt(7) lgkmcnt(4)
    v_mfma_f32_32x32x16_bf16 v[140:155], v[160:163], v[48:51], v[140:155]
    ds_read_b64_tr_b16 v[156:157], v254 offset:10752
    ds_read_b64_tr_b16 v[158:159], v254 offset:11264
    s_add_u32 s41, s43, 17408
    buffer_load_dwordx4 v[80:83], v1, s[4:7], s41 offen sc1
    s_waitcnt vmcnt(7) lgkmcnt(4)
    v_mfma_f32_32x32x16_bf16 v[140:155], v[164:167], v[52:55], v[140:155]
    ds_read_b64_tr_b16 v[160:161], v254 offset:11776
    ds_read_b64_tr_b16 v[162:163], v254 offset:12288
    s_add_u32 s41, s43, 18432
    buffer_load_dwordx4 v[84:87], v1, s[4:7], s41 offen sc1
    s_waitcnt vmcnt(7) lgkmcnt(4)
    v_mfma_f32_32x32x16_bf16 v[140:155], v[168:171], v[56:59], v[140:155]
    ds_read_b64_tr_b16 v[164:165], v254 offset:12544
    ds_read_b64_tr_b16 v[166:167], v254 offset:13056
    s_add_u32 s41, s43, 19456
    buffer_load_dwordx4 v[88:91], v1, s[4:7], s41 offen sc1
    s_waitcnt vmcnt(7) lgkmcnt(4)
    v_mfma_f32_32x32x16_bf16 v[140:155], v[156:159], v[60:63], v[140:155]
    ds_read_b64_tr_b16 v[168:169], v254 offset:13568
    ds_read_b64_tr_b16 v[170:171], v254 offset:14080
    s_add_u32 s41, s43, 20480
    buffer_load_dwordx4 v[92:95], v1, s[4:7], s41 offen sc1
    s_waitcnt vmcnt(7) lgkmcnt(4)
    v_mfma_f32_32x32x16_bf16 v[140:155], v[160:163], v[64:67], v[140:155]
    ds_read_b64_tr_b16 v[156:157], v254 offset:14336
    ds_read_b64_tr_b16 v[158:159], v254 offset:14848
    s_add_u32 s41, s43, 21504
    buffer_load_dwordx4 v[96:99], v1, s[4:7], s41 offen sc1
    s_waitcnt vmcnt(7) lgkmcnt(4)
    v_mfma_f32_32x32x16_bf16 v[140:155], v[164:167], v[68:71], v[140:155]
    ds_read_b64_tr_b16 v[160:161], v254 offset:15360
    ds_read_b64_tr_b16 v[162:163], v254 offset:15872
    s_add_u32 s41, s43, 22528
    buffer_load_dwordx4 v[100:103], v1, s[4:7], s41 offen sc1
    s_waitcnt vmcnt(7) lgkmcnt(4)
    v_mfma_f32_32x32x16_bf16 v[140:155], v[168:171], v[72:75], v[140:155]
    ds_read_b64_tr_b16 v[164:165], v254 offset:16128
    ds_read_b64_tr_b16 v[166:167], v254 offset:16640
    s_add_u32 s41, s43, 23552
    buffer_load_dwordx4 v[104:107], v1, s[4:7], s41 offen sc1
    s_waitcnt vmcnt(7) lgkmcnt(4)
    v_mfma_f32_32x32x16_bf16 v[140:155], v[156:159], v[76:79], v[140:155]
    ds_read_b64_tr_b16 v[168:169], v254 offset:17152
    ds_read_b64_tr_b16 v[170:171], v254 offset:17664
    s_add_u32 s41, s43, 24576
    buffer_load_dwordx4 v[108:111], v1, s[4:7], s41 offen sc1
    s_waitcnt vmcnt(7) lgkmcnt(4)
    v_mfma_f32_32x32x16_bf16 v[140:155], v[160:163], v[80:83], v[140:155]
    ds_read_b64_tr_b16 v[156:157], v254 offset:17920
    ds_read_b64_tr_b16 v[158:159], v254 offset:18432
    s_add_u32 s41, s43, 25600
    buffer_load_dwordx4 v[112:115], v1, s[4:7], s41 offen sc1
    s_waitcnt vmcnt(7) lgkmcnt(4)
    v_mfma_f32_32x32x16_bf16 v[140:155], v[164:167], v[84:87], v[140:155]
    ds_read_b64_tr_b16 v[160:161], v254 offset:18944
    ds_read_b64_tr_b16 v[162:163], v254 offset:19456
    s_add_u32 s41, s43, 26624
    buffer_load_dwordx4 v[116:119], v1, s[4:7], s41 offen sc1
    s_waitcnt vmcnt(7) lgkmcnt(4)
    v_mfma_f32_32x32x16_bf16 v[140:155], v[168:171], v[88:91], v[140:155]
    ds_read_b64_tr_b16 v[164:165], v254 offset:19712
    ds_read_b64_tr_b16 v[166:167], v254 offset:20224
    s_add_u32 s41, s43, 27648
    buffer_load_dwordx4 v[120:123], v1, s[4:7], s41 offen sc1
    s_waitcnt vmcnt(7) lgkmcnt(4)
    v_mfma_f32_32x32x16_bf16 v[140:155], v[156:159], v[92:95], v[140:155]
    ds_read_b64_tr_b16 v[168:169], v254 offset:20736
    ds_read_b64_tr_b16 v[170:171], v254 offset:21248
    s_add_u32 s41, s43, 28672
    buffer_load_dwordx4 v[124:127], v1, s[4:7], s41 offen sc1
    s_waitcnt vmcnt(7) lgkmcnt(4)
    v_mfma_f32_32x32x16_bf16 v[140:155], v[160:163], v[96:99], v[140:155]
    ds_read_b64_tr_b16 v[156:157], v254 offset:21504
    ds_read_b64_tr_b16 v[158:159], v254 offset:22016
    s_add_u32 s41, s43, 29696
    buffer_load_dwordx4 v[128:131], v1, s[4:7], s41 offen sc1
    s_waitcnt vmcnt(7) lgkmcnt(4)
    v_mfma_f32_32x32x16_bf16 v[140:155], v[164:167], v[100:103], v[140:155]
    ds_read_b64_tr_b16 v[160:161], v254 offset:22528
    ds_read_b64_tr_b16 v[162:163], v254 offset:23040
    s_add_u32 s41, s43, 30720
    buffer_load_dwordx4 v[132:135], v1, s[4:7], s41 offen sc1
    s_waitcnt vmcnt(7) lgkmcnt(4)
    v_mfma_f32_32x32x16_bf16 v[140:155], v[168:171], v[104:107], v[140:155]
    ds_read_b64_tr_b16 v[164:165], v254 offset:23296
    ds_read_b64_tr_b16 v[166:167], v254 offset:23808
    s_add_u32 s41, s43, 31744
    buffer_load_dwordx4 v[136:139], v1, s[4:7], s41 offen sc1
    s_waitcnt vmcnt(7) lgkmcnt(4)
    v_mfma_f32_32x32x16_bf16 v[140:155], v[156:159], v[108:111], v[140:155]
    ds_read_b64_tr_b16 v[168:169], v254 offset:24320
    ds_read_b64_tr_b16 v[170:171], v254 offset:24832
    s_waitcnt vmcnt(6) lgkmcnt(4)
    v_mfma_f32_32x32x16_bf16 v[140:155], v[160:163], v[112:115], v[140:155]
    ds_read_b64_tr_b16 v[156:157], v254 offset:25088
    ds_read_b64_tr_b16 v[158:159], v254 offset:25600
    s_waitcnt vmcnt(5) lgkmcnt(4)
    v_mfma_f32_32x32x16_bf16 v[140:155], v[164:167], v[116:119], v[140:155]
    ds_read_b64_tr_b16 v[160:161], v254 offset:26112
    ds_read_b64_tr_b16 v[162:163], v254 offset:26624
    s_waitcnt vmcnt(4) lgkmcnt(4)
    v_mfma_f32_32x32x16_bf16 v[140:155], v[168:171], v[120:123], v[140:155]
    ds_read_b64_tr_b16 v[164:165], v254 offset:26880
    ds_read_b64_tr_b16 v[166:167], v254 offset:27392
    s_waitcnt vmcnt(3) lgkmcnt(4)
    v_mfma_f32_32x32x16_bf16 v[140:155], v[156:159], v[124:127], v[140:155]
    ds_read_b64_tr_b16 v[168:169], v254 offset:27904
    ds_read_b64_tr_b16 v[170:171], v254 offset:28416
    s_waitcnt vmcnt(2) lgkmcnt(4)
    v_mfma_f32_32x32x16_bf16 v[140:155], v[160:163], v[128:131], v[140:155]
    s_waitcnt vmcnt(1) lgkmcnt(2)
    v_mfma_f32_32x32x16_bf16 v[140:155], v[164:167], v[132:135], v[140:155]
    s_waitcnt vmcnt(0) lgkmcnt(0)
    v_mfma_f32_32x32x16_bf16 v[140:155], v[168:171], v[136:139], v[140:155]
    s_add_u32 s45, s70, s87
    s_add_u32 s46, s71, s90
    s_nop 9
    v_cvt_pk_bf16_f32 v180, v140, v141
    v_cvt_pk_bf16_f32 v181, v142, v143
    v_cvt_pk_bf16_f32 v182, v144, v145
    v_cvt_pk_bf16_f32 v183, v146, v147
    v_cvt_pk_bf16_f32 v184, v148, v149
    v_cvt_pk_bf16_f32 v185, v150, v151
    v_cvt_pk_bf16_f32 v186, v152, v153
    v_cvt_pk_bf16_f32 v187, v154, v155
    buffer_store_dwordx4 v[180:183], v1, s[4:7], s45 offen
    buffer_store_dwordx4 v[184:187], v1, s[4:7], s45 offen offset:1024
    v_pk_add_f32 v[192:193], v[140:141], v[142:143]
    v_pk_mul_f32 v[194:195], v[140:141], v[140:141]
    v_pk_fma_f32 v[194:195], v[142:143], v[142:143], v[194:195]
    v_pk_add_f32 v[192:193], v[192:193], v[144:145]
    v_pk_fma_f32 v[194:195], v[144:145], v[144:145], v[194:195]
    v_pk_add_f32 v[192:193], v[192:193], v[146:147]
    v_pk_fma_f32 v[194:195], v[146:147], v[146:147], v[194:195]
    v_pk_add_f32 v[192:193], v[192:193], v[148:149]
    v_pk_fma_f32 v[194:195], v[148:149], v[148:149], v[194:195]
    v_pk_add_f32 v[192:193], v[192:193], v[150:151]
    v_pk_fma_f32 v[194:195], v[150:151], v[150:151], v[194:195]
    v_pk_add_f32 v[192:193], v[192:193], v[152:153]
    v_pk_fma_f32 v[194:195], v[152:153], v[152:153], v[194:195]
    v_pk_add_f32 v[192:193], v[192:193], v[154:155]
    v_pk_fma_f32 v[194:195], v[154:155], v[154:155], v[194:195]
    v_add_f32 v188, v192, v193
    v_add_f32 v189, v194, v195
    v_mov_b32 v190, v188
    v_mov_b32 v191, v189
    s_nop 0
    v_permlane32_swap_b32 v188, v190
    v_permlane32_swap_b32 v189, v191
    v_add_f32 v188, v188, v190
    v_add_f32 v189, v189, v191
    v_lshlrev_b32 v190, 3, v2
    buffer_store_dwordx2 v[188:189], v190, s[4:7], s46 offen
    s_add_u32 s43, s75, 8192
    s_waitcnt vmcnt(0)
    s_mov_b64 exec, 1
    s_cmp_eq_u32 s19, 0
    s_cbranch_scc0 pubs_18
    buffer_store_dword v10, v6, s[4:7], s43 offen
    s_branch pubd_19
pubs_18:
    buffer_wbl2 sc1
    s_waitcnt vmcnt(0)
    buffer_store_dword v10, v6, s[4:7], s43 offen sc1
pubd_19:
    s_mov_b64 exec, -1
    s_nop 0
    s_barrier
    ds_read_b64_tr_b16 a[0:1], v236 offset:0
    ds_read_b64_tr_b16 a[2:3], v236 offset:512
    ds_read_b64_tr_b16 a[112:113], v236 offset:1024
    ds_read_b64_tr_b16 a[114:115], v236 offset:1536
    ds_read_b64_tr_b16 a[4:5], v236 offset:2048
    ds_read_b64_tr_b16 a[6:7], v236 offset:2560
    s_waitcnt lgkmcnt(0)
    s_add_u32 s40, s83, 114688
    s_add_u32 m0, s76, 0
    s_nop 0
    buffer_load_dwordx4 v238, s[52:55], s40 offen lds
    s_add_u32 s40, s82, 229376
    s_add_u32 m0, s76, 1024
    s_nop 0
    buffer_load_dwordx4 v238, s[52:55], s40 offen lds
    s_add_u32 s40, s83, 229376
    s_add_u32 m0, s76, 2048
    s_nop 0
    buffer_load_dwordx4 v238, s[52:55], s40 offen lds
    s_lshr_b32 s42, s3, 1
    s_mul_i32 s42, s42, 57344
    s_and_b32 s43, s3, 1
    s_lshl_b32 s43, s43, 9
    s_add_u32 s42, s42, s43
    v_add_u32 v234, s42, v7
    v_mov_b32 v240, 0x3f803f80
    v_mov_b32 v241, 0x3f803f80
    v_mov_b32 v242, 0x3f803f80
    v_mov_b32 v243, 0x3f803f80
    ds_read_b64_tr_b16 v[188:189], v234 offset:0
    ds_read_b64_tr_b16 v[190:191], v234 offset:1024
    ds_read_b64_tr_b16 v[192:193], v234 offset:2048
    ds_read_b64_tr_b16 v[194:195], v234 offset:3072
    ds_read_b64_tr_b16 v[196:197], v234 offset:4096
    ds_read_b64_tr_b16 v[198:199], v234 offset:5120
    ds_read_b64_tr_b16 v[200:201], v234 offset:6144
    ds_read_b64_tr_b16 v[202:203], v234 offset:7168
    ds_read_b64_tr_b16 v[204:205], v234 offset:8192
    ds_read_b64_tr_b16 v[206:207], v234 offset:9216
    s_waitcnt lgkmcnt(8)
    v_mfma_f32_4x4x4_16b_bf16 v[124:127], v[240:241], v[188:189], 0
    v_mfma_f32_4x4x4_16b_bf16 v[128:131], v[240:241], v[190:191], 0
    ds_read_b64_tr_b16 v[208:209], v234 offset:10240
    ds_read_b64_tr_b16 v[210:211], v234 offset:11264
    s_waitcnt lgkmcnt(8)
    v_mfma_f32_4x4x4_16b_bf16 v[124:127], v[240:241], v[192:193], v[124:127]
    v_mfma_f32_4x4x4_16b_bf16 v[128:131], v[240:241], v[194:195], v[128:131]
    ds_read_b64_tr_b16 v[188:189], v234 offset:12288
    ds_read_b64_tr_b16 v[190:191], v234 offset:13312
    s_waitcnt lgkmcnt(8)
    v_mfma_f32_4x4x4_16b_bf16 v[124:127], v[240:241], v[196:197], v[124:127]
    v_mfma_f32_4x4x4_16b_bf16 v[128:131], v[240:241], v[198:199], v[128:131]
    ds_read_b64_tr_b16 v[192:193], v234 offset:14336
    ds_read_b64_tr_b16 v[194:195], v234 offset:15360
    s_waitcnt lgkmcnt(8)
    v_mfma_f32_4x4x4_16b_bf16 v[124:127], v[240:241], v[200:201], v[124:127]
    v_mfma_f32_4x4x4_16b_bf16 v[128:131], v[240:241], v[202:203], v[128:131]
    ds_read_b64_tr_b16 v[196:197], v234 offset:16384
    ds_read_b64_tr_b16 v[198:199], v234 offset:17408
    s_waitcnt lgkmcnt(8)
    v_mfma_f32_4x4x4_16b_bf16 v[124:127], v[240:241], v[204:205], v[124:127]
    v_mfma_f32_4x4x4_16b_bf16 v[128:131], v[240:241], v[206:207], v[128:131]
    ds_read_b64_tr_b16 v[200:201], v234 offset:18432
    ds_read_b64_tr_b16 v[202:203], v234 offset:19456
    s_waitcnt lgkmcnt(8)
    v_mfma_f32_4x4x4_16b_bf16 v[124:127], v[240:241], v[208:209], v[124:127]
    v_mfma_f32_4x4x4_16b_bf16 v[128:131], v[240:241], v[210:211], v[128:131]
    ds_read_b64_tr_b16 v[204:205], v234 offset:20480
    ds_read_b64_tr_b16 v[206:207], v234 offset:21504
    s_waitcnt lgkmcnt(8)
    v_mfma_f32_4x4x4_16b_bf16 v[124:127], v[240:241], v[188:189], v[124:127]
    v_mfma_f32_4x4x4_16b_bf16 v[128:131], v[240:241], v[190:191], v[128:131]
    ds_read_b64_tr_b16 v[208:209], v234 offset:22528
    ds_read_b64_tr_b16 v[210:211], v234 offset:23552
    s_waitcnt lgkmcnt(8)
    v_mfma_f32_4x4x4_16b_bf16 v[124:127], v[240:241], v[192:193], v[124:127]
    v_mfma_f32_4x4x4_16b_bf16 v[128:131], v[240:241], v[194:195], v[128:131]
    ds_read_b64_tr_b16 v[188:189], v234 offset:24576
    ds_read_b64_tr_b16 v[190:191], v234 offset:25600
    s_waitcnt lgkmcnt(8)
    v_mfma_f32_4x4x4_16b_bf16 v[124:127], v[240:241], v[196:197], v[124:127]
    v_mfma_f32_4x4x4_16b_bf16 v[128:131], v[240:241], v[198:199], v[128:131]
    ds_read_b64_tr_b16 v[192:193], v234 offset:26624
    ds_read_b64_tr_b16 v[194:195], v234 offset:27648
    s_waitcnt lgkmcnt(8)
    v_mfma_f32_4x4x4_16b_bf16 v[124:127], v[240:241], v[200:201], v[124:127]
    v_mfma_f32_4x4x4_16b_bf16 v[128:131], v[240:241], v[202:203], v[128:131]
    ds_read_b64_tr_b16 v[196:197], v234 offset:28672
    ds_read_b64_tr_b16 v[198:199], v234 offset:29696
    s_waitcnt lgkmcnt(8)
    v_mfma_f32_4x4x4_16b_bf16 v[124:127], v[240:241], v[204:205], v[124:127]
    v_mfma_f32_4x4x4_16b_bf16 v[128:131], v[240:241], v[206:207], v[128:131]
    ds_read_b64_tr_b16 v[200:201], v234 offset:30720
    ds_read_b64_tr_b16 v[202:203], v234 offset:31744
    s_waitcnt lgkmcnt(8)
    v_mfma_f32_4x4x4_16b_bf16 v[124:127], v[240:241], v[208:209], v[124:127]
    v_mfma_f32_4x4x4_16b_bf16 v[128:131], v[240:241], v[210:211], v[128:131]
    ds_read_b64_tr_b16 v[204:205], v234 offset:32768
    ds_read_b64_tr_b16 v[206:207], v234 offset:33792
    s_waitcnt lgkmcnt(8)
    v_mfma_f32_4x4x4_16b_bf16 v[124:127], v[240:241], v[188:189], v[124:127]
    v_mfma_f32_4x4x4_16b_bf16 v[128:131], v[240:241], v[190:191], v[128:131]
    ds_read_b64_tr_b16 v[208:209], v234 offset:34816
    ds_read_b64_tr_b16 v[210:211], v234 offset:35840
    s_waitcnt lgkmcnt(8)
    v_mfma_f32_4x4x4_16b_bf16 v[124:127], v[240:241], v[192:193], v[124:127]
    v_mfma_f32_4x4x4_16b_bf16 v[128:131], v[240:241], v[194:195], v[128:131]
    ds_read_b64_tr_b16 v[188:189], v234 offset:36864
    ds_read_b64_tr_b16 v[190:191], v234 offset:37888
    s_waitcnt lgkmcnt(8)
    v_mfma_f32_4x4x4_16b_bf16 v[124:127], v[240:241], v[196:197], v[124:127]
    v_mfma_f32_4x4x4_16b_bf16 v[128:131], v[240:241], v[198:199], v[128:131]
    ds_read_b64_tr_b16 v[192:193], v234 offset:38912
    ds_read_b64_tr_b16 v[194:195], v234 offset:39936
    s_waitcnt lgkmcnt(8)
    v_mfma_f32_4x4x4_16b_bf16 v[124:127], v[240:241], v[200:201], v[124:127]
    v_mfma_f32_4x4x4_16b_bf16 v[128:131], v[240:241], v[202:203], v[128:131]
    ds_read_b64_tr_b16 v[196:197], v234 offset:40960
    ds_read_b64_tr_b16 v[198:199], v234 offset:41984
    s_waitcnt lgkmcnt(8)
    v_mfma_f32_4x4x4_16b_bf16 v[124:127], v[240:241], v[204:205], v[124:127]
    v_mfma_f32_4x4x4_16b_bf16 v[128:131], v[240:241], v[206:207], v[128:131]
    ds_read_b64_tr_b16 v[200:201], v234 offset:43008
    ds_read_b64_tr_b16 v[202:203], v234 offset:44032
    s_waitcnt lgkmcnt(8)
    v_mfma_f32_4x4x4_16b_bf16 v[124:127], v[240:241], v[208:209], v[124:127]
    v_mfma_f32_4x4x4_16b_bf16 v[128:131], v[240:241], v[210:211], v[128:131]
    ds_read_b64_tr_b16 v[204:205], v234 offset:45056
    ds_read_b64_tr_b16 v[206:207], v234 offset:46080
    s_waitcnt lgkmcnt(8)
    v_mfma_f32_4x4x4_16b_bf16 v[124:127], v[240:241], v[188:189], v[124:127]
    v_mfma_f32_4x4x4_16b_bf16 v[128:131], v[240:241], v[190:191], v[128:131]
    ds_read_b64_tr_b16 v[208:209], v234 offset:47104
    ds_read_b64_tr_b16 v[210:211], v234 offset:48128
    s_waitcnt lgkmcnt(8)
    v_mfma_f32_4x4x4_16b_bf16 v[124:127], v[240:241], v[192:193], v[124:127]
    v_mfma_f32_4x4x4_16b_bf16 v[128:131], v[240:241], v[194:195], v[128:131]
    ds_read_b64_tr_b16 v[188:189], v234 offset:49152
    ds_read_b64_tr_b16 v[190:191], v234 offset:50176
    s_waitcnt lgkmcnt(8)
    v_mfma_f32_4x4x4_16b_bf16 v[124:127], v[240:241], v[196:197], v[124:127]
    v_mfma_f32_4x4x4_16b_bf16 v[128:131], v[240:241], v[198:199], v[128:131]
    ds_read_b64_tr_b16 v[192:193], v234 offset:51200
    ds_read_b64_tr_b16 v[194:195], v234 offset:52224
    s_waitcnt lgkmcnt(8)
    v_mfma_f32_4x4x4_16b_bf16 v[124:127], v[240:241], v[200:201], v[124:127]
    v_mfma_f32_4x4x4_16b_bf16 v[128:131], v[240:241], v[202:203], v[128:131]
    ds_read_b64_tr_b16 v[196:197], v234 offset:53248
    ds_read_b64_tr_b16 v[198:199], v234 offset:54272
    s_waitcnt lgkmcnt(8)
    v_mfma_f32_4x4x4_16b_bf16 v[124:127], v[240:241], v[204:205], v[124:127]
    v_mfma_f32_4x4x4_16b_bf16 v[128:131], v[240:241], v[206:207], v[128:131]
    ds_read_b64_tr_b16 v[200:201], v234 offset:55296
    ds_read_b64_tr_b16 v[202:203], v234 offset:56320
    s_waitcnt lgkmcnt(8)
    v_mfma_f32_4x4x4_16b_bf16 v[124:127], v[240:241], v[208:209], v[124:127]
    v_mfma_f32_4x4x4_16b_bf16 v[128:131], v[240:241], v[210:211], v[128:131]
    s_waitcnt lgkmcnt(6)
    v_mfma_f32_4x4x4_16b_bf16 v[124:127], v[240:241], v[188:189], v[124:127]
    v_mfma_f32_4x4x4_16b_bf16 v[128:131], v[240:241], v[190:191], v[128:131]
    s_waitcnt lgkmcnt(4)
    v_mfma_f32_4x4x4_16b_bf16 v[124:127], v[240:241], v[192:193], v[124:127]
    v_mfma_f32_4x4x4_16b_bf16 v[128:131], v[240:241], v[194:195], v[128:131]
    s_waitcnt lgkmcnt(2)
    v_mfma_f32_4x4x4_16b_bf16 v[124:127], v[240:241], v[196:197], v[124:127]
    v_mfma_f32_4x4x4_16b_bf16 v[128:131], v[240:241], v[198:199], v[128:131]
    s_waitcnt lgkmcnt(0)
    v_mfma_f32_4x4x4_16b_bf16 v[124:127], v[240:241], v[200:201], v[124:127]
    v_mfma_f32_4x4x4_16b_bf16 v[128:131], v[240:241], v[202:203], v[128:131]
    v_accvgpr_read_b32 v235, a252
    s_nop 3
    v_add_f32 v124, v124, v128
    v_mov_b32 v125, v124
    s_nop 1
    v_permlane32_swap_b32 v124, v125
    v_add_f32 v124, v124, v125
    v_cmp_eq_u32 vcc, 0, v3
    v_cvt_pk_bf16_f32 v188, v124, v124
    v_lshlrev_b32 v248, 16, v188
    v_sub_f32 v248, v124, v248
    v_cvt_pk_bf16_f32 v189, v248, v248
    v_and_b32 v189, 0xffff, v189
    v_lshl_or_b32 v189, v235, 16, v189
    v_cndmask_b32 v190, 0, v235, vcc
    v_mov_b32 v191, 0
    v_cndmask_b32 v188, 0, v188, vcc
    v_cndmask_b32 v189, 0, v189, vcc
    s_add_u32 s42, s63, 114688
    v_add_u32 v234, s42, v1
    ds_write_b128 v234, v[188:191]
    v_add_u32 v234, 114688, v1
    s_waitcnt lgkmcnt(0)
    s_barrier
    ds_read_b128 a[224:227], v234 offset:0
    ds_read_b128 a[228:231], v234 offset:1024
    ds_read_b128 a[232:235], v234 offset:2048
    ds_read_b128 a[236:239], v234 offset:3072
    s_add_u32 s42, s67, 8192
poll_20:
    s_add_u32 s50, s50, 1
    s_cmp_gt_u32 s50, 0x40000
    s_cbranch_scc1 pollx_21
    buffer_load_dword v9, v5, s[4:7], s42 offen sc1
    s_waitcnt vmcnt(0)
    v_cmp_eq_u32 vcc, 1, v9
    s_nop 0
    s_and_b32 s51, vcc_lo, 0x3fff
    s_cmp_eq_u32 s51, 0x3fff
    s_cbranch_scc0 poll_20
pollx_21:
    s_cmp_eq_u32 s19, 0
    s_cbranch_scc1 acq_22
    buffer_inv sc1
    s_waitcnt vmcnt(0)
acq_22:
    s_add_u32 s43, s64, s87
    s_add_u32 s44, s65, s90
    s_add_u32 s41, s43, 0
    buffer_load_dwordx4 v[12:15], v1, s[4:7], s41 offen sc1
    s_add_u32 s41, s43, 1024
    buffer_load_dwordx4 v[16:19], v1, s[4:7], s41 offen sc1
    s_add_u32 s41, s43, 2048
    buffer_load_dwordx4 v[20:23], v1, s[4:7], s41 offen sc1
    s_add_u32 s41, s43, 3072
    buffer_load_dwordx4 v[24:27], v1, s[4:7], s41 offen sc1
    s_add_u32 s41, s43, 4096
    buffer_load_dwordx4 v[28:31], v1, s[4:7], s41 offen sc1
    s_add_u32 s41, s43, 5120
    buffer_load_dwordx4 v[32:35], v1, s[4:7], s41 offen sc1
    s_add_u32 s41, s43, 6144
    buffer_load_dwordx4 v[36:39], v1, s[4:7], s41 offen sc1
    s_add_u32 s41, s43, 7168
    buffer_load_dwordx4 v[40:43], v1, s[4:7], s41 offen sc1
    ds_read_b64_tr_b16 v[188:189], v7 offset:0
    ds_read_b64_tr_b16 v[190:191], v7 offset:1024
    ds_read_b64_tr_b16 v[192:193], v7 offset:512
    ds_read_b64_tr_b16 v[194:195], v7 offset:1536
    ds_read_b64_tr_b16 v[196:197], v7 offset:57344
    ds_read_b64_tr_b16 v[198:199], v7 offset:58368
    ds_read_b64_tr_b16 v[200:201], v7 offset:2048
    ds_read_b64_tr_b16 v[202:203], v7 offset:3072
    ds_read_b64_tr_b16 v[204:205], v7 offset:2560
    ds_read_b64_tr_b16 v[206:207], v7 offset:3584
    ds_read_b64_tr_b16 v[208:209], v7 offset:59392
    ds_read_b64_tr_b16 v[210:211], v7 offset:60416
    s_waitcnt vmcnt(7) lgkmcnt(10)
    v_mfma_f32_32x32x16_bf16 v[124:139], v[188:191], v[12:15], 0
    ds_read_b64_tr_b16 v[188:189], v7 offset:4096
    ds_read_b64_tr_b16 v[190:191], v7 offset:5120
    s_waitcnt lgkmcnt(10)
    v_mfma_f32_32x32x16_bf16 v[140:155], v[192:195], v[12:15], 0
    ds_read_b64_tr_b16 v[192:193], v7 offset:4608
    ds_read_b64_tr_b16 v[194:195], v7 offset:5632
    s_waitcnt lgkmcnt(10)
    v_mfma_f32_32x32x16_bf16 v[156:171], v[196:199], v[12:15], 0
    ds_read_b64_tr_b16 v[196:197], v7 offset:61440
    ds_read_b64_tr_b16 v[198:199], v7 offset:62464
    s_add_u32 s41, s43, 8192
    buffer_load_dwordx4 v[44:47], v1, s[4:7], s41 offen sc1
    s_waitcnt vmcnt(7) lgkmcnt(10)
    v_mfma_f32_32x32x16_bf16 v[124:139], v[200:203], v[16:19], v[124:139]
    ds_read_b64_tr_b16 v[200:201], v7 offset:6144
    ds_read_b64_tr_b16 v[202:203], v7 offset:7168
    s_waitcnt lgkmcnt(10)
    v_mfma_f32_32x32x16_bf16 v[140:155], v[204:207], v[16:19], v[140:155]
    ds_read_b64_tr_b16 v[204:205], v7 offset:6656
    ds_read_b64_tr_b16 v[206:207], v7 offset:7680
    s_waitcnt lgkmcnt(10)
    v_mfma_f32_32x32x16_bf16 v[156:171], v[208:211], v[16:19], v[156:171]
    ds_read_b64_tr_b16 v[208:209], v7 offset:63488
    ds_read_b64_tr_b16 v[210:211], v7 offset:64512
    s_add_u32 s41, s43, 9216
    buffer_load_dwordx4 v[48:51], v1, s[4:7], s41 offen sc1
    s_waitcnt vmcnt(7) lgkmcnt(10)
    v_mfma_f32_32x32x16_bf16 v[124:139], v[188:191], v[20:23], v[124:139]
    ds_read_b64_tr_b16 v[188:189], v7 offset:8192
    ds_read_b64_tr_b16 v[190:191], v7 offset:9216
    s_waitcnt lgkmcnt(10)
    v_mfma_f32_32x32x16_bf16 v[140:155], v[192:195], v[20:23], v[140:155]
    ds_read_b64_tr_b16 v[192:193], v7 offset:8704
    ds_read_b64_tr_b16 v[194:195], v7 offset:9728
    s_waitcnt lgkmcnt(10)
    v_mfma_f32_32x32x16_bf16 v[156:171], v[196:199], v[20:23], v[156:171]
    ds_read_b64_tr_b16 v[196:197], v8 offset:0
    ds_read_b64_tr_b16 v[198:199], v8 offset:1024
    s_add_u32 s41, s43, 10240
    buffer_load_dwordx4 v[52:55], v1, s[4:7], s41 offen sc1
    buffer_load_dwordx2 v[212:213], v4, s[4:7], s44 offen offset:0 sc1
    buffer_load_dwordx2 v[214:215], v4, s[4:7], s44 offen offset:512 sc1
    buffer_load_dwordx2 v[216:217], v4, s[4:7], s44 offen offset:1024 sc1
    buffer_load_dwordx2 v[218:219], v4, s[4:7], s44 offen offset:1536 sc1
    s_waitcnt vmcnt(11) lgkmcnt(10)
    v_mfma_f32_32x32x16_bf16 v[124:139], v[200:203], v[24:27], v[124:139]
    ds_read_b64_tr_b16 v[200:201], v7 offset:10240
    ds_read_b64_tr_b16 v[202:203], v7 offset:11264
    s_waitcnt lgkmcnt(10)
    v_mfma_f32_32x32x16_bf16 v[140:155], v[204:207], v[24:27], v[140:155]
    ds_read_b64_tr_b16 v[204:205], v7 offset:10752
    ds_read_b64_tr_b16 v[206:207], v7 offset:11776
    s_waitcnt lgkmcnt(10)
    v_mfma_f32_32x32x16_bf16 v[156:171], v[208:211], v[24:27], v[156:171]
    ds_read_b64_tr_b16 v[208:209], v8 offset:2048
    ds_read_b64_tr_b16 v[210:211], v8 offset:3072
    s_add_u32 s41, s43, 11264
    buffer_load_dwordx4 v[56:59], v1, s[4:7], s41 offen sc1
    buffer_load_dwordx2 v[220:221], v4, s[4:7], s44 offen offset:2048 sc1
    buffer_load_dwordx2 v[222:223], v4, s[4:7], s44 offen offset:2560 sc1
    buffer_load_dwordx2 v[224:225], v4, s[4:7], s44 offen offset:3072 sc1
    s_waitcnt vmcnt(14) lgkmcnt(10)
    v_mfma_f32_32x32x16_bf16 v[124:139], v[188:191], v[28:31], v[124:139]
    ds_read_b64_tr_b16 v[188:189], v7 offset:12288
    ds_read_b64_tr_b16 v[190:191], v7 offset:13312
    s_waitcnt lgkmcnt(10)
    v_mfma_f32_32x32x16_bf16 v[140:155], v[192:195], v[28:31], v[140:155]
    ds_read_b64_tr_b16 v[192:193], v7 offset:12800
    ds_read_b64_tr_b16 v[194:195], v7 offset:13824
    s_waitcnt lgkmcnt(10)
    v_mfma_f32_32x32x16_bf16 v[156:171], v[196:199], v[28:31], v[156:171]
    ds_read_b64_tr_b16 v[196:197], v8 offset:4096
    ds_read_b64_tr_b16 v[198:199], v8 offset:5120
    s_add_u32 s41, s43, 12288
    buffer_load_dwordx4 v[60:63], v1, s[4:7], s41 offen sc1
    s_waitcnt vmcnt(14) lgkmcnt(10)
    v_mfma_f32_32x32x16_bf16 v[124:139], v[200:203], v[32:35], v[124:139]
    ds_read_b64_tr_b16 v[200:201], v7 offset:14336
    ds_read_b64_tr_b16 v[202:203], v7 offset:15360
    s_waitcnt lgkmcnt(10)
    v_mfma_f32_32x32x16_bf16 v[140:155], v[204:207], v[32:35], v[140:155]
    ds_read_b64_tr_b16 v[204:205], v7 offset:14848
    ds_read_b64_tr_b16 v[206:207], v7 offset:15872
    s_waitcnt lgkmcnt(10)
    v_mfma_f32_32x32x16_bf16 v[156:171], v[208:211], v[32:35], v[156:171]
    ds_read_b64_tr_b16 v[208:209], v8 offset:6144
    ds_read_b64_tr_b16 v[210:211], v8 offset:7168
    s_add_u32 s41, s43, 13312
    buffer_load_dwordx4 v[64:67], v1, s[4:7], s41 offen sc1
    s_waitcnt vmcnt(14) lgkmcnt(10)
    v_mfma_f32_32x32x16_bf16 v[124:139], v[188:191], v[36:39], v[124:139]
    ds_read_b64_tr_b16 v[188:189], v7 offset:16384
    ds_read_b64_tr_b16 v[190:191], v7 offset:17408
    s_waitcnt lgkmcnt(10)
    v_mfma_f32_32x32x16_bf16 v[140:155], v[192:195], v[36:39], v[140:155]
    ds_read_b64_tr_b16 v[192:193], v7 offset:16896
    ds_read_b64_tr_b16 v[194:195], v7 offset:17920
    s_waitcnt lgkmcnt(10)
    v_mfma_f32_32x32x16_bf16 v[156:171], v[196:199], v[36:39], v[156:171]
    ds_read_b64_tr_b16 v[196:197], v8 offset:8192
    ds_read_b64_tr_b16 v[198:199], v8 offset:9216
    s_add_u32 s41, s43, 14336
    buffer_load_dwordx4 v[68:71], v1, s[4:7], s41 offen sc1
    s_waitcnt vmcnt(14) lgkmcnt(10)
    v_mfma_f32_32x32x16_bf16 v[124:139], v[200:203], v[40:43], v[124:139]
    ds_read_b64_tr_b16 v[200:201], v7 offset:18432
    ds_read_b64_tr_b16 v[202:203], v7 offset:19456
    s_waitcnt lgkmcnt(10)
    v_mfma_f32_32x32x16_bf16 v[140:155], v[204:207], v[40:43], v[140:155]
    ds_read_b64_tr_b16 v[204:205], v7 offset:18944
    ds_read_b64_tr_b16 v[206:207], v7 offset:19968
    s_waitcnt lgkmcnt(10)
    v_mfma_f32_32x32x16_bf16 v[156:171], v[208:211], v[40:43], v[156:171]
    ds_read_b64_tr_b16 v[208:209], v8 offset:10240
    ds_read_b64_tr_b16 v[210:211], v8 offset:11264
    s_add_u32 s41, s43, 15360
    buffer_load_dwordx4 v[72:75], v1, s[4:7], s41 offen sc1
    s_waitcnt vmcnt(14) lgkmcnt(10)
    v_mfma_f32_32x32x16_bf16 v[124:139], v[188:191], v[44:47], v[124:139]
    ds_read_b64_tr_b16 v[188:189], v7 offset:20480
    ds_read_b64_tr_b16 v[190:191], v7 offset:21504
    s_waitcnt lgkmcnt(10)
    v_mfma_f32_32x32x16_bf16 v[140:155], v[192:195], v[44:47], v[140:155]
    ds_read_b64_tr_b16 v[192:193], v7 offset:20992
    ds_read_b64_tr_b16 v[194:195], v7 offset:22016
    s_waitcnt lgkmcnt(10)
    v_mfma_f32_32x32x16_bf16 v[156:171], v[196:199], v[44:47], v[156:171]
    ds_read_b64_tr_b16 v[196:197], v8 offset:12288
    ds_read_b64_tr_b16 v[198:199], v8 offset:13312
    s_add_u32 s41, s43, 16384
    buffer_load_dwordx4 v[76:79], v1, s[4:7], s41 offen sc1
    s_waitcnt vmcnt(14) lgkmcnt(10)
    v_mfma_f32_32x32x16_bf16 v[124:139], v[200:203], v[48:51], v[124:139]
    ds_read_b64_tr_b16 v[200:201], v7 offset:22528
    ds_read_b64_tr_b16 v[202:203], v7 offset:23552
    s_waitcnt lgkmcnt(10)
    v_mfma_f32_32x32x16_bf16 v[140:155], v[204:207], v[48:51], v[140:155]
    ds_read_b64_tr_b16 v[204:205], v7 offset:23040
    ds_read_b64_tr_b16 v[206:207], v7 offset:24064
    s_waitcnt lgkmcnt(10)
    v_mfma_f32_32x32x16_bf16 v[156:171], v[208:211], v[48:51], v[156:171]
    ds_read_b64_tr_b16 v[208:209], v8 offset:14336
    ds_read_b64_tr_b16 v[210:211], v8 offset:15360
    s_add_u32 s41, s43, 17408
    buffer_load_dwordx4 v[80:83], v1, s[4:7], s41 offen sc1
    s_waitcnt vmcnt(14) lgkmcnt(10)
    v_mfma_f32_32x32x16_bf16 v[124:139], v[188:191], v[52:55], v[124:139]
    ds_read_b64_tr_b16 v[188:189], v7 offset:24576
    ds_read_b64_tr_b16 v[190:191], v7 offset:25600
    s_waitcnt lgkmcnt(10)
    v_mfma_f32_32x32x16_bf16 v[140:155], v[192:195], v[52:55], v[140:155]
    ds_read_b64_tr_b16 v[192:193], v7 offset:25088
    ds_read_b64_tr_b16 v[194:195], v7 offset:26112
    s_waitcnt lgkmcnt(10)
    v_mfma_f32_32x32x16_bf16 v[156:171], v[196:199], v[52:55], v[156:171]
    ds_read_b64_tr_b16 v[196:197], v8 offset:16384
    ds_read_b64_tr_b16 v[198:199], v8 offset:17408
    s_add_u32 s41, s43, 18432
    buffer_load_dwordx4 v[84:87], v1, s[4:7], s41 offen sc1
    s_waitcnt vmcnt(10) lgkmcnt(10)
    v_mfma_f32_32x32x16_bf16 v[124:139], v[200:203], v[56:59], v[124:139]
    ds_read_b64_tr_b16 v[200:201], v7 offset:26624
    ds_read_b64_tr_b16 v[202:203], v7 offset:27648
    s_waitcnt lgkmcnt(10)
    v_mfma_f32_32x32x16_bf16 v[140:155], v[204:207], v[56:59], v[140:155]
    ds_read_b64_tr_b16 v[204:205], v7 offset:27136
    ds_read_b64_tr_b16 v[206:207], v7 offset:28160
    s_waitcnt lgkmcnt(10)
    v_mfma_f32_32x32x16_bf16 v[156:171], v[208:211], v[56:59], v[156:171]
    ds_read_b64_tr_b16 v[208:209], v8 offset:18432
    ds_read_b64_tr_b16 v[210:211], v8 offset:19456
    s_add_u32 s41, s43, 19456
    buffer_load_dwordx4 v[88:91], v1, s[4:7], s41 offen sc1
    s_waitcnt vmcnt(7) lgkmcnt(10)
    v_mfma_f32_32x32x16_bf16 v[124:139], v[188:191], v[60:63], v[124:139]
    ds_read_b64_tr_b16 v[188:189], v7 offset:28672
    ds_read_b64_tr_b16 v[190:191], v7 offset:29696
    s_waitcnt lgkmcnt(10)
    v_mfma_f32_32x32x16_bf16 v[140:155], v[192:195], v[60:63], v[140:155]
    ds_read_b64_tr_b16 v[192:193], v7 offset:29184
    ds_read_b64_tr_b16 v[194:195], v7 offset:30208
    s_waitcnt lgkmcnt(10)
    v_mfma_f32_32x32x16_bf16 v[156:171], v[196:199], v[60:63], v[156:171]
    ds_read_b64_tr_b16 v[196:197], v8 offset:20480
    ds_read_b64_tr_b16 v[198:199], v8 offset:21504
    s_add_u32 s41, s43, 20480
    buffer_load_dwordx4 v[92:95], v1, s[4:7], s41 offen sc1
    s_waitcnt vmcnt(7) lgkmcnt(10)
    v_mfma_f32_32x32x16_bf16 v[124:139], v[200:203], v[64:67], v[124:139]
    ds_read_b64_tr_b16 v[200:201], v7 offset:30720
    ds_read_b64_tr_b16 v[202:203], v7 offset:31744
    s_waitcnt lgkmcnt(10)
    v_mfma_f32_32x32x16_bf16 v[140:155], v[204:207], v[64:67], v[140:155]
    v_add_f32 v212, v212, v214
    ds_read_b64_tr_b16 v[204:205], v7 offset:31232
    ds_read_b64_tr_b16 v[206:207], v7 offset:32256
    s_waitcnt lgkmcnt(10)
    v_mfma_f32_32x32x16_bf16 v[156:171], v[208:211], v[64:67], v[156:171]
    v_add_f32 v213, v213, v215
    v_add_f32 v212, v212, v216
    ds_read_b64_tr_b16 v[208:209], v8 offset:22528
    ds_read_b64_tr_b16 v[210:211], v8 offset:23552
    s_add_u32 s41, s43, 21504
    buffer_load_dwordx4 v[96:99], v1, s[4:7], s41 offen sc1
    s_waitcnt vmcnt(7) lgkmcnt(10)
    v_mfma_f32_32x32x16_bf16 v[124:139], v[188:191], v[68:71], v[124:139]
    v_add_f32 v213, v213, v217
    v_add_f32 v212, v212, v218
    ds_read_b64_tr_b16 v[188:189], v7 offset:32768
    ds_read_b64_tr_b16 v[190:191], v7 offset:33792
    s_waitcnt lgkmcnt(10)
    v_mfma_f32_32x32x16_bf16 v[140:155], v[192:195], v[68:71], v[140:155]
    v_add_f32 v213, v213, v219
    v_add_f32 v212, v212, v220
    ds_read_b64_tr_b16 v[192:193], v7 offset:33280
    ds_read_b64_tr_b16 v[194:195], v7 offset:34304
    s_waitcnt lgkmcnt(10)
    v_mfma_f32_32x32x16_bf16 v[156:171], v[196:199], v[68:71], v[156:171]
    v_add_f32 v213, v213, v221
    v_add_f32 v212, v212, v222
    ds_read_b64_tr_b16 v[196:197], v8 offset:24576
    ds_read_b64_tr_b16 v[198:199], v8 offset:25600
    s_add_u32 s41, s43, 22528
    buffer_load_dwordx4 v[100:103], v1, s[4:7], s41 offen sc1
    s_waitcnt vmcnt(7) lgkmcnt(10)
    v_mfma_f32_32x32x16_bf16 v[124:139], v[200:203], v[72:75], v[124:139]
    v_add_f32 v213, v213, v223
    v_add_f32 v212, v212, v224
    ds_read_b64_tr_b16 v[200:201], v7 offset:34816
    ds_read_b64_tr_b16 v[202:203], v7 offset:35840
    s_waitcnt lgkmcnt(10)
    v_mfma_f32_32x32x16_bf16 v[140:155], v[204:207], v[72:75], v[140:155]
    v_add_f32 v213, v213, v225
    v_mov_b32 v248, v212
    ds_read_b64_tr_b16 v[204:205], v7 offset:35328
    ds_read_b64_tr_b16 v[206:207], v7 offset:36352
    s_waitcnt lgkmcnt(10)
    v_mfma_f32_32x32x16_bf16 v[156:171], v[208:211], v[72:75], v[156:171]
    v_mov_b32 v249, v213
    v_permlane32_swap_b32 v212, v248
    ds_read_b64_tr_b16 v[208:209], v8 offset:26624
    ds_read_b64_tr_b16 v[210:211], v8 offset:27648
    s_add_u32 s41, s43, 23552
    buffer_load_dwordx4 v[104:107], v1, s[4:7], s41 offen sc1
    s_waitcnt vmcnt(7) lgkmcnt(10)
    v_mfma_f32_32x32x16_bf16 v[124:139], v[188:191], v[76:79], v[124:139]
    v_permlane32_swap_b32 v213, v249
    v_add_f32 v212, v212, v248
    ds_read_b64_tr_b16 v[188:189], v7 offset:36864
    ds_read_b64_tr_b16 v[190:191], v7 offset:37888
    s_waitcnt lgkmcnt(10)
    v_mfma_f32_32x32x16_bf16 v[140:155], v[192:195], v[76:79], v[140:155]
    v_add_f32 v213, v213, v249
    v_mul_f32 v244, 0xbb124925, v212
    ds_read_b64_tr_b16 v[192:193], v7 offset:37376
    ds_read_b64_tr_b16 v[194:195], v7 offset:38400
    s_waitcnt lgkmcnt(10)
    v_mfma_f32_32x32x16_bf16 v[156:171], v[196:199], v[76:79], v[156:171]
    v_mul_f32 v245, 0x3b124925, v213
    v_fma_f32 v245, -v244, v244, v245
    ds_read_b64_tr_b16 v[196:197], v8 offset:28672
    ds_read_b64_tr_b16 v[198:199], v8 offset:29696
    s_add_u32 s41, s43, 24576
    buffer_load_dwordx4 v[108:111], v1, s[4:7], s41 offen sc1
    s_waitcnt vmcnt(7) lgkmcnt(10)
    v_mfma_f32_32x32x16_bf16 v[124:139], v[200:203], v[80:83], v[124:139]
    v_max_f32 v245, 0, v245
    v_add_f32 v248, 0x3727c5ac, v245
    ds_read_b64_tr_b16 v[200:201], v7 offset:38912
    ds_read_b64_tr_b16 v[202:203], v7 offset:39936
    s_waitcnt lgkmcnt(10)
    v_mfma_f32_32x32x16_bf16 v[140:155], v[204:207], v[80:83], v[140:155]
    v_rcp_f32 v249, v248
    s_nop 0
    v_mul_f32 v249, v249, v245
    ds_read_b64_tr_b16 v[204:205], v7 offset:39424
    ds_read_b64_tr_b16 v[206:207], v7 offset:40448
    s_waitcnt lgkmcnt(10)
    v_mfma_f32_32x32x16_bf16 v[156:171], v[208:211], v[80:83], v[156:171]
    v_add_f32 v249, 0x3727c5ac, v249
    v_mul_f32 v248, v248, v249
    ds_read_b64_tr_b16 v[208:209], v8 offset:30720
    ds_read_b64_tr_b16 v[210:211], v8 offset:31744
    s_add_u32 s41, s43, 25600
    buffer_load_dwordx4 v[112:115], v1, s[4:7], s41 offen sc1
    s_waitcnt vmcnt(7) lgkmcnt(10)
    v_mfma_f32_32x32x16_bf16 v[124:139], v[188:191], v[84:87], v[124:139]
    v_rsq_f32 v246, v248
    v_sqrt_f32 v247, v248
    ds_read_b64_tr_b16 v[188:189], v7 offset:40960
    ds_read_b64_tr_b16 v[190:191], v7 offset:41984
    s_waitcnt lgkmcnt(10)
    v_mfma_f32_32x32x16_bf16 v[140:155], v[192:195], v[84:87], v[140:155]
    v_mul_f32 v250, 0xc0135761, v246
    v_mul_f32 v248, v246, v246
    ds_read_b64_tr_b16 v[192:193], v7 offset:41472
    ds_read_b64_tr_b16 v[194:195], v7 offset:42496
    s_waitcnt lgkmcnt(10)
    v_mfma_f32_32x32x16_bf16 v[156:171], v[196:199], v[84:87], v[156:171]
    v_mul_f32 v251, 0x3d372713, v250
    v_mul_f32 v251, v251, v248
    ds_read_b64_tr_b16 v[196:197], v8 offset:32768
    ds_read_b64_tr_b16 v[198:199], v8 offset:33792
    s_add_u32 s41, s43, 26624
    buffer_load_dwordx4 v[116:119], v1, s[4:7], s41 offen sc1
    s_waitcnt vmcnt(7) lgkmcnt(10)
    v_mfma_f32_32x32x16_bf16 v[124:139], v[200:203], v[88:91], v[124:139]
    v_cvt_pk_bf16_f32 v241, v244, v247
    v_mov_b32 v243, 0
    ds_read_b64_tr_b16 v[200:201], v7 offset:43008
    ds_read_b64_tr_b16 v[202:203], v7 offset:44032
    s_waitcnt lgkmcnt(10)
    v_mfma_f32_32x32x16_bf16 v[140:155], v[204:207], v[88:91], v[140:155]
    v_lshlrev_b32 v248, 16, v241
    v_and_b32 v249, 0xffff0000, v241
    ds_read_b64_tr_b16 v[204:205], v7 offset:43520
    ds_read_b64_tr_b16 v[206:207], v7 offset:44544
    s_waitcnt lgkmcnt(10)
    v_mfma_f32_32x32x16_bf16 v[156:171], v[208:211], v[88:91], v[156:171]
    v_sub_f32 v240, v244, v248
    v_sub_f32 v249, v247, v249
    ds_read_b64_tr_b16 v[208:209], v8 offset:34816
    ds_read_b64_tr_b16 v[210:211], v8 offset:35840
    s_add_u32 s41, s43, 27648
    buffer_load_dwordx4 v[120:123], v1, s[4:7], s41 offen sc1
    s_waitcnt vmcnt(7) lgkmcnt(10)
    v_mfma_f32_32x32x16_bf16 v[124:139], v[188:191], v[92:95], v[124:139]
    v_cvt_pk_bf16_f32 v240, v248, v240
    v_cvt_pk_bf16_f32 v242, v249, v243
    ds_read_b64_tr_b16 v[188:189], v7 offset:45056
    ds_read_b64_tr_b16 v[190:191], v7 offset:46080
    s_waitcnt lgkmcnt(10)
    v_mfma_f32_32x32x16_bf16 v[140:155], v[192:195], v[92:95], v[140:155]
    ds_read_b64_tr_b16 v[192:193], v7 offset:45568
    ds_read_b64_tr_b16 v[194:195], v7 offset:46592
    s_waitcnt lgkmcnt(10)
    v_mfma_f32_32x32x16_bf16 v[156:171], v[196:199], v[92:95], v[156:171]
    ds_read_b64_tr_b16 v[196:197], v8 offset:36864
    ds_read_b64_tr_b16 v[198:199], v8 offset:37888
    s_waitcnt vmcnt(6) lgkmcnt(10)
    v_mfma_f32_32x32x16_bf16 v[124:139], v[200:203], v[96:99], v[124:139]
    ds_read_b64_tr_b16 v[200:201], v7 offset:47104
    ds_read_b64_tr_b16 v[202:203], v7 offset:48128
    s_waitcnt lgkmcnt(10)
    v_mfma_f32_32x32x16_bf16 v[140:155], v[204:207], v[96:99], v[140:155]
    ds_read_b64_tr_b16 v[204:205], v7 offset:47616
    ds_read_b64_tr_b16 v[206:207], v7 offset:48640
    s_waitcnt lgkmcnt(10)
    v_mfma_f32_32x32x16_bf16 v[156:171], v[208:211], v[96:99], v[156:171]
    ds_read_b64_tr_b16 v[208:209], v8 offset:38912
    ds_read_b64_tr_b16 v[210:211], v8 offset:39936
    s_waitcnt vmcnt(5) lgkmcnt(10)
    v_mfma_f32_32x32x16_bf16 v[124:139], v[188:191], v[100:103], v[124:139]
    ds_read_b64_tr_b16 v[188:189], v7 offset:49152
    ds_read_b64_tr_b16 v[190:191], v7 offset:50176
    s_waitcnt lgkmcnt(10)
    v_mfma_f32_32x32x16_bf16 v[140:155], v[192:195], v[100:103], v[140:155]
    ds_read_b64_tr_b16 v[192:193], v7 offset:49664
    ds_read_b64_tr_b16 v[194:195], v7 offset:50688
    s_waitcnt lgkmcnt(10)
    v_mfma_f32_32x32x16_bf16 v[156:171], v[196:199], v[100:103], v[156:171]
    ds_read_b64_tr_b16 v[196:197], v8 offset:40960
    ds_read_b64_tr_b16 v[198:199], v8 offset:41984
    s_waitcnt vmcnt(4) lgkmcnt(10)
    v_mfma_f32_32x32x16_bf16 v[124:139], v[200:203], v[104:107], v[124:139]
    ds_read_b64_tr_b16 v[200:201], v7 offset:51200
    ds_read_b64_tr_b16 v[202:203], v7 offset:52224
    s_waitcnt lgkmcnt(10)
    v_mfma_f32_32x32x16_bf16 v[140:155], v[204:207], v[104:107], v[140:155]
    ds_read_b64_tr_b16 v[204:205], v7 offset:51712
    ds_read_b64_tr_b16 v[206:207], v7 offset:52736
    s_waitcnt lgkmcnt(10)
    v_mfma_f32_32x32x16_bf16 v[156:171], v[208:211], v[104:107], v[156:171]
    ds_read_b64_tr_b16 v[208:209], v8 offset:43008
    ds_read_b64_tr_b16 v[210:211], v8 offset:44032
    s_waitcnt vmcnt(3) lgkmcnt(10)
    v_mfma_f32_32x32x16_bf16 v[124:139], v[188:191], v[108:111], v[124:139]
    ds_read_b64_tr_b16 v[188:189], v7 offset:53248
    ds_read_b64_tr_b16 v[190:191], v7 offset:54272
    s_waitcnt lgkmcnt(10)
    v_mfma_f32_32x32x16_bf16 v[140:155], v[192:195], v[108:111], v[140:155]
    ds_read_b64_tr_b16 v[192:193], v7 offset:53760
    ds_read_b64_tr_b16 v[194:195], v7 offset:54784
    s_waitcnt lgkmcnt(10)
    v_mfma_f32_32x32x16_bf16 v[156:171], v[196:199], v[108:111], v[156:171]
    ds_read_b64_tr_b16 v[196:197], v8 offset:45056
    ds_read_b64_tr_b16 v[198:199], v8 offset:46080
    s_waitcnt vmcnt(2) lgkmcnt(10)
    v_mfma_f32_32x32x16_bf16 v[124:139], v[200:203], v[112:115], v[124:139]
    ds_read_b64_tr_b16 v[200:201], v7 offset:55296
    ds_read_b64_tr_b16 v[202:203], v7 offset:56320
    s_waitcnt lgkmcnt(10)
    v_mfma_f32_32x32x16_bf16 v[140:155], v[204:207], v[112:115], v[140:155]
    ds_read_b64_tr_b16 v[204:205], v7 offset:55808
    ds_read_b64_tr_b16 v[206:207], v7 offset:56832
    s_waitcnt lgkmcnt(10)
    v_mfma_f32_32x32x16_bf16 v[156:171], v[208:211], v[112:115], v[156:171]
    ds_read_b64_tr_b16 v[208:209], v8 offset:47104
    ds_read_b64_tr_b16 v[210:211], v8 offset:48128
    s_waitcnt vmcnt(1) lgkmcnt(10)
    v_mfma_f32_32x32x16_bf16 v[124:139], v[188:191], v[116:119], v[124:139]
    s_waitcnt lgkmcnt(8)
    v_mfma_f32_32x32x16_bf16 v[140:155], v[192:195], v[116:119], v[140:155]
    s_waitcnt lgkmcnt(6)
    v_mfma_f32_32x32x16_bf16 v[156:171], v[196:199], v[116:119], v[156:171]
    s_waitcnt vmcnt(0) lgkmcnt(4)
    v_mfma_f32_32x32x16_bf16 v[124:139], v[200:203], v[120:123], v[124:139]
    s_waitcnt lgkmcnt(2)
    v_mfma_f32_32x32x16_bf16 v[140:155], v[204:207], v[120:123], v[140:155]
    s_waitcnt lgkmcnt(0)
    v_mfma_f32_32x32x16_bf16 v[156:171], v[208:211], v[120:123], v[156:171]
    v_mfma_f32_32x32x16_bf16 v[124:139], a[224:227], v[240:243], v[124:139]
    v_mfma_f32_32x32x16_bf16 v[140:155], a[228:231], v[240:243], v[140:155]
    v_mfma_f32_32x32x16_bf16 v[156:171], a[232:235], v[240:243], v[156:171]
    ds_read_b64_tr_b16 a[116:117], v236 offset:0
    ds_read_b64_tr_b16 a[118:119], v236 offset:512
    ds_read_b64_tr_b16 a[8:9], v236 offset:1024
    ds_read_b64_tr_b16 a[10:11], v236 offset:1536
    ds_read_b64_tr_b16 a[120:121], v236 offset:2048
    ds_read_b64_tr_b16 a[122:123], v236 offset:2560
    s_waitcnt lgkmcnt(0)
    s_barrier
    s_add_u32 s46, s74, s95
    s_lshl_b32 s47, s21, 11
    s_sub_u32 s45, s46, s47
    s_add_u32 s45, s45, 57344
    s_add_u32 s47, s47, s73
    s_add_u32 s47, s47, s97
    s_add_u32 s58, s75, 16384
    s_add_u32 s59, s75, 24576
    ds_read_b64_tr_b16 v[188:189], v7 offset:57856
    ds_read_b64_tr_b16 v[190:191], v7 offset:58880
    ds_read_b64_tr_b16 v[192:193], v7 offset:59904
    ds_read_b64_tr_b16 v[194:195], v7 offset:60928
    ds_read_b64_tr_b16 v[196:197], v7 offset:61952
    ds_read_b64_tr_b16 v[198:199], v7 offset:62976
    ds_read_b64_tr_b16 v[200:201], v7 offset:64000
    ds_read_b64_tr_b16 v[202:203], v7 offset:65024
    ds_read_b64_tr_b16 v[204:205], v8 offset:512
    ds_read_b64_tr_b16 v[206:207], v8 offset:1536
    s_waitcnt lgkmcnt(6)
    v_mfma_f32_32x32x16_bf16 v[172:187], v[188:191], v[12:15], 0
    s_add_u32 s40, s82, 344064
    s_add_u32 m0, s76, 0
    s_nop 0
    buffer_load_dwordx4 v238, s[52:55], s40 offen lds
    ds_read_b64_tr_b16 v[208:209], v8 offset:2560
    ds_read_b64_tr_b16 v[210:211], v8 offset:3584
    v_mfma_f32_32x32x16_bf16 v[172:187], v[192:195], v[16:19], v[172:187]
    v_mul_f32 v212, v124, v124
    v_mul_f32 v213, v125, v125
    v_mul_f32 v214, v126, v126
    v_mul_f32 v215, v127, v127
    s_add_u32 s40, s83, 344064
    s_add_u32 m0, s76, 1024
    s_nop 0
    buffer_load_dwordx4 v238, s[52:55], s40 offen lds
    ds_read_b64_tr_b16 v[188:189], v8 offset:4608
    ds_read_b64_tr_b16 v[190:191], v8 offset:5632
    s_waitcnt lgkmcnt(6)
    v_mfma_f32_32x32x16_bf16 v[172:187], v[196:199], v[20:23], v[172:187]
    v_fma_f32 v212, v212, v251, v250
    v_fma_f32 v213, v213, v251, v250
    v_fma_f32 v214, v214, v251, v250
    v_fma_f32 v215, v215, v251, v250
    s_add_u32 s40, s82, 458752
    s_add_u32 m0, s76, 2048
    s_nop 0
    buffer_load_dwordx4 v238, s[52:55], s40 offen lds
    ds_read_b64_tr_b16 v[192:193], v8 offset:6656
    ds_read_b64_tr_b16 v[194:195], v8 offset:7680
    v_mfma_f32_32x32x16_bf16 v[172:187], v[200:203], v[24:27], v[172:187]
    v_mul_f32 v212, v212, v124
    v_mul_f32 v213, v213, v125
    v_mul_f32 v214, v214, v126
    v_mul_f32 v215, v215, v127
    v_exp_f32 v212, v212
    s_add_u32 s40, s83, 458752
    s_add_u32 m0, s77, 0
    s_nop 0
    buffer_load_dwordx4 v238, s[52:55], s40 offen lds
    ds_read_b64_tr_b16 v[196:197], v8 offset:8704
    ds_read_b64_tr_b16 v[198:199], v8 offset:9728
    s_waitcnt lgkmcnt(6)
    v_mfma_f32_32x32x16_bf16 v[172:187], v[204:207], v[28:31], v[172:187]
    v_exp_f32 v213, v213
    v_exp_f32 v214, v214
    v_exp_f32 v215, v215
    v_fma_f32 v212, v212, v247, v247
    s_add_u32 s40, s82, 573440
    s_add_u32 m0, s77, 1024
    s_nop 0
    buffer_load_dwordx4 v238, s[52:55], s40 offen lds
    ds_read_b64_tr_b16 v[200:201], v8 offset:10752
    ds_read_b64_tr_b16 v[202:203], v8 offset:11776
    v_mfma_f32_32x32x16_bf16 v[172:187], v[208:211], v[32:35], v[172:187]
    v_fma_f32 v213, v213, v247, v247
    v_fma_f32 v214, v214, v247, v247
    v_fma_f32 v215, v215, v247, v247
    v_rcp_f32 v212, v212
    v_rcp_f32 v213, v213
    s_add_u32 s40, s83, 573440
    s_add_u32 m0, s77, 2048
    s_nop 0
    buffer_load_dwordx4 v238, s[52:55], s40 offen lds
    ds_read_b64_tr_b16 v[204:205], v8 offset:12800
    ds_read_b64_tr_b16 v[206:207], v8 offset:13824
    s_waitcnt lgkmcnt(6)
    v_mfma_f32_32x32x16_bf16 v[172:187], v[188:191], v[36:39], v[172:187]
    v_rcp_f32 v214, v214
    v_rcp_f32 v215, v215
    v_mul_f32 v124, v124, v212
    v_mul_f32 v125, v125, v213
    s_add_u32 s40, s82, 688128
    s_add_u32 m0, s77, 3072
    s_nop 0
    buffer_load_dwordx4 v238, s[52:55], s40 offen lds
    ds_read_b64_tr_b16 v[208:209], v8 offset:14848
    ds_read_b64_tr_b16 v[210:211], v8 offset:15872
    v_mfma_f32_32x32x16_bf16 v[172:187], v[192:195], v[40:43], v[172:187]
    v_mul_f32 v126, v126, v214
    v_mul_f32 v127, v127, v215
    v_cvt_pk_bf16_f32 v220, v124, v125
    v_cvt_pk_bf16_f32 v221, v126, v127
    s_add_u32 s40, s83, 688128
    s_add_u32 m0, s77, 4096
    s_nop 0
    buffer_load_dwordx4 v238, s[52:55], s40 offen lds
    ds_read_b64_tr_b16 v[188:189], v8 offset:16896
    ds_read_b64_tr_b16 v[190:191], v8 offset:17920
    s_waitcnt lgkmcnt(6)
    v_mfma_f32_32x32x16_bf16 v[172:187], v[196:199], v[44:47], v[172:187]
    v_mul_f32 v212, v128, v128
    v_mul_f32 v213, v129, v129
    v_mul_f32 v214, v130, v130
    v_mul_f32 v215, v131, v131
    v_fma_f32 v212, v212, v251, v250
    s_add_u32 s40, s82, 802816
    s_add_u32 m0, s77, 5120
    s_nop 0
    buffer_load_dwordx4 v238, s[52:55], s40 offen lds
    ds_read_b64_tr_b16 v[192:193], v8 offset:18944
    ds_read_b64_tr_b16 v[194:195], v8 offset:19968
    v_mfma_f32_32x32x16_bf16 v[172:187], v[200:203], v[48:51], v[172:187]
    v_fma_f32 v213, v213, v251, v250
    v_fma_f32 v214, v214, v251, v250
    v_fma_f32 v215, v215, v251, v250
    v_mul_f32 v212, v212, v128
    s_add_u32 s40, s83, 802816
    s_add_u32 m0, s77, 6144
    s_nop 0
    buffer_load_dwordx4 v238, s[52:55], s40 offen lds
    ds_read_b64_tr_b16 v[196:197], v8 offset:20992
    ds_read_b64_tr_b16 v[198:199], v8 offset:22016
    s_waitcnt lgkmcnt(6)
    v_mfma_f32_32x32x16_bf16 v[172:187], v[204:207], v[52:55], v[172:187]
    v_mul_f32 v213, v213, v129
    v_mul_f32 v214, v214, v130
    v_mul_f32 v215, v215, v131
    v_exp_f32 v212, v212
    v_exp_f32 v213, v213
    s_add_u32 s40, s82, 917504
    s_add_u32 m0, s77, 7168
    s_nop 0
    buffer_load_dwordx4 v238, s[52:55], s40 offen lds
    ds_read_b64_tr_b16 v[200:201], v8 offset:23040
    ds_read_b64_tr_b16 v[202:203], v8 offset:24064
    v_mfma_f32_32x32x16_bf16 v[172:187], v[208:211], v[56:59], v[172:187]
    v_exp_f32 v214, v214
    v_exp_f32 v215, v215
    v_fma_f32 v212, v212, v247, v247
    v_fma_f32 v213, v213, v247, v247
    s_add_u32 s40, s83, 917504
    s_add_u32 m0, s77, 8192
    s_nop 0
    buffer_load_dwordx4 v238, s[52:55], s40 offen lds
    ds_read_b64_tr_b16 v[204:205], v8 offset:25088
    ds_read_b64_tr_b16 v[206:207], v8 offset:26112
    s_waitcnt lgkmcnt(6)
    v_mfma_f32_32x32x16_bf16 v[172:187], v[188:191], v[60:63], v[172:187]
    v_fma_f32 v214, v214, v247, v247
    v_fma_f32 v215, v215, v247, v247
    v_rcp_f32 v212, v212
    v_rcp_f32 v213, v213
    s_add_u32 s40, s82, 1032192
    s_add_u32 m0, s77, 9216
    s_nop 0
    buffer_load_dwordx4 v238, s[52:55], s40 offen lds
    ds_read_b64_tr_b16 v[208:209], v8 offset:27136
    ds_read_b64_tr_b16 v[210:211], v8 offset:28160
    v_mfma_f32_32x32x16_bf16 v[172:187], v[192:195], v[64:67], v[172:187]
    v_rcp_f32 v214, v214
    v_rcp_f32 v215, v215
    v_mul_f32 v128, v128, v212
    v_mul_f32 v129, v129, v213
    v_mul_f32 v130, v130, v214
    s_add_u32 s40, s83, 1032192
    s_add_u32 m0, s77, 10240
    s_nop 0
    buffer_load_dwordx4 v238, s[52:55], s40 offen lds
    ds_read_b64_tr_b16 v[188:189], v8 offset:29184
    ds_read_b64_tr_b16 v[190:191], v8 offset:30208
    s_waitcnt lgkmcnt(6)
    v_mfma_f32_32x32x16_bf16 v[172:187], v[196:199], v[68:71], v[172:187]
    v_mul_f32 v131, v131, v215
    v_cvt_pk_bf16_f32 v222, v128, v129
    v_cvt_pk_bf16_f32 v223, v130, v131
    v_mul_f32 v212, v132, v132
    s_waitcnt vmcnt(13)
    ds_read_b64_tr_b16 a[12:13], v236 offset:0
    ds_read_b64_tr_b16 a[14:15], v236 offset:512
    s_add_u32 s40, s82, 1146880
    s_add_u32 m0, s77, 11264
    s_nop 0
    buffer_load_dwordx4 v238, s[52:55], s40 offen lds
    ds_read_b64_tr_b16 v[192:193], v8 offset:31232
    ds_read_b64_tr_b16 v[194:195], v8 offset:32256
    v_mfma_f32_32x32x16_bf16 v[172:187], v[200:203], v[72:75], v[172:187]
    v_mul_f32 v213, v133, v133
    v_mul_f32 v214, v134, v134
    v_mul_f32 v215, v135, v135
    v_fma_f32 v212, v212, v251, v250
    v_fma_f32 v213, v213, v251, v250
    s_waitcnt vmcnt(13)
    ds_read_b64_tr_b16 a[124:125], v236 offset:1024
    ds_read_b64_tr_b16 a[126:127], v236 offset:1536
    s_add_u32 s40, s83, 1146880
    s_add_u32 m0, s77, 12288
    s_nop 0
    buffer_load_dwordx4 v238, s[52:55], s40 offen lds
    ds_read_b64_tr_b16 v[196:197], v8 offset:33280
    ds_read_b64_tr_b16 v[198:199], v8 offset:34304
    s_waitcnt lgkmcnt(10)
    v_mfma_f32_32x32x16_bf16 v[172:187], v[204:207], v[76:79], v[172:187]
    v_fma_f32 v214, v214, v251, v250
    v_fma_f32 v215, v215, v251, v250
    v_mul_f32 v212, v212, v132
    v_mul_f32 v213, v213, v133
    s_waitcnt vmcnt(13)
    ds_read_b64_tr_b16 a[16:17], v236 offset:2048
    ds_read_b64_tr_b16 a[18:19], v236 offset:2560
    s_add_u32 s40, s82, 1261568
    s_add_u32 m0, s77, 13312
    s_nop 0
    buffer_load_dwordx4 v238, s[52:55], s40 offen lds
    ds_read_b64_tr_b16 v[200:201], v8 offset:35328
    ds_read_b64_tr_b16 v[202:203], v8 offset:36352
    v_mfma_f32_32x32x16_bf16 v[172:187], v[208:211], v[80:83], v[172:187]
    v_mul_f32 v214, v214, v134
    v_mul_f32 v215, v215, v135
    v_exp_f32 v212, v212
    v_exp_f32 v213, v213
    s_waitcnt vmcnt(13)
    ds_read_b64_tr_b16 a[128:129], v237 offset:0
    ds_read_b64_tr_b16 a[130:131], v237 offset:512
    s_waitcnt lgkmcnt(12)
    s_add_u32 s40, s83, 1261568
    s_add_u32 m0, s76, 0
    s_nop 0
    buffer_load_dwordx4 v238, s[52:55], s40 offen lds
    ds_read_b64_tr_b16 v[204:205], v8 offset:37376
    ds_read_b64_tr_b16 v[206:207], v8 offset:38400
    s_waitcnt lgkmcnt(12)
    v_mfma_f32_32x32x16_bf16 v[172:187], v[188:191], v[84:87], v[172:187]
    v_exp_f32 v214, v214
    v_exp_f32 v215, v215
    v_fma_f32 v212, v212, v247, v247
    v_fma_f32 v213, v213, v247, v247
    v_fma_f32 v214, v214, v247, v247
    s_waitcnt vmcnt(13)
    ds_read_b64_tr_b16 a[20:21], v237 offset:1024
    ds_read_b64_tr_b16 a[22:23], v237 offset:1536
    s_waitcnt lgkmcnt(12)
    s_add_u32 s40, s82, 1376256
    s_add_u32 m0, s76, 1024
    s_nop 0
    buffer_load_dwordx4 v238, s[52:55], s40 offen lds
    ds_read_b64_tr_b16 v[208:209], v8 offset:39424
    ds_read_b64_tr_b16 v[210:211], v8 offset:40448
    v_mfma_f32_32x32x16_bf16 v[172:187], v[192:195], v[88:91], v[172:187]
    v_fma_f32 v215, v215, v247, v247
    v_rcp_f32 v212, v212
    v_rcp_f32 v213, v213
    v_rcp_f32 v214, v214
    s_waitcnt vmcnt(13)
    ds_read_b64_tr_b16 a[132:133], v237 offset:2048
    ds_read_b64_tr_b16 a[134:135], v237 offset:2560
    s_waitcnt lgkmcnt(12)
    s_add_u32 s40, s83, 1376256
    s_add_u32 m0, s76, 2048
    s_nop 0
    buffer_load_dwordx4 v238, s[52:55], s40 offen lds
    ds_read_b64_tr_b16 v[188:189], v8 offset:41472
    ds_read_b64_tr_b16 v[190:191], v8 offset:42496
    s_waitcnt lgkmcnt(12)
    v_mfma_f32_32x32x16_bf16 v[172:187], v[196:199], v[92:95], v[172:187]
    v_rcp_f32 v215, v215
    v_mul_f32 v132, v132, v212
    v_mul_f32 v133, v133, v213
    v_mul_f32 v134, v134, v214
    v_mul_f32 v135, v135, v215
    s_waitcnt vmcnt(13)
    ds_read_b64_tr_b16 a[24:25], v237 offset:3072
    ds_read_b64_tr_b16 a[26:27], v237 offset:3584
    s_waitcnt lgkmcnt(12)
    s_add_u32 s40, s82, 1490944
    s_add_u32 m0, s77, 0
    s_nop 0
    buffer_load_dwordx4 v238, s[52:55], s40 offen lds
    ds_read_b64_tr_b16 v[192:193], v8 offset:43520
    ds_read_b64_tr_b16 v[194:195], v8 offset:44544
    v_mfma_f32_32x32x16_bf16 v[172:187], v[200:203], v[96:99], v[172:187]
    v_cvt_pk_bf16_f32 v224, v132, v133
    v_cvt_pk_bf16_f32 v225, v134, v135
    v_mul_f32 v212, v136, v136
    v_mul_f32 v213, v137, v137
    s_waitcnt vmcnt(13)
    ds_read_b64_tr_b16 a[136:137], v237 offset:4096
    ds_read_b64_tr_b16 a[138:139], v237 offset:4608
    s_waitcnt lgkmcnt(12)
    s_add_u32 s40, s83, 1490944
    s_add_u32 m0, s77, 1024
    s_nop 0
    buffer_load_dwordx4 v238, s[52:55], s40 offen lds
    ds_read_b64_tr_b16 v[196:197], v8 offset:45568
    ds_read_b64_tr_b16 v[198:199], v8 offset:46592
    s_waitcnt lgkmcnt(12)
    v_mfma_f32_32x32x16_bf16 v[172:187], v[204:207], v[100:103], v[172:187]
    v_mul_f32 v214, v138, v138
    v_mul_f32 v215, v139, v139
    v_fma_f32 v212, v212, v251, v250
    v_fma_f32 v213, v213, v251, v250
    s_waitcnt vmcnt(13)
    ds_read_b64_tr_b16 a[28:29], v237 offset:5120
    ds_read_b64_tr_b16 a[30:31], v237 offset:5632
    s_waitcnt lgkmcnt(12)
    s_add_u32 s40, s82, 57344
    s_add_u32 m0, s77, 2048
    s_nop 0
    buffer_load_dwordx4 v238, s[52:55], s40 offen lds
    ds_read_b64_tr_b16 v[200:201], v8 offset:47616
    ds_read_b64_tr_b16 v[202:203], v8 offset:48640
    v_mfma_f32_32x32x16_bf16 v[172:187], v[208:211], v[104:107], v[172:187]
    v_fma_f32 v214, v214, v251, v250
    v_fma_f32 v215, v215, v251, v250
    v_mul_f32 v212, v212, v136
    v_mul_f32 v213, v213, v137
    v_mul_f32 v214, v214, v138
    s_waitcnt vmcnt(13)
    ds_read_b64_tr_b16 a[140:141], v237 offset:6144
    ds_read_b64_tr_b16 a[142:143], v237 offset:6656
    s_waitcnt lgkmcnt(12)
    s_add_u32 s40, s83, 57344
    s_add_u32 m0, s77, 3072
    s_nop 0
    buffer_load_dwordx4 v238, s[52:55], s40 offen lds
    s_waitcnt lgkmcnt(10)
    v_mfma_f32_32x32x16_bf16 v[172:187], v[188:191], v[108:111], v[172:187]
    v_mul_f32 v215, v215, v139
    v_exp_f32 v212, v212
    v_exp_f32 v213, v213
    v_exp_f32 v214, v214
    s_waitcnt vmcnt(13)
    ds_read_b64_tr_b16 a[32:33], v237 offset:7168
    ds_read_b64_tr_b16 a[34:35], v237 offset:7680
    s_waitcnt lgkmcnt(10)
    s_add_u32 s40, s82, 172032
    s_add_u32 m0, s77, 4096
    s_nop 0
    buffer_load_dwordx4 v238, s[52:55], s40 offen lds
    v_mfma_f32_32x32x16_bf16 v[172:187], v[192:195], v[112:115], v[172:187]
    v_exp_f32 v215, v215
    v_fma_f32 v212, v212, v247, v247
    v_fma_f32 v213, v213, v247, v247
    v_fma_f32 v214, v214, v247, v247
    v_fma_f32 v215, v215, v247, v247
    s_waitcnt vmcnt(13)
    ds_read_b64_tr_b16 a[144:145], v237 offset:8192
    ds_read_b64_tr_b16 a[146:147], v237 offset:8704
    s_waitcnt lgkmcnt(8)
    s_add_u32 s40, s83, 172032
    s_add_u32 m0, s77, 5120
    s_nop 0
    buffer_load_dwordx4 v238, s[52:55], s40 offen lds
    s_waitcnt lgkmcnt(6)
    v_mfma_f32_32x32x16_bf16 v[172:187], v[196:199], v[116:119], v[172:187]
    v_rcp_f32 v212, v212
    v_rcp_f32 v213, v213
    v_rcp_f32 v214, v214
    v_rcp_f32 v215, v215
    s_waitcnt vmcnt(13)
    ds_read_b64_tr_b16 a[36:37], v237 offset:9216
    ds_read_b64_tr_b16 a[38:39], v237 offset:9728
    s_waitcnt lgkmcnt(6)
    s_add_u32 s40, s82, 286720
    s_add_u32 m0, s77, 6144
    s_nop 0
    buffer_load_dwordx4 v238, s[52:55], s40 offen lds
    v_mfma_f32_32x32x16_bf16 v[172:187], v[200:203], v[120:123], v[172:187]
    v_mul_f32 v136, v136, v212
    v_mul_f32 v137, v137, v213
    v_mul_f32 v138, v138, v214
    v_mul_f32 v139, v139, v215
    s_waitcnt vmcnt(13)
    ds_read_b64_tr_b16 a[148:149], v237 offset:10240
    ds_read_b64_tr_b16 a[150:151], v237 offset:10752
    s_waitcnt lgkmcnt(6)
    s_add_u32 s40, s83, 286720
    s_add_u32 m0, s77, 7168
    s_nop 0
    buffer_load_dwordx4 v238, s[52:55], s40 offen lds
    v_mfma_f32_32x32x16_bf16 v[172:187], a[236:239], v[240:243], v[172:187]
    v_cvt_pk_bf16_f32 v226, v136, v137
    v_cvt_pk_bf16_f32 v227, v138, v139
    buffer_store_dwordx4 v[220:223], v1, s[4:7], s46 offen offset:0
    buffer_store_dwordx4 v[224:227], v1, s[4:7], s46 offen offset:1024
    v_mov_b32 v188, v250
    v_mov_b32 v189, v250
    v_mov_b32 v190, v251
    v_mov_b32 v191, v251
    v_mov_b32 v192, v247
    v_mov_b32 v193, v247
    v_pk_mul_f32 v[212:213], v[140:141], v[140:141]
    v_pk_mul_f32 v[214:215], v[142:143], v[142:143]
    v_pk_mul_f32 v[216:217], v[144:145], v[144:145]
    v_pk_mul_f32 v[218:219], v[146:147], v[146:147]
    v_pk_fma_f32 v[212:213], v[212:213], v[190:191], v[188:189]
    v_pk_fma_f32 v[214:215], v[214:215], v[190:191], v[188:189]
    s_waitcnt vmcnt(15)
    ds_read_b64_tr_b16 a[40:41], v237 offset:11264
    ds_read_b64_tr_b16 a[42:43], v237 offset:11776
    s_waitcnt lgkmcnt(6)
    s_add_u32 s40, s82, 401408
    s_add_u32 m0, s77, 8192
    s_nop 0
    buffer_load_dwordx4 v238, s[52:55], s40 offen lds
    v_pk_fma_f32 v[216:217], v[216:217], v[190:191], v[188:189]
    v_pk_fma_f32 v[218:219], v[218:219], v[190:191], v[188:189]
    v_pk_mul_f32 v[212:213], v[212:213], v[140:141]
    v_pk_mul_f32 v[214:215], v[214:215], v[142:143]
    v_pk_mul_f32 v[216:217], v[216:217], v[144:145]
    v_pk_mul_f32 v[218:219], v[218:219], v[146:147]
    s_waitcnt vmcnt(15)
    ds_read_b64_tr_b16 a[152:153], v237 offset:12288
    ds_read_b64_tr_b16 a[154:155], v237 offset:12800
    s_waitcnt lgkmcnt(6)
    s_add_u32 s40, s83, 401408
    s_add_u32 m0, s77, 9216
    s_nop 0
    buffer_load_dwordx4 v238, s[52:55], s40 offen lds
    v_exp_f32 v212, v212
    v_exp_f32 v213, v213
    v_exp_f32 v214, v214
    v_exp_f32 v215, v215
    v_exp_f32 v216, v216
    v_exp_f32 v217, v217
    s_waitcnt vmcnt(15)
    ds_read_b64_tr_b16 a[44:45], v237 offset:13312
    ds_read_b64_tr_b16 a[46:47], v237 offset:13824
    s_waitcnt lgkmcnt(6)
    s_add_u32 s40, s82, 516096
    s_add_u32 m0, s77, 10240
    s_nop 0
    buffer_load_dwordx4 v238, s[52:55], s40 offen lds
    v_exp_f32 v218, v218
    v_exp_f32 v219, v219
    v_pk_fma_f32 v[212:213], v[212:213], v[192:193], v[192:193]
    v_pk_fma_f32 v[214:215], v[214:215], v[192:193], v[192:193]
    v_pk_fma_f32 v[216:217], v[216:217], v[192:193], v[192:193]
    v_pk_fma_f32 v[218:219], v[218:219], v[192:193], v[192:193]
    s_waitcnt vmcnt(15)
    ds_read_b64_tr_b16 a[156:157], v236 offset:0
    ds_read_b64_tr_b16 a[158:159], v236 offset:512
    s_waitcnt lgkmcnt(6)
    s_add_u32 s40, s83, 516096
    s_add_u32 m0, s77, 11264
    s_nop 0
    buffer_load_dwordx4 v238, s[52:55], s40 offen lds
    v_rcp_f32 v212, v212
    v_rcp_f32 v213, v213
    v_rcp_f32 v214, v214
    v_rcp_f32 v215, v215
    v_rcp_f32 v216, v216
    v_rcp_f32 v217, v217
    s_waitcnt vmcnt(15)
    ds_read_b64_tr_b16 a[48:49], v236 offset:1024
    ds_read_b64_tr_b16 a[50:51], v236 offset:1536
    s_waitcnt lgkmcnt(6)
    s_add_u32 s40, s82, 630784
    s_add_u32 m0, s77, 12288
    s_nop 0
    buffer_load_dwordx4 v238, s[52:55], s40 offen lds
    v_rcp_f32 v218, v218
    v_rcp_f32 v219, v219
    v_pk_mul_f32 v[140:141], v[140:141], v[212:213]
    v_pk_mul_f32 v[142:143], v[142:143], v[214:215]
    v_pk_mul_f32 v[144:145], v[144:145], v[216:217]
    v_pk_mul_f32 v[146:147], v[146:147], v[218:219]
    s_waitcnt vmcnt(15)
    ds_read_b64_tr_b16 a[160:161], v236 offset:2048
    ds_read_b64_tr_b16 a[162:163], v236 offset:2560
    s_waitcnt lgkmcnt(6)
    s_add_u32 s40, s83, 630784
    s_add_u32 m0, s77, 13312
    s_nop 0
    buffer_load_dwordx4 v238, s[52:55], s40 offen lds
    v_cvt_pk_bf16_f32 v228, v140, v141
    v_cvt_pk_bf16_f32 v229, v142, v143
    v_cvt_pk_bf16_f32 v230, v144, v145
    v_cvt_pk_bf16_f32 v231, v146, v147
    v_pk_mul_f32 v[212:213], v[148:149], v[148:149]
    v_pk_mul_f32 v[214:215], v[150:151], v[150:151]
    s_waitcnt vmcnt(15)
    ds_read_b64_tr_b16 a[52:53], v237 offset:0
    ds_read_b64_tr_b16 a[54:55], v237 offset:512
    s_waitcnt lgkmcnt(6)
    s_add_u32 s40, s82, 745472
    s_add_u32 m0, s76, 0
    s_nop 0
    buffer_load_dwordx4 v238, s[52:55], s40 offen lds
    v_pk_mul_f32 v[216:217], v[152:153], v[152:153]
    v_pk_mul_f32 v[218:219], v[154:155], v[154:155]
    v_pk_fma_f32 v[212:213], v[212:213], v[190:191], v[188:189]
    v_pk_fma_f32 v[214:215], v[214:215], v[190:191], v[188:189]
    v_pk_fma_f32 v[216:217], v[216:217], v[190:191], v[188:189]
    v_pk_fma_f32 v[218:219], v[218:219], v[190:191], v[188:189]
    s_waitcnt vmcnt(15)
    ds_read_b64_tr_b16 a[164:165], v237 offset:1024
    ds_read_b64_tr_b16 a[166:167], v237 offset:1536
    s_waitcnt lgkmcnt(6)
    s_add_u32 s40, s83, 745472
    s_add_u32 m0, s76, 1024
    s_nop 0
    buffer_load_dwordx4 v238, s[52:55], s40 offen lds
    v_pk_mul_f32 v[212:213], v[212:213], v[148:149]
    v_pk_mul_f32 v[214:215], v[214:215], v[150:151]
    v_pk_mul_f32 v[216:217], v[216:217], v[152:153]
    v_pk_mul_f32 v[218:219], v[218:219], v[154:155]
    v_exp_f32 v212, v212
    v_exp_f32 v213, v213
    s_waitcnt vmcnt(15)
    ds_read_b64_tr_b16 a[56:57], v237 offset:2048
    ds_read_b64_tr_b16 a[58:59], v237 offset:2560
    s_waitcnt lgkmcnt(6)
    s_add_u32 s40, s82, 860160
    s_add_u32 m0, s76, 2048
    s_nop 0
    buffer_load_dwordx4 v238, s[52:55], s40 offen lds
    v_exp_f32 v214, v214
    v_exp_f32 v215, v215
    v_exp_f32 v216, v216
    v_exp_f32 v217, v217
    v_exp_f32 v218, v218
    v_exp_f32 v219, v219
    s_waitcnt vmcnt(15)
    ds_read_b64_tr_b16 a[168:169], v237 offset:3072
    ds_read_b64_tr_b16 a[170:171], v237 offset:3584
    s_waitcnt lgkmcnt(6)
    s_add_u32 s40, s83, 860160
    s_add_u32 m0, s77, 0
    s_nop 0
    buffer_load_dwordx4 v238, s[52:55], s40 offen lds
    v_pk_fma_f32 v[212:213], v[212:213], v[192:193], v[192:193]
    v_pk_fma_f32 v[214:215], v[214:215], v[192:193], v[192:193]
    v_pk_fma_f32 v[216:217], v[216:217], v[192:193], v[192:193]
    v_pk_fma_f32 v[218:219], v[218:219], v[192:193], v[192:193]
    v_rcp_f32 v212, v212
    v_rcp_f32 v213, v213
    s_waitcnt vmcnt(15)
    ds_read_b64_tr_b16 a[60:61], v237 offset:4096
    ds_read_b64_tr_b16 a[62:63], v237 offset:4608
    s_waitcnt lgkmcnt(6)
    s_add_u32 s40, s82, 974848
    s_add_u32 m0, s77, 1024
    s_nop 0
    buffer_load_dwordx4 v238, s[52:55], s40 offen lds
    v_rcp_f32 v214, v214
    v_rcp_f32 v215, v215
    v_rcp_f32 v216, v216
    v_rcp_f32 v217, v217
    v_rcp_f32 v218, v218
    v_rcp_f32 v219, v219
    s_waitcnt vmcnt(15)
    ds_read_b64_tr_b16 a[172:173], v237 offset:5120
    ds_read_b64_tr_b16 a[174:175], v237 offset:5632
    s_waitcnt lgkmcnt(6)
    s_add_u32 s40, s83, 974848
    s_add_u32 m0, s77, 2048
    s_nop 0
    buffer_load_dwordx4 v238, s[52:55], s40 offen lds
    v_pk_mul_f32 v[148:149], v[148:149], v[212:213]
    v_pk_mul_f32 v[150:151], v[150:151], v[214:215]
    v_pk_mul_f32 v[152:153], v[152:153], v[216:217]
    v_pk_mul_f32 v[154:155], v[154:155], v[218:219]
    v_cvt_pk_bf16_f32 v232, v148, v149
    v_cvt_pk_bf16_f32 v233, v150, v151
    v_cvt_pk_bf16_f32 v234, v152, v153
    v_cvt_pk_bf16_f32 v235, v154, v155
    buffer_store_dwordx4 v[228:231], v1, s[4:7], s46 offen offset:2048
    buffer_store_dwordx4 v[232:235], v1, s[4:7], s46 offen offset:3072
    v_lshrrev_b32 v242, 2, v0
    v_mul_u32_u24 v242, 2688, v242
    v_and_b32 v11, 3, v0
    v_lshl_add_u32 v242, v11, 4, v242
    v_pk_mul_f32 v[212:213], v[156:157], v[156:157]
    v_pk_mul_f32 v[214:215], v[158:159], v[158:159]
    v_pk_mul_f32 v[216:217], v[160:161], v[160:161]
    v_pk_mul_f32 v[218:219], v[162:163], v[162:163]
    s_waitcnt vmcnt(17)
    ds_read_b64_tr_b16 a[64:65], v237 offset:6144
    ds_read_b64_tr_b16 a[66:67], v237 offset:6656
    s_waitcnt lgkmcnt(6)
    s_add_u32 s40, s82, 1089536
    s_add_u32 m0, s77, 3072
    s_nop 0
    buffer_load_dwordx4 v238, s[52:55], s40 offen lds
    v_pk_fma_f32 v[212:213], v[212:213], v[190:191], v[188:189]
    v_pk_fma_f32 v[214:215], v[214:215], v[190:191], v[188:189]
    v_pk_fma_f32 v[216:217], v[216:217], v[190:191], v[188:189]
    v_pk_fma_f32 v[218:219], v[218:219], v[190:191], v[188:189]
    s_waitcnt vmcnt(17)
    ds_read_b64_tr_b16 a[176:177], v237 offset:7168
    ds_read_b64_tr_b16 a[178:179], v237 offset:7680
    s_waitcnt lgkmcnt(6)
    s_add_u32 s40, s83, 1089536
    s_add_u32 m0, s77, 4096
    s_nop 0
    buffer_load_dwordx4 v238, s[52:55], s40 offen lds
    v_pk_mul_f32 v[212:213], v[212:213], v[156:157]
    v_pk_mul_f32 v[214:215], v[214:215], v[158:159]
    v_pk_mul_f32 v[216:217], v[216:217], v[160:161]
    v_pk_mul_f32 v[218:219], v[218:219], v[162:163]
    s_waitcnt vmcnt(15)
    ds_read_b64_tr_b16 a[68:69], v237 offset:8192
    ds_read_b64_tr_b16 a[70:71], v237 offset:8704
    s_waitcnt lgkmcnt(6)
    s_add_u32 s40, s82, 1204224
    s_add_u32 m0, s77, 5120
    s_nop 0
    buffer_load_dwordx4 v238, s[52:55], s40 offen lds
    v_exp_f32 v212, v212
    v_exp_f32 v213, v213
    v_exp_f32 v214, v214
    v_exp_f32 v215, v215
    s_waitcnt vmcnt(15)
    ds_read_b64_tr_b16 a[180:181], v237 offset:9216
    ds_read_b64_tr_b16 a[182:183], v237 offset:9728
    s_waitcnt lgkmcnt(6)
    s_add_u32 s40, s83, 1204224
    s_add_u32 m0, s77, 6144
    s_nop 0
    buffer_load_dwordx4 v238, s[52:55], s40 offen lds
    v_exp_f32 v216, v216
    v_exp_f32 v217, v217
    v_exp_f32 v218, v218
    v_exp_f32 v219, v219
    s_waitcnt vmcnt(15)
    ds_read_b64_tr_b16 a[72:73], v237 offset:10240
    ds_read_b64_tr_b16 a[74:75], v237 offset:10752
    s_waitcnt lgkmcnt(6)
    s_add_u32 s40, s82, 1318912
    s_add_u32 m0, s77, 7168
    s_nop 0
    buffer_load_dwordx4 v238, s[52:55], s40 offen lds
    v_pk_fma_f32 v[212:213], v[212:213], v[192:193], v[192:193]
    v_pk_fma_f32 v[214:215], v[214:215], v[192:193], v[192:193]
    v_pk_fma_f32 v[216:217], v[216:217], v[192:193], v[192:193]
    v_pk_fma_f32 v[218:219], v[218:219], v[192:193], v[192:193]
    s_waitcnt vmcnt(15)
    ds_read_b64_tr_b16 a[184:185], v237 offset:11264
    ds_read_b64_tr_b16 a[186:187], v237 offset:11776
    s_waitcnt lgkmcnt(6)
    s_add_u32 s40, s83, 1318912
    s_add_u32 m0, s77, 8192
    s_nop 0
    buffer_load_dwordx4 v238, s[52:55], s40 offen lds
    v_rcp_f32 v212, v212
    v_rcp_f32 v213, v213
    v_rcp_f32 v214, v214
    v_rcp_f32 v215, v215
    s_waitcnt vmcnt(15)
    ds_read_b64_tr_b16 a[76:77], v237 offset:12288
    ds_read_b64_tr_b16 a[78:79], v237 offset:12800
    s_waitcnt lgkmcnt(6)
    s_add_u32 s40, s82, 1433600
    s_add_u32 m0, s77, 9216
    s_nop 0
    buffer_load_dwordx4 v238, s[52:55], s40 offen lds
    v_rcp_f32 v216, v216
    v_rcp_f32 v217, v217
    v_rcp_f32 v218, v218
    v_rcp_f32 v219, v219
    s_waitcnt vmcnt(15)
    ds_read_b64_tr_b16 a[188:189], v237 offset:13312
    ds_read_b64_tr_b16 a[190:191], v237 offset:13824
    s_waitcnt lgkmcnt(6)
    s_add_u32 s40, s83, 1433600
    s_add_u32 m0, s77, 10240
    s_nop 0
    buffer_load_dwordx4 v238, s[52:55], s40 offen lds
    v_pk_mul_f32 v[156:157], v[156:157], v[212:213]
    v_pk_mul_f32 v[158:159], v[158:159], v[214:215]
    v_pk_mul_f32 v[160:161], v[160:161], v[216:217]
    v_pk_mul_f32 v[162:163], v[162:163], v[218:219]
    s_waitcnt vmcnt(8)
    s_mov_b64 exec, 1
    s_cmp_eq_u32 s19, 0
    s_cbranch_scc0 pubs_23
    buffer_store_dword v10, v6, s[4:7], s58 offen
    s_branch pubd_24
pubs_23:
    buffer_wbl2 sc1
    s_waitcnt vmcnt(0)
    buffer_store_dword v10, v6, s[4:7], s58 offen sc1
pubd_24:
    s_mov_b64 exec, -1
    s_nop 0
    v_cvt_pk_bf16_f32 v220, v156, v157
    v_cvt_pk_bf16_f32 v221, v158, v159
    v_cvt_pk_bf16_f32 v222, v160, v161
    ds_read_b64_tr_b16 a[80:81], v236 offset:0
    ds_read_b64_tr_b16 a[82:83], v236 offset:512
    s_waitcnt lgkmcnt(6)
    s_add_u32 s40, s82, 1548288
    s_add_u32 m0, s77, 11264
    s_nop 0
    buffer_load_dwordx4 v238, s[52:55], s40 offen lds
    v_cvt_pk_bf16_f32 v223, v162, v163
    v_pk_mul_f32 v[212:213], v[164:165], v[164:165]
    v_pk_mul_f32 v[214:215], v[166:167], v[166:167]
    ds_read_b64_tr_b16 a[192:193], v236 offset:1024
    ds_read_b64_tr_b16 a[194:195], v236 offset:1536
    s_waitcnt lgkmcnt(6)
    s_add_u32 s40, s83, 1548288
    s_add_u32 m0, s77, 12288
    s_nop 0
    buffer_load_dwordx4 v238, s[52:55], s40 offen lds
    v_pk_mul_f32 v[216:217], v[168:169], v[168:169]
    v_pk_mul_f32 v[218:219], v[170:171], v[170:171]
    v_pk_fma_f32 v[212:213], v[212:213], v[190:191], v[188:189]
    ds_read_b64_tr_b16 a[84:85], v236 offset:2048
    ds_read_b64_tr_b16 a[86:87], v236 offset:2560
    v_pk_fma_f32 v[214:215], v[214:215], v[190:191], v[188:189]
    v_pk_fma_f32 v[216:217], v[216:217], v[190:191], v[188:189]
    v_pk_fma_f32 v[218:219], v[218:219], v[190:191], v[188:189]
    ds_read_b64_tr_b16 a[196:197], v237 offset:0
    ds_read_b64_tr_b16 a[198:199], v237 offset:512
    v_pk_mul_f32 v[212:213], v[212:213], v[164:165]
    v_pk_mul_f32 v[214:215], v[214:215], v[166:167]
    v_pk_mul_f32 v[216:217], v[216:217], v[168:169]
    ds_read_b64_tr_b16 a[88:89], v237 offset:1024
    ds_read_b64_tr_b16 a[90:91], v237 offset:1536
    v_pk_mul_f32 v[218:219], v[218:219], v[170:171]
    v_exp_f32 v212, v212
    v_exp_f32 v213, v213
    ds_read_b64_tr_b16 a[200:201], v237 offset:2048
    ds_read_b64_tr_b16 a[202:203], v237 offset:2560
    v_exp_f32 v214, v214
    v_exp_f32 v215, v215
    v_exp_f32 v216, v216
    s_waitcnt vmcnt(10)
    ds_read_b64_tr_b16 a[92:93], v237 offset:3072
    ds_read_b64_tr_b16 a[94:95], v237 offset:3584
    v_exp_f32 v217, v217
    v_exp_f32 v218, v218
    v_exp_f32 v219, v219
    s_waitcnt vmcnt(9)
    ds_read_b64_tr_b16 a[204:205], v237 offset:4096
    ds_read_b64_tr_b16 a[206:207], v237 offset:4608
    v_pk_fma_f32 v[212:213], v[212:213], v[192:193], v[192:193]
    v_pk_fma_f32 v[214:215], v[214:215], v[192:193], v[192:193]
    v_pk_fma_f32 v[216:217], v[216:217], v[192:193], v[192:193]
    s_waitcnt vmcnt(8)
    ds_read_b64_tr_b16 a[96:97], v237 offset:5120
    ds_read_b64_tr_b16 a[98:99], v237 offset:5632
    v_pk_fma_f32 v[218:219], v[218:219], v[192:193], v[192:193]
    v_rcp_f32 v212, v212
    v_rcp_f32 v213, v213
    s_waitcnt vmcnt(7)
    ds_read_b64_tr_b16 a[208:209], v237 offset:6144
    ds_read_b64_tr_b16 a[210:211], v237 offset:6656
    v_rcp_f32 v214, v214
    v_rcp_f32 v215, v215
    v_rcp_f32 v216, v216
    s_waitcnt vmcnt(6)
    ds_read_b64_tr_b16 a[100:101], v237 offset:7168
    ds_read_b64_tr_b16 a[102:103], v237 offset:7680
    v_rcp_f32 v217, v217
    v_rcp_f32 v218, v218
    v_rcp_f32 v219, v219
    s_waitcnt vmcnt(5)
    ds_read_b64_tr_b16 a[212:213], v237 offset:8192
    ds_read_b64_tr_b16 a[214:215], v237 offset:8704
    v_pk_mul_f32 v[164:165], v[164:165], v[212:213]
    v_pk_mul_f32 v[166:167], v[166:167], v[214:215]
    v_pk_mul_f32 v[168:169], v[168:169], v[216:217]
    s_waitcnt vmcnt(4)
    ds_read_b64_tr_b16 a[104:105], v237 offset:9216
    ds_read_b64_tr_b16 a[106:107], v237 offset:9728
    v_pk_mul_f32 v[170:171], v[170:171], v[218:219]
    v_cvt_pk_bf16_f32 v224, v164, v165
    v_cvt_pk_bf16_f32 v225, v166, v167
    s_waitcnt vmcnt(3)
    ds_read_b64_tr_b16 a[216:217], v237 offset:10240
    ds_read_b64_tr_b16 a[218:219], v237 offset:10752
    v_cvt_pk_bf16_f32 v226, v168, v169
    v_cvt_pk_bf16_f32 v227, v170, v171
    buffer_store_dwordx4 v[220:223], v1, s[4:7], s45 offen offset:0
    s_waitcnt vmcnt(2)
    ds_read_b64_tr_b16 a[108:109], v237 offset:11264
    ds_read_b64_tr_b16 a[110:111], v237 offset:11776
    buffer_store_dwordx4 v[224:227], v1, s[4:7], s45 offen offset:1024
    s_waitcnt vmcnt(2)
    ds_read_b64_tr_b16 a[220:221], v237 offset:12288
    ds_read_b64_tr_b16 a[222:223], v237 offset:12800
    s_waitcnt lgkmcnt(0)
    s_barrier
    v_bfe_u32 v11, v0, 4, 1
    v_lshl_add_u32 v5, v11, 7, v5
    s_add_u32 s42, s86, 16384
    s_add_u32 s48, s84, s87
poll_25:
    s_add_u32 s50, s50, 1
    s_cmp_gt_u32 s50, 0x40000
    s_cbranch_scc1 pollx_26
    buffer_load_dword v9, v5, s[4:7], s42 offen sc1
    s_waitcnt vmcnt(0)
    v_cmp_eq_u32 vcc, 1, v9
    s_nop 0
    s_and_b32 s51, vcc_lo, 0x3fff3fff
    s_cmp_eq_u32 s51, 0x3fff3fff
    s_cbranch_scc0 poll_25
pollx_26:
    s_cmp_eq_u32 s19, 0
    s_cbranch_scc1 acq_27
    buffer_inv sc1
    s_waitcnt vmcnt(0)
acq_27:
    s_add_u32 s41, s48, 0
    buffer_load_dwordx4 v[140:143], v1, s[4:7], s41 offen sc1
    s_add_u32 s41, s48, 1024
    buffer_load_dwordx4 v[144:147], v1, s[4:7], s41 offen sc1
    s_add_u32 s42, s86, 24576
    s_add_u32 s43, s80, s95
    s_add_u32 s44, s81, s95
    s_add_u32 s52, s43, 57344
    s_add_u32 s53, s44, 57344
    s_add_u32 s54, s99, s97
    s_add_u32 s55, s100, s97
    s_cmp_lt_u32 s3, 2
    s_cselect_b32 s52, s52, s54
    s_cselect_b32 s53, s53, s55
    s_add_u32 s41, s43, 0
    buffer_load_dwordx4 v[12:15], v1, s[4:7], s41 offen sc1
    s_add_u32 s41, s44, 0
    buffer_load_dwordx4 v[16:19], v1, s[4:7], s41 offen sc1
    s_add_u32 s41, s43, 4096
    buffer_load_dwordx4 v[20:23], v1, s[4:7], s41 offen sc1
    s_add_u32 s41, s44, 4096
    buffer_load_dwordx4 v[24:27], v1, s[4:7], s41 offen sc1
    s_add_u32 s41, s43, 8192
    buffer_load_dwordx4 v[28:31], v1, s[4:7], s41 offen sc1
    s_add_u32 s41, s44, 8192
    buffer_load_dwordx4 v[32:35], v1, s[4:7], s41 offen sc1
    v_cmp_eq_u32 vcc, 0, v3
    v_mov_b32 v152, 0x3f80
    s_nop 0
    v_cndmask_b32 v148, 0, v253, vcc
    v_mov_b32 v149, 0
    v_mov_b32 v150, 0
    v_mov_b32 v151, 0
    v_mov_b32 v153, 0
    v_mov_b32 v154, 0
    v_mov_b32 v155, 0
    v_pk_mul_f32 v[212:213], v[172:173], v[172:173]
    v_pk_mul_f32 v[214:215], v[174:175], v[174:175]
    v_pk_mul_f32 v[216:217], v[176:177], v[176:177]
    v_pk_mul_f32 v[218:219], v[178:179], v[178:179]
    v_pk_fma_f32 v[212:213], v[212:213], v[190:191], v[188:189]
    v_pk_fma_f32 v[214:215], v[214:215], v[190:191], v[188:189]
    s_add_u32 s41, s43, 12288
    buffer_load_dwordx4 v[36:39], v1, s[4:7], s41 offen sc1
    v_pk_fma_f32 v[216:217], v[216:217], v[190:191], v[188:189]
    v_pk_fma_f32 v[218:219], v[218:219], v[190:191], v[188:189]
    v_pk_mul_f32 v[212:213], v[212:213], v[172:173]
    v_pk_mul_f32 v[214:215], v[214:215], v[174:175]
    v_pk_mul_f32 v[216:217], v[216:217], v[176:177]
    v_pk_mul_f32 v[218:219], v[218:219], v[178:179]
    s_add_u32 s41, s44, 12288
    buffer_load_dwordx4 v[40:43], v1, s[4:7], s41 offen sc1
    v_exp_f32 v212, v212
    v_exp_f32 v213, v213
    v_exp_f32 v214, v214
    v_exp_f32 v215, v215
    v_exp_f32 v216, v216
    v_exp_f32 v217, v217
    s_add_u32 s41, s43, 16384
    buffer_load_dwordx4 v[44:47], v1, s[4:7], s41 offen sc1
    v_exp_f32 v218, v218
    v_exp_f32 v219, v219
    v_pk_fma_f32 v[212:213], v[212:213], v[192:193], v[192:193]
    v_pk_fma_f32 v[214:215], v[214:215], v[192:193], v[192:193]
    v_pk_fma_f32 v[216:217], v[216:217], v[192:193], v[192:193]
    v_pk_fma_f32 v[218:219], v[218:219], v[192:193], v[192:193]
    s_add_u32 s41, s44, 16384
    buffer_load_dwordx4 v[48:51], v1, s[4:7], s41 offen sc1
    v_rcp_f32 v212, v212
    v_rcp_f32 v213, v213
    v_rcp_f32 v214, v214
    v_rcp_f32 v215, v215
    v_rcp_f32 v216, v216
    v_rcp_f32 v217, v217
    s_add_u32 s41, s43, 20480
    buffer_load_dwordx4 v[52:55], v1, s[4:7], s41 offen sc1
    v_rcp_f32 v218, v218
    v_rcp_f32 v219, v219
    v_pk_mul_f32 v[172:173], v[172:173], v[212:213]
    v_pk_mul_f32 v[174:175], v[174:175], v[214:215]
    v_pk_mul_f32 v[176:177], v[176:177], v[216:217]
    v_pk_mul_f32 v[178:179], v[178:179], v[218:219]
    s_add_u32 s41, s44, 20480
    buffer_load_dwordx4 v[56:59], v1, s[4:7], s41 offen sc1
    v_cvt_pk_bf16_f32 v228, v172, v173
    v_cvt_pk_bf16_f32 v229, v174, v175
    v_cvt_pk_bf16_f32 v230, v176, v177
    v_cvt_pk_bf16_f32 v231, v178, v179
    v_pk_mul_f32 v[212:213], v[180:181], v[180:181]
    v_pk_mul_f32 v[214:215], v[182:183], v[182:183]
    s_add_u32 s40, s62, 896
    s_add_u32 m0, s63, 0
    s_nop 0
    buffer_load_dwordx4 v242, s[8:11], s40 offen lds
    v_pk_mul_f32 v[216:217], v[184:185], v[184:185]
    v_pk_mul_f32 v[218:219], v[186:187], v[186:187]
    v_pk_fma_f32 v[212:213], v[212:213], v[190:191], v[188:189]
    v_pk_fma_f32 v[214:215], v[214:215], v[190:191], v[188:189]
    v_pk_fma_f32 v[216:217], v[216:217], v[190:191], v[188:189]
    v_pk_fma_f32 v[218:219], v[218:219], v[190:191], v[188:189]
    s_add_u32 s40, s62, 1792
    s_add_u32 m0, s63, 28672
    s_nop 0
    buffer_load_dwordx4 v242, s[8:11], s40 offen lds
    v_pk_mul_f32 v[212:213], v[212:213], v[180:181]
    v_pk_mul_f32 v[214:215], v[214:215], v[182:183]
    v_pk_mul_f32 v[216:217], v[216:217], v[184:185]
    v_pk_mul_f32 v[218:219], v[218:219], v[186:187]
    v_exp_f32 v212, v212
    v_exp_f32 v213, v213
    s_add_u32 s40, s62, 172928
    s_add_u32 m0, s63, 4096
    s_nop 0
    buffer_load_dwordx4 v242, s[8:11], s40 offen lds
    v_exp_f32 v214, v214
    v_exp_f32 v215, v215
    v_exp_f32 v216, v216
    v_exp_f32 v217, v217
    v_exp_f32 v218, v218
    v_exp_f32 v219, v219
    s_add_u32 s40, s62, 173824
    s_add_u32 m0, s63, 32768
    s_nop 0
    buffer_load_dwordx4 v242, s[8:11], s40 offen lds
    v_pk_fma_f32 v[212:213], v[212:213], v[192:193], v[192:193]
    v_pk_fma_f32 v[214:215], v[214:215], v[192:193], v[192:193]
    v_pk_fma_f32 v[216:217], v[216:217], v[192:193], v[192:193]
    v_pk_fma_f32 v[218:219], v[218:219], v[192:193], v[192:193]
    v_rcp_f32 v212, v212
    v_rcp_f32 v213, v213
    s_add_u32 s40, s62, 344960
    s_add_u32 m0, s63, 8192
    s_nop 0
    buffer_load_dwordx4 v242, s[8:11], s40 offen lds
    v_rcp_f32 v214, v214
    v_rcp_f32 v215, v215
    v_rcp_f32 v216, v216
    v_rcp_f32 v217, v217
    v_rcp_f32 v218, v218
    v_rcp_f32 v219, v219
    s_add_u32 s40, s62, 345856
    s_add_u32 m0, s63, 36864
    s_nop 0
    buffer_load_dwordx4 v242, s[8:11], s40 offen lds
    v_pk_mul_f32 v[180:181], v[180:181], v[212:213]
    v_pk_mul_f32 v[182:183], v[182:183], v[214:215]
    v_pk_mul_f32 v[184:185], v[184:185], v[216:217]
    v_pk_mul_f32 v[186:187], v[186:187], v[218:219]
    v_cvt_pk_bf16_f32 v232, v180, v181
    v_cvt_pk_bf16_f32 v233, v182, v183
    v_cvt_pk_bf16_f32 v234, v184, v185
    v_cvt_pk_bf16_f32 v235, v186, v187
    buffer_store_dwordx4 v[228:231], v1, s[4:7], s47 offen offset:0
    buffer_store_dwordx4 v[232:235], v1, s[4:7], s47 offen offset:1024
    s_waitcnt vmcnt(20)
    v_lshlrev_b32 v76, 16, v140
    v_and_b32 v77, 0xffff0000, v140
    v_lshlrev_b32 v78, 16, v141
    v_and_b32 v79, 0xffff0000, v141
    v_lshlrev_b32 v80, 16, v142
    v_and_b32 v81, 0xffff0000, v142
    v_lshlrev_b32 v82, 16, v143
    v_and_b32 v83, 0xffff0000, v143
    v_lshlrev_b32 v84, 16, v144
    v_and_b32 v85, 0xffff0000, v144
    v_lshlrev_b32 v86, 16, v145
    v_and_b32 v87, 0xffff0000, v145
    v_lshlrev_b32 v88, 16, v146
    v_and_b32 v89, 0xffff0000, v146
    v_lshlrev_b32 v90, 16, v147
    v_and_b32 v91, 0xffff0000, v147
    s_nop 1
    v_mfma_f32_32x32x16_bf16 v[76:91], v[148:151], v[152:155], v[76:91]
    s_waitcnt vmcnt(18)
    v_mfma_f32_32x32x16_bf16 v[76:91], a[0:3], v[12:15], v[76:91]
    v_mfma_f32_32x32x16_bf16 v[92:107], a[112:115], v[12:15], 0
    s_add_u32 s41, s43, 24576
    buffer_load_dwordx4 v[60:63], v1, s[4:7], s41 offen sc1
    v_mfma_f32_32x32x16_bf16 v[108:123], a[0:3], v[16:19], 0
    v_mfma_f32_32x32x16_bf16 v[124:139], a[112:115], v[16:19], 0
    s_add_u32 s41, s44, 24576
    buffer_load_dwordx4 v[64:67], v1, s[4:7], s41 offen sc1
    s_waitcnt vmcnt(18)
    v_mfma_f32_32x32x16_bf16 v[76:91], a[4:7], v[20:23], v[76:91]
    v_mfma_f32_32x32x16_bf16 v[92:107], a[116:119], v[20:23], v[92:107]
    s_add_u32 s41, s43, 28672
    buffer_load_dwordx4 v[68:71], v1, s[4:7], s41 offen sc1
    v_mfma_f32_32x32x16_bf16 v[108:123], a[4:7], v[24:27], v[108:123]
    v_mfma_f32_32x32x16_bf16 v[124:139], a[116:119], v[24:27], v[124:139]
    s_add_u32 s41, s44, 28672
    buffer_load_dwordx4 v[72:75], v1, s[4:7], s41 offen sc1
    s_waitcnt vmcnt(4)
    s_mov_b64 exec, 1
    s_cmp_eq_u32 s19, 0
    s_cbranch_scc0 pubs_28
    buffer_store_dword v10, v6, s[4:7], s59 offen
    s_branch pubd_29
pubs_28:
    buffer_wbl2 sc1
    s_waitcnt vmcnt(0)
    buffer_store_dword v10, v6, s[4:7], s59 offen sc1
pubd_29:
    s_mov_b64 exec, -1
    s_nop 0
    v_mfma_f32_32x32x16_bf16 v[76:91], a[8:11], v[28:31], v[76:91]
    v_mfma_f32_32x32x16_bf16 v[92:107], a[120:123], v[28:31], v[92:107]
    s_add_u32 s41, s43, 32768
    buffer_load_dwordx4 v[12:15], v1, s[4:7], s41 offen sc1
    v_mfma_f32_32x32x16_bf16 v[108:123], a[8:11], v[32:35], v[108:123]
    v_mfma_f32_32x32x16_bf16 v[124:139], a[120:123], v[32:35], v[124:139]
    s_add_u32 s41, s44, 32768
    buffer_load_dwordx4 v[16:19], v1, s[4:7], s41 offen sc1
    v_mfma_f32_32x32x16_bf16 v[76:91], a[12:15], v[36:39], v[76:91]
    v_mfma_f32_32x32x16_bf16 v[92:107], a[124:127], v[36:39], v[92:107]
    s_add_u32 s41, s43, 36864
    buffer_load_dwordx4 v[20:23], v1, s[4:7], s41 offen sc1
    v_mfma_f32_32x32x16_bf16 v[108:123], a[12:15], v[40:43], v[108:123]
    v_mfma_f32_32x32x16_bf16 v[124:139], a[124:127], v[40:43], v[124:139]
    s_add_u32 s41, s44, 36864
    buffer_load_dwordx4 v[24:27], v1, s[4:7], s41 offen sc1
    v_mfma_f32_32x32x16_bf16 v[76:91], a[16:19], v[44:47], v[76:91]
    v_mfma_f32_32x32x16_bf16 v[92:107], a[128:131], v[44:47], v[92:107]
    s_add_u32 s41, s43, 40960
    buffer_load_dwordx4 v[28:31], v1, s[4:7], s41 offen sc1
    v_mfma_f32_32x32x16_bf16 v[108:123], a[16:19], v[48:51], v[108:123]
    v_mfma_f32_32x32x16_bf16 v[124:139], a[128:131], v[48:51], v[124:139]
    s_add_u32 s41, s44, 40960
    buffer_load_dwordx4 v[32:35], v1, s[4:7], s41 offen sc1
    v_mfma_f32_32x32x16_bf16 v[76:91], a[20:23], v[52:55], v[76:91]
    v_mfma_f32_32x32x16_bf16 v[92:107], a[132:135], v[52:55], v[92:107]
    s_add_u32 s41, s43, 45056
    buffer_load_dwordx4 v[36:39], v1, s[4:7], s41 offen sc1
    v_mfma_f32_32x32x16_bf16 v[108:123], a[20:23], v[56:59], v[108:123]
    v_mfma_f32_32x32x16_bf16 v[124:139], a[132:135], v[56:59], v[124:139]
    s_add_u32 s41, s44, 45056
    buffer_load_dwordx4 v[40:43], v1, s[4:7], s41 offen sc1
    s_waitcnt vmcnt(11)
    v_mfma_f32_32x32x16_bf16 v[76:91], a[24:27], v[60:63], v[76:91]
    v_mfma_f32_32x32x16_bf16 v[92:107], a[136:139], v[60:63], v[92:107]
    s_add_u32 s41, s43, 49152
    buffer_load_dwordx4 v[44:47], v1, s[4:7], s41 offen sc1
    v_mfma_f32_32x32x16_bf16 v[108:123], a[24:27], v[64:67], v[108:123]
    v_mfma_f32_32x32x16_bf16 v[124:139], a[136:139], v[64:67], v[124:139]
    s_add_u32 s41, s44, 49152
    buffer_load_dwordx4 v[48:51], v1, s[4:7], s41 offen sc1
    s_waitcnt vmcnt(11)
    v_mfma_f32_32x32x16_bf16 v[76:91], a[28:31], v[68:71], v[76:91]
    v_mfma_f32_32x32x16_bf16 v[92:107], a[140:143], v[68:71], v[92:107]
    s_add_u32 s41, s43, 53248
    buffer_load_dwordx4 v[52:55], v1, s[4:7], s41 offen sc1
    v_mfma_f32_32x32x16_bf16 v[108:123], a[28:31], v[72:75], v[108:123]
    v_mfma_f32_32x32x16_bf16 v[124:139], a[140:143], v[72:75], v[124:139]
    s_add_u32 s41, s44, 53248
    buffer_load_dwordx4 v[56:59], v1, s[4:7], s41 offen sc1
    s_waitcnt vmcnt(10)
    v_mfma_f32_32x32x16_bf16 v[76:91], a[32:35], v[12:15], v[76:91]
    v_mfma_f32_32x32x16_bf16 v[92:107], a[144:147], v[12:15], v[92:107]
    v_mfma_f32_32x32x16_bf16 v[108:123], a[32:35], v[16:19], v[108:123]
    v_mfma_f32_32x32x16_bf16 v[124:139], a[144:147], v[16:19], v[124:139]
    s_waitcnt vmcnt(8)
    v_mfma_f32_32x32x16_bf16 v[76:91], a[36:39], v[20:23], v[76:91]
    v_mfma_f32_32x32x16_bf16 v[92:107], a[148:151], v[20:23], v[92:107]
    v_mfma_f32_32x32x16_bf16 v[108:123], a[36:39], v[24:27], v[108:123]
    v_mfma_f32_32x32x16_bf16 v[124:139], a[148:151], v[24:27], v[124:139]
    buffer_load_dword v9, v5, s[4:7], s42 offen sc1
    s_waitcnt vmcnt(7)
    v_mfma_f32_32x32x16_bf16 v[76:91], a[40:43], v[28:31], v[76:91]
    v_mfma_f32_32x32x16_bf16 v[92:107], a[152:155], v[28:31], v[92:107]
    v_mfma_f32_32x32x16_bf16 v[108:123], a[40:43], v[32:35], v[108:123]
    v_mfma_f32_32x32x16_bf16 v[124:139], a[152:155], v[32:35], v[124:139]
    s_waitcnt vmcnt(0)
    s_branch hbc_31
hbp_30:
    s_add_u32 s50, s50, 1
    s_cmp_gt_u32 s50, 0x40000
    s_cbranch_scc1 hbx_32
    buffer_load_dword v9, v5, s[4:7], s42 offen sc1
    s_waitcnt vmcnt(0)
hbc_31:
    v_cmp_eq_u32 vcc, 1, v9
    s_nop 0
    s_and_b32 s51, vcc_lo, 0x3fff3fff
    s_cmp_eq_u32 s51, 0x3fff3fff
    s_cbranch_scc0 hbp_30
hbx_32:
    s_cmp_eq_u32 s19, 0
    s_cbranch_scc1 hba_33
    buffer_inv sc1
    s_waitcnt vmcnt(0)
hba_33:
    v_and_b32 v5, 63, v5
    s_add_u32 s41, s52, 0
    buffer_load_dwordx4 v[60:63], v1, s[4:7], s41 offen sc1
    s_add_u32 s41, s53, 0
    buffer_load_dwordx4 v[64:67], v1, s[4:7], s41 offen sc1
    s_add_u32 s41, s52, 2048
    buffer_load_dwordx4 v[68:71], v1, s[4:7], s41 offen sc1
    s_add_u32 s41, s53, 2048
    buffer_load_dwordx4 v[72:75], v1, s[4:7], s41 offen sc1
    s_add_u32 s41, s52, 4096
    buffer_load_dwordx4 v[12:15], v1, s[4:7], s41 offen sc1
    s_add_u32 s41, s53, 4096
    buffer_load_dwordx4 v[16:19], v1, s[4:7], s41 offen sc1
    s_xor_b32 s40, s3, 1
    s_mul_i32 s41, s40, 12288
    s_add_u32 s41, s41, 81920
    v_add_u32 v213, s41, v1
    s_xor_b32 s40, s3, 2
    s_mul_i32 s41, s40, 12288
    s_add_u32 s41, s41, 86016
    v_add_u32 v214, s41, v1
    s_xor_b32 s40, s3, 3
    s_mul_i32 s41, s40, 12288
    s_add_u32 s41, s41, 90112
    v_add_u32 v215, s41, v1
    v_mfma_f32_32x32x16_bf16 v[76:91], a[44:47], v[36:39], v[76:91]
    v_mfma_f32_32x32x16_bf16 v[92:107], a[156:159], v[36:39], v[92:107]
    s_add_u32 s41, s52, 6144
    buffer_load_dwordx4 v[20:23], v1, s[4:7], s41 offen sc1
    v_mfma_f32_32x32x16_bf16 v[108:123], a[44:47], v[40:43], v[108:123]
    v_mfma_f32_32x32x16_bf16 v[124:139], a[156:159], v[40:43], v[124:139]
    s_add_u32 s41, s53, 6144
    buffer_load_dwordx4 v[24:27], v1, s[4:7], s41 offen sc1
    v_mfma_f32_32x32x16_bf16 v[76:91], a[48:51], v[44:47], v[76:91]
    v_mfma_f32_32x32x16_bf16 v[92:107], a[160:163], v[44:47], v[92:107]
    s_add_u32 s41, s52, 8192
    buffer_load_dwordx4 v[28:31], v1, s[4:7], s41 offen sc1
    v_mfma_f32_32x32x16_bf16 v[108:123], a[48:51], v[48:51], v[108:123]
    v_mfma_f32_32x32x16_bf16 v[124:139], a[160:163], v[48:51], v[124:139]
    s_add_u32 s41, s53, 8192
    buffer_load_dwordx4 v[32:35], v1, s[4:7], s41 offen sc1
    v_mfma_f32_32x32x16_bf16 v[76:91], a[52:55], v[52:55], v[76:91]
    v_mfma_f32_32x32x16_bf16 v[92:107], a[164:167], v[52:55], v[92:107]
    s_add_u32 s41, s52, 10240
    buffer_load_dwordx4 v[36:39], v1, s[4:7], s41 offen sc1
    v_mfma_f32_32x32x16_bf16 v[108:123], a[52:55], v[56:59], v[108:123]
    v_mfma_f32_32x32x16_bf16 v[124:139], a[164:167], v[56:59], v[124:139]
    s_add_u32 s41, s53, 10240
    buffer_load_dwordx4 v[40:43], v1, s[4:7], s41 offen sc1
    s_waitcnt vmcnt(10)
    v_mfma_f32_32x32x16_bf16 v[76:91], a[56:59], v[60:63], v[76:91]
    v_mfma_f32_32x32x16_bf16 v[92:107], a[168:171], v[60:63], v[92:107]
    s_add_u32 s41, s52, 12288
    buffer_load_dwordx4 v[44:47], v1, s[4:7], s41 offen sc1
    v_mfma_f32_32x32x16_bf16 v[108:123], a[56:59], v[64:67], v[108:123]
    v_mfma_f32_32x32x16_bf16 v[124:139], a[168:171], v[64:67], v[124:139]
    s_add_u32 s41, s53, 12288
    buffer_load_dwordx4 v[48:51], v1, s[4:7], s41 offen sc1
    s_waitcnt vmcnt(10)
    v_mfma_f32_32x32x16_bf16 v[76:91], a[60:63], v[68:71], v[76:91]
    v_mfma_f32_32x32x16_bf16 v[92:107], a[172:175], v[68:71], v[92:107]
    s_add_u32 s41, s52, 14336
    buffer_load_dwordx4 v[52:55], v1, s[4:7], s41 offen sc1
    v_mfma_f32_32x32x16_bf16 v[108:123], a[60:63], v[72:75], v[108:123]
    v_mfma_f32_32x32x16_bf16 v[124:139], a[172:175], v[72:75], v[124:139]
    s_add_u32 s41, s53, 14336
    buffer_load_dwordx4 v[56:59], v1, s[4:7], s41 offen sc1
    s_waitcnt vmcnt(10)
    v_mfma_f32_32x32x16_bf16 v[76:91], a[64:67], v[12:15], v[76:91]
    v_mfma_f32_32x32x16_bf16 v[92:107], a[176:179], v[12:15], v[92:107]
    s_add_u32 s41, s52, 16384
    buffer_load_dwordx4 v[60:63], v1, s[4:7], s41 offen sc1
    v_mfma_f32_32x32x16_bf16 v[108:123], a[64:67], v[16:19], v[108:123]
    v_mfma_f32_32x32x16_bf16 v[124:139], a[176:179], v[16:19], v[124:139]
    s_add_u32 s41, s53, 16384
    buffer_load_dwordx4 v[64:67], v1, s[4:7], s41 offen sc1
    s_waitcnt vmcnt(10)
    v_mfma_f32_32x32x16_bf16 v[76:91], a[68:71], v[20:23], v[76:91]
    v_mfma_f32_32x32x16_bf16 v[92:107], a[180:183], v[20:23], v[92:107]
    s_add_u32 s41, s52, 18432
    buffer_load_dwordx4 v[68:71], v1, s[4:7], s41 offen sc1
    v_mfma_f32_32x32x16_bf16 v[108:123], a[68:71], v[24:27], v[108:123]
    v_mfma_f32_32x32x16_bf16 v[124:139], a[180:183], v[24:27], v[124:139]
    s_add_u32 s41, s53, 18432
    buffer_load_dwordx4 v[72:75], v1, s[4:7], s41 offen sc1
    s_waitcnt vmcnt(10)
    v_mfma_f32_32x32x16_bf16 v[76:91], a[72:75], v[28:31], v[76:91]
    v_mfma_f32_32x32x16_bf16 v[92:107], a[184:187], v[28:31], v[92:107]
    s_add_u32 s41, s52, 20480
    buffer_load_dwordx4 v[12:15], v1, s[4:7], s41 offen sc1
    v_mfma_f32_32x32x16_bf16 v[108:123], a[72:75], v[32:35], v[108:123]
    v_mfma_f32_32x32x16_bf16 v[124:139], a[184:187], v[32:35], v[124:139]
    s_add_u32 s41, s53, 20480
    buffer_load_dwordx4 v[16:19], v1, s[4:7], s41 offen sc1
    s_waitcnt vmcnt(10)
    v_mfma_f32_32x32x16_bf16 v[76:91], a[76:79], v[36:39], v[76:91]
    v_mfma_f32_32x32x16_bf16 v[92:107], a[188:191], v[36:39], v[92:107]
    s_add_u32 s41, s52, 22528
    buffer_load_dwordx4 v[20:23], v1, s[4:7], s41 offen sc1
    v_mfma_f32_32x32x16_bf16 v[108:123], a[76:79], v[40:43], v[108:123]
    v_mfma_f32_32x32x16_bf16 v[124:139], a[188:191], v[40:43], v[124:139]
    s_add_u32 s41, s53, 22528
    buffer_load_dwordx4 v[24:27], v1, s[4:7], s41 offen sc1
    s_waitcnt vmcnt(10)
    v_mfma_f32_32x32x16_bf16 v[92:107], a[192:195], v[44:47], v[92:107]
    v_mfma_f32_32x32x16_bf16 v[108:123], a[80:83], v[48:51], v[108:123]
    s_add_u32 s41, s52, 24576
    buffer_load_dwordx4 v[28:31], v1, s[4:7], s41 offen sc1
    v_mfma_f32_32x32x16_bf16 v[124:139], a[192:195], v[48:51], v[124:139]
    s_add_u32 s41, s53, 24576
    buffer_load_dwordx4 v[32:35], v1, s[4:7], s41 offen sc1
    s_waitcnt vmcnt(10)
    v_mfma_f32_32x32x16_bf16 v[92:107], a[196:199], v[52:55], v[92:107]
    v_mfma_f32_32x32x16_bf16 v[108:123], a[84:87], v[56:59], v[108:123]
    s_add_u32 s41, s52, 26624
    buffer_load_dwordx4 v[36:39], v1, s[4:7], s41 offen sc1
    v_mfma_f32_32x32x16_bf16 v[124:139], a[196:199], v[56:59], v[124:139]
    s_add_u32 s41, s53, 26624
    buffer_load_dwordx4 v[40:43], v1, s[4:7], s41 offen sc1
    s_waitcnt vmcnt(10)
    v_mfma_f32_32x32x16_bf16 v[92:107], a[200:203], v[60:63], v[92:107]
    v_mfma_f32_32x32x16_bf16 v[108:123], a[88:91], v[64:67], v[108:123]
    v_mfma_f32_32x32x16_bf16 v[124:139], a[200:203], v[64:67], v[124:139]
    s_add_u32 s40, s62, 516992
    s_add_u32 m0, s63, 12288
    s_nop 0
    buffer_load_dwordx4 v242, s[8:11], s40 offen lds
    s_add_u32 s40, s62, 517888
    s_add_u32 m0, s63, 40960
    s_nop 0
    buffer_load_dwordx4 v242, s[8:11], s40 offen lds
    s_waitcnt vmcnt(10)
    v_mfma_f32_32x32x16_bf16 v[92:107], a[204:207], v[68:71], v[92:107]
    v_mfma_f32_32x32x16_bf16 v[108:123], a[92:95], v[72:75], v[108:123]
    v_mfma_f32_32x32x16_bf16 v[124:139], a[204:207], v[72:75], v[124:139]
    s_add_u32 s40, s62, 689024
    s_add_u32 m0, s63, 16384
    s_nop 0
    buffer_load_dwordx4 v242, s[8:11], s40 offen lds
    s_add_u32 s40, s62, 689920
    s_add_u32 m0, s63, 45056
    s_nop 0
    buffer_load_dwordx4 v242, s[8:11], s40 offen lds
    s_waitcnt vmcnt(10)
    v_mfma_f32_32x32x16_bf16 v[92:107], a[208:211], v[12:15], v[92:107]
    v_mfma_f32_32x32x16_bf16 v[108:123], a[96:99], v[16:19], v[108:123]
    v_mfma_f32_32x32x16_bf16 v[124:139], a[208:211], v[16:19], v[124:139]
    s_add_u32 s40, s62, 861056
    s_add_u32 m0, s63, 20480
    s_nop 0
    buffer_load_dwordx4 v242, s[8:11], s40 offen lds
    s_add_u32 s40, s62, 861952
    s_add_u32 m0, s63, 49152
    s_nop 0
    buffer_load_dwordx4 v242, s[8:11], s40 offen lds
    s_waitcnt vmcnt(10)
    v_mfma_f32_32x32x16_bf16 v[92:107], a[212:215], v[20:23], v[92:107]
    v_mfma_f32_32x32x16_bf16 v[108:123], a[100:103], v[24:27], v[108:123]
    v_mfma_f32_32x32x16_bf16 v[124:139], a[212:215], v[24:27], v[124:139]
    s_waitcnt vmcnt(8)
    v_mfma_f32_32x32x16_bf16 v[92:107], a[216:219], v[28:31], v[92:107]
    v_mfma_f32_32x32x16_bf16 v[108:123], a[104:107], v[32:35], v[108:123]
    v_mfma_f32_32x32x16_bf16 v[124:139], a[216:219], v[32:35], v[124:139]
    s_waitcnt vmcnt(6)
    v_mfma_f32_32x32x16_bf16 v[92:107], a[220:223], v[36:39], v[92:107]
    v_mfma_f32_32x32x16_bf16 v[108:123], a[108:111], v[40:43], v[108:123]
    v_mfma_f32_32x32x16_bf16 v[124:139], a[220:223], v[40:43], v[124:139]
    v_mfma_f32_32x32x16_bf16 v[76:91], a[80:83], v[44:47], v[76:91]
    v_mfma_f32_32x32x16_bf16 v[76:91], a[84:87], v[52:55], v[76:91]
    v_mfma_f32_32x32x16_bf16 v[76:91], a[88:91], v[60:63], v[76:91]
    s_nop 6
    ds_write_b128 v213, v[92:95] offset:0
    ds_write_b128 v213, v[96:99] offset:1024
    v_mfma_f32_32x32x16_bf16 v[76:91], a[92:95], v[68:71], v[76:91]
    ds_write_b128 v213, v[100:103] offset:2048
    ds_write_b128 v213, v[104:107] offset:3072
    v_mfma_f32_32x32x16_bf16 v[76:91], a[96:99], v[12:15], v[76:91]
    ds_write_b128 v214, v[108:111] offset:0
    ds_write_b128 v214, v[112:115] offset:1024
    v_mfma_f32_32x32x16_bf16 v[76:91], a[100:103], v[20:23], v[76:91]
    ds_write_b128 v214, v[116:119] offset:2048
    ds_write_b128 v214, v[120:123] offset:3072
    v_mfma_f32_32x32x16_bf16 v[76:91], a[104:107], v[28:31], v[76:91]
    ds_write_b128 v215, v[124:127] offset:0
    ds_write_b128 v215, v[128:131] offset:1024
    v_mfma_f32_32x32x16_bf16 v[76:91], a[108:111], v[36:39], v[76:91]
    ds_write_b128 v215, v[132:135] offset:2048
    ds_write_b128 v215, v[136:139] offset:3072
    s_waitcnt lgkmcnt(0)
    s_barrier
    s_mul_i32 s41, s3, 12288
    s_add_u32 s41, s41, 81920
    v_add_u32 v212, s41, v1
    ds_read_b128 v[12:15], v212 offset:0
    ds_read_b128 v[16:19], v212 offset:1024
    ds_read_b128 v[20:23], v212 offset:2048
    ds_read_b128 v[24:27], v212 offset:3072
    ds_read_b128 v[28:31], v212 offset:4096
    ds_read_b128 v[32:35], v212 offset:5120
    ds_read_b128 v[36:39], v212 offset:6144
    ds_read_b128 v[40:43], v212 offset:7168
    ds_read_b128 v[44:47], v212 offset:8192
    ds_read_b128 v[48:51], v212 offset:9216
    ds_read_b128 v[52:55], v212 offset:10240
    ds_read_b128 v[56:59], v212 offset:11264
    s_waitcnt lgkmcnt(8)
    v_pk_add_f32 v[76:77], v[76:77], v[12:13]
    v_pk_add_f32 v[78:79], v[78:79], v[14:15]
    v_pk_add_f32 v[80:81], v[80:81], v[16:17]
    v_pk_add_f32 v[82:83], v[82:83], v[18:19]
    v_pk_add_f32 v[84:85], v[84:85], v[20:21]
    v_pk_add_f32 v[86:87], v[86:87], v[22:23]
    v_pk_add_f32 v[88:89], v[88:89], v[24:25]
    v_pk_add_f32 v[90:91], v[90:91], v[26:27]
    s_waitcnt lgkmcnt(4)
    v_pk_add_f32 v[76:77], v[76:77], v[28:29]
    v_pk_add_f32 v[78:79], v[78:79], v[30:31]
    v_pk_add_f32 v[80:81], v[80:81], v[32:33]
    v_pk_add_f32 v[82:83], v[82:83], v[34:35]
    v_pk_add_f32 v[84:85], v[84:85], v[36:37]
    v_pk_add_f32 v[86:87], v[86:87], v[38:39]
    v_pk_add_f32 v[88:89], v[88:89], v[40:41]
    v_pk_add_f32 v[90:91], v[90:91], v[42:43]
    s_waitcnt lgkmcnt(0)
    v_pk_add_f32 v[76:77], v[76:77], v[44:45]
    v_pk_add_f32 v[78:79], v[78:79], v[46:47]
    v_pk_add_f32 v[80:81], v[80:81], v[48:49]
    v_pk_add_f32 v[82:83], v[82:83], v[50:51]
    v_pk_add_f32 v[84:85], v[84:85], v[52:53]
    v_pk_add_f32 v[86:87], v[86:87], v[54:55]
    v_pk_add_f32 v[88:89], v[88:89], v[56:57]
    v_pk_add_f32 v[90:91], v[90:91], v[58:59]
    s_add_u32 s45, s84, s88
    s_add_u32 s46, s85, s91
    v_cvt_pk_bf16_f32 v164, v76, v77
    v_cvt_pk_bf16_f32 v165, v78, v79
    v_cvt_pk_bf16_f32 v166, v80, v81
    v_cvt_pk_bf16_f32 v167, v82, v83
    v_cvt_pk_bf16_f32 v168, v84, v85
    v_cvt_pk_bf16_f32 v169, v86, v87
    v_cvt_pk_bf16_f32 v170, v88, v89
    v_cvt_pk_bf16_f32 v171, v90, v91
    buffer_store_dwordx4 v[164:167], v1, s[4:7], s45 offen
    buffer_store_dwordx4 v[168:171], v1, s[4:7], s45 offen offset:1024
    v_pk_add_f32 v[176:177], v[76:77], v[78:79]
    v_pk_mul_f32 v[178:179], v[76:77], v[76:77]
    v_pk_fma_f32 v[178:179], v[78:79], v[78:79], v[178:179]
    v_pk_add_f32 v[176:177], v[176:177], v[80:81]
    v_pk_fma_f32 v[178:179], v[80:81], v[80:81], v[178:179]
    v_pk_add_f32 v[176:177], v[176:177], v[82:83]
    v_pk_fma_f32 v[178:179], v[82:83], v[82:83], v[178:179]
    v_pk_add_f32 v[176:177], v[176:177], v[84:85]
    v_pk_fma_f32 v[178:179], v[84:85], v[84:85], v[178:179]
    v_pk_add_f32 v[176:177], v[176:177], v[86:87]
    v_pk_fma_f32 v[178:179], v[86:87], v[86:87], v[178:179]
    v_pk_add_f32 v[176:177], v[176:177], v[88:89]
    v_pk_fma_f32 v[178:179], v[88:89], v[88:89], v[178:179]
    v_pk_add_f32 v[176:177], v[176:177], v[90:91]
    v_pk_fma_f32 v[178:179], v[90:91], v[90:91], v[178:179]
    v_add_f32 v172, v176, v177
    v_add_f32 v173, v178, v179
    v_mov_b32 v174, v172
    v_mov_b32 v175, v173
    s_nop 0
    v_permlane32_swap_b32 v172, v174
    v_permlane32_swap_b32 v173, v175
    v_add_f32 v172, v172, v174
    v_add_f32 v173, v173, v175
    v_lshlrev_b32 v174, 3, v2
    buffer_store_dwordx2 v[172:173], v174, s[4:7], s46 offen
    s_lshl_b32 s43, s79, 7
    s_lshl_b32 s42, s78, 2
    s_add_u32 s43, s43, s42
    s_add_u32 s43, s43, 5308416
    s_waitcnt vmcnt(0)
    s_mov_b64 exec, 1
    s_cmp_eq_u32 s19, 0
    s_cbranch_scc0 pubs_34
    buffer_store_dword v10, v6, s[4:7], s43 offen
    s_branch pubd_35
pubs_34:
    buffer_wbl2 sc1
    s_waitcnt vmcnt(0)
    buffer_store_dword v10, v6, s[4:7], s43 offen sc1
pubd_35:
    s_mov_b64 exec, -1
    s_nop 0
    s_barrier
    s_branch layer1
idle0:
    s_sub_u32 s42, s101, 112
    s_lshl_b32 s43, s16, 4
    s_add_u32 s43, s43, s42
    v_lshlrev_b32 v11, 7, v0
    s_lshl_b32 s40, s42, 13
    s_mov_b32 s52, s36
    s_and_b32 s53, s37, 0xffff
    s_mov_b32 s54, 0x188000
    s_mov_b32 s55, 0x00020000
    buffer_load_dword v20, v11, s[52:55], s40 offen
    s_add_u32 s40, s40, 131072
    buffer_load_dword v21, v11, s[52:55], s40 offen
    s_add_u32 s40, s40, 131072
    buffer_load_dword v22, v11, s[52:55], s40 offen
    s_add_u32 s40, s40, 131072
    buffer_load_dword v23, v11, s[52:55], s40 offen
    s_add_u32 s40, s40, 131072
    buffer_load_dword v24, v11, s[52:55], s40 offen
    s_add_u32 s40, s40, 131072
    buffer_load_dword v25, v11, s[52:55], s40 offen
    s_add_u32 s40, s40, 131072
    buffer_load_dword v26, v11, s[52:55], s40 offen
    s_add_u32 s40, s40, 131072
    buffer_load_dword v27, v11, s[52:55], s40 offen
    s_add_u32 s40, s40, 131072
    buffer_load_dword v20, v11, s[52:55], s40 offen
    s_add_u32 s40, s40, 131072
    buffer_load_dword v21, v11, s[52:55], s40 offen
    s_add_u32 s40, s40, 131072
    buffer_load_dword v22, v11, s[52:55], s40 offen
    s_add_u32 s40, s40, 131072
    buffer_load_dword v23, v11, s[52:55], s40 offen
    s_add_u32 s40, s40, 131072
    buffer_load_dword v24, v11, s[52:55], s40 offen
    s_add_u32 s40, s40, 131072
    s_cmp_eq_u32 s19, 0
    s_cbranch_scc0 idle_w2
    s_sub_u32 s42, s101, 112
    s_mul_i32 s40, s42, 43008
    s_mul_i32 s41, s16, 688128
    s_add_u32 s40, s40, s41
    s_add_u32 s40, s40, 33554432
    v_lshlrev_b32 v11, 7, v0
    buffer_load_dword v12, v11, s[4:7], s40 offen sc1
    s_add_u32 s40, s40, 8192
    buffer_load_dword v13, v11, s[4:7], s40 offen sc1
    s_add_u32 s40, s40, 8192
    buffer_load_dword v14, v11, s[4:7], s40 offen sc1
    s_add_u32 s40, s40, 8192
    buffer_load_dword v15, v11, s[4:7], s40 offen sc1
    s_add_u32 s40, s40, 8192
    buffer_load_dword v16, v11, s[4:7], s40 offen sc1
    s_add_u32 s40, s40, 2048
    buffer_load_dword v17, v11, s[4:7], s40 offen sc1
    s_add_u32 s40, s40, 2048
idle_w2:
    v_mov_b32 v60, -1
    v_mov_b32 v61, -1
    v_mov_b32 v62, -1
    v_mov_b32 v63, -1
    s_lshl_b32 s40, s43, 15
    s_add_u32 s40, s40, 20971520
    buffer_store_dwordx4 v[60:63], v1, s[4:7], s40 offen offset:0 sc1
    buffer_store_dwordx4 v[60:63], v1, s[4:7], s40 offen offset:1024 sc1
    buffer_store_dwordx4 v[60:63], v1, s[4:7], s40 offen offset:2048 sc1
    buffer_store_dwordx4 v[60:63], v1, s[4:7], s40 offen offset:3072 sc1
    s_add_u32 s40, s40, 4096
    buffer_store_dwordx4 v[60:63], v1, s[4:7], s40 offen offset:0 sc1
    buffer_store_dwordx4 v[60:63], v1, s[4:7], s40 offen offset:1024 sc1
    buffer_store_dwordx4 v[60:63], v1, s[4:7], s40 offen offset:2048 sc1
    buffer_store_dwordx4 v[60:63], v1, s[4:7], s40 offen offset:3072 sc1
    s_add_u32 s40, s40, 4096
    buffer_store_dwordx4 v[60:63], v1, s[4:7], s40 offen offset:0 sc1
    buffer_store_dwordx4 v[60:63], v1, s[4:7], s40 offen offset:1024 sc1
    buffer_store_dwordx4 v[60:63], v1, s[4:7], s40 offen offset:2048 sc1
    buffer_store_dwordx4 v[60:63], v1, s[4:7], s40 offen offset:3072 sc1
    s_add_u32 s40, s40, 4096
    buffer_store_dwordx4 v[60:63], v1, s[4:7], s40 offen offset:0 sc1
    buffer_store_dwordx4 v[60:63], v1, s[4:7], s40 offen offset:1024 sc1
    buffer_store_dwordx4 v[60:63], v1, s[4:7], s40 offen offset:2048 sc1
    buffer_store_dwordx4 v[60:63], v1, s[4:7], s40 offen offset:3072 sc1
    s_add_u32 s40, s40, 4096
    buffer_store_dwordx4 v[60:63], v1, s[4:7], s40 offen offset:0 sc1
    buffer_store_dwordx4 v[60:63], v1, s[4:7], s40 offen offset:1024 sc1
    buffer_store_dwordx4 v[60:63], v1, s[4:7], s40 offen offset:2048 sc1
    buffer_store_dwordx4 v[60:63], v1, s[4:7], s40 offen offset:3072 sc1
    s_add_u32 s40, s40, 4096
    buffer_store_dwordx4 v[60:63], v1, s[4:7], s40 offen offset:0 sc1
    buffer_store_dwordx4 v[60:63], v1, s[4:7], s40 offen offset:1024 sc1
    buffer_store_dwordx4 v[60:63], v1, s[4:7], s40 offen offset:2048 sc1
    buffer_store_dwordx4 v[60:63], v1, s[4:7], s40 offen offset:3072 sc1
    s_add_u32 s40, s40, 4096
    buffer_store_dwordx4 v[60:63], v1, s[4:7], s40 offen offset:0 sc1
    buffer_store_dwordx4 v[60:63], v1, s[4:7], s40 offen offset:1024 sc1
    buffer_store_dwordx4 v[60:63], v1, s[4:7], s40 offen offset:2048 sc1
    buffer_store_dwordx4 v[60:63], v1, s[4:7], s40 offen offset:3072 sc1
    s_add_u32 s40, s40, 4096
    buffer_store_dwordx4 v[60:63], v1, s[4:7], s40 offen offset:0 sc1
    buffer_store_dwordx4 v[60:63], v1, s[4:7], s40 offen offset:1024 sc1
    buffer_store_dwordx4 v[60:63], v1, s[4:7], s40 offen offset:2048 sc1
    buffer_store_dwordx4 v[60:63], v1, s[4:7], s40 offen offset:3072 sc1
    s_add_u32 s40, s40, 4096
    s_waitcnt vmcnt(0)
    v_mov_b32 v70, 1
    s_mov_b64 exec, 1
    buffer_atomic_add v70, v6, s[12:15], 0 offen offset:8 sc0 sc1
    s_waitcnt vmcnt(0)
    s_mov_b64 exec, -1
    v_readfirstlane_b32 s46, v70
    s_nop 0
    s_and_b32 s46, s46, 127
    s_cmp_eq_u32 s46, 127
    s_cbranch_scc0 ev_36
    v_lshlrev_b32 v71, 7, v0
    s_mov_b32 s46, 5316608
    buffer_store_dword v10, v71, s[4:7], s46 offen sc1
ev_36:
    s_mov_b32 s26, 1605632
    v_lshlrev_b32 v11, 7, v0
    s_sub_u32 s42, s101, 112
    s_lshl_b32 s40, s42, 13
    buffer_load_dword v20, v11, s[24:27], s40 offen
    s_add_u32 s40, s40, 131072
    buffer_load_dword v21, v11, s[24:27], s40 offen
    s_add_u32 s40, s40, 131072
    buffer_load_dword v22, v11, s[24:27], s40 offen
    s_add_u32 s40, s40, 131072
    buffer_load_dword v23, v11, s[24:27], s40 offen
    s_add_u32 s40, s40, 131072
    buffer_load_dword v24, v11, s[24:27], s40 offen
    s_add_u32 s40, s40, 131072
layer1:
    v_lshrrev_b32 v251, 2, v0
    v_mul_u32_u24 v251, 2688, v251
    v_and_b32 v11, 3, v0
    v_lshl_add_u32 v251, v11, 4, v251
    s_mov_b32 s28, s8
    s_mov_b32 s29, s9
    s_cmp_ge_u32 s21, 14
    s_cselect_b32 s30, 0, s10
    s_mov_b32 s31, 0x00020000
    s_add_u32 s40, s62, 1033088
    s_add_u32 m0, s0, 24576
    s_nop 0
    buffer_load_dwordx4 v251, s[28:31], s40 offen lds
    s_add_u32 s40, s62, 1033984
    s_add_u32 m0, s0, 53248
    s_nop 0
    buffer_load_dwordx4 v251, s[28:31], s40 offen lds
    s_add_u32 s42, s67, 65536
poll_37:
    s_add_u32 s50, s50, 1
    s_cmp_gt_u32 s50, 0x40000
    s_cbranch_scc1 pollx_38
    buffer_load_dword v9, v5, s[4:7], s42 offen sc1
    s_waitcnt vmcnt(0)
    v_cmp_eq_u32 vcc, 1, v9
    s_nop 0
    s_and_b32 s51, vcc_lo, 0x3fff
    s_cmp_eq_u32 s51, 0x3fff
    s_cbranch_scc0 poll_37
pollx_38:
    s_cmp_eq_u32 s19, 0
    s_cbranch_scc1 acq_39
    buffer_inv sc1
    s_waitcnt vmcnt(0)
acq_39:
    v_and_b32 v249, 19, v0
    v_cmp_eq_u32 vcc, 19, v249
    v_mov_b32 v249, s18
    s_nop 0
    v_cndmask_b32_e64 v249, v249, 0, vcc
    v_add_u32 v248, v249, v7
    v_add_u32 v249, 0x10000, v248
    s_add_u32 s43, s64, s88
    s_add_u32 s44, s65, s91
    s_add_u32 s41, s43, 0
    buffer_load_dwordx4 v[12:15], v1, s[4:7], s41 offen sc1
    s_add_u32 s41, s43, 1024
    buffer_load_dwordx4 v[16:19], v1, s[4:7], s41 offen sc1
    s_add_u32 s41, s43, 2048
    buffer_load_dwordx4 v[20:23], v1, s[4:7], s41 offen sc1
    s_add_u32 s41, s43, 3072
    buffer_load_dwordx4 v[24:27], v1, s[4:7], s41 offen sc1
    s_add_u32 s41, s43, 4096
    buffer_load_dwordx4 v[28:31], v1, s[4:7], s41 offen sc1
    s_add_u32 s41, s43, 5120
    buffer_load_dwordx4 v[32:35], v1, s[4:7], s41 offen sc1
    s_add_u32 s41, s43, 6144
    buffer_load_dwordx4 v[36:39], v1, s[4:7], s41 offen sc1
    s_add_u32 s41, s43, 7168
    buffer_load_dwordx4 v[40:43], v1, s[4:7], s41 offen sc1
    s_barrier
    ds_read_b64_tr_b16 v[172:173], v248 offset:0
    ds_read_b64_tr_b16 v[174:175], v248 offset:512
    ds_read_b64_tr_b16 v[176:177], v248 offset:28672
    ds_read_b64_tr_b16 v[178:179], v248 offset:29184
    ds_read_b64_tr_b16 v[180:181], v248 offset:1024
    ds_read_b64_tr_b16 v[182:183], v248 offset:1536
    ds_read_b64_tr_b16 v[184:185], v248 offset:29696
    ds_read_b64_tr_b16 v[186:187], v248 offset:30208
    s_waitcnt vmcnt(7) lgkmcnt(4)
    v_mfma_f32_32x32x16_bf16 v[124:139], v[172:175], v[12:15], 0
    ds_read_b64_tr_b16 v[188:189], v248 offset:2048
    ds_read_b64_tr_b16 v[190:191], v248 offset:2560
    v_mfma_f32_32x32x16_bf16 v[140:155], v[12:15], v[176:179], 0
    ds_read_b64_tr_b16 v[192:193], v248 offset:30720
    ds_read_b64_tr_b16 v[194:195], v248 offset:31232
    s_add_u32 s41, s43, 8192
    buffer_load_dwordx4 v[44:47], v1, s[4:7], s41 offen sc1
    s_waitcnt vmcnt(7) lgkmcnt(4)
    v_mfma_f32_32x32x16_bf16 v[124:139], v[180:183], v[16:19], v[124:139]
    ds_read_b64_tr_b16 v[172:173], v248 offset:3072
    ds_read_b64_tr_b16 v[174:175], v248 offset:3584
    v_mfma_f32_32x32x16_bf16 v[140:155], v[16:19], v[184:187], v[140:155]
    ds_read_b64_tr_b16 v[176:177], v248 offset:31744
    ds_read_b64_tr_b16 v[178:179], v248 offset:32256
    s_add_u32 s41, s43, 9216
    buffer_load_dwordx4 v[48:51], v1, s[4:7], s41 offen sc1
    s_waitcnt vmcnt(7) lgkmcnt(4)
    v_mfma_f32_32x32x16_bf16 v[124:139], v[188:191], v[20:23], v[124:139]
    ds_read_b64_tr_b16 v[180:181], v248 offset:4096
    ds_read_b64_tr_b16 v[182:183], v248 offset:4608
    v_mfma_f32_32x32x16_bf16 v[140:155], v[20:23], v[192:195], v[140:155]
    ds_read_b64_tr_b16 v[184:185], v248 offset:32768
    ds_read_b64_tr_b16 v[186:187], v248 offset:33280
    s_add_u32 s41, s43, 10240
    buffer_load_dwordx4 v[52:55], v1, s[4:7], s41 offen sc1
    buffer_load_dwordx2 v[196:197], v4, s[4:7], s44 offen offset:0 sc1
    buffer_load_dwordx2 v[198:199], v4, s[4:7], s44 offen offset:512 sc1
    buffer_load_dwordx2 v[200:201], v4, s[4:7], s44 offen offset:1024 sc1
    buffer_load_dwordx2 v[202:203], v4, s[4:7], s44 offen offset:1536 sc1
    s_add_u32 s40, s62, 0
    s_add_u32 m0, s0, 57344
    s_nop 0
    buffer_load_dwordx4 v251, s[28:31], s40 offen lds
    s_waitcnt vmcnt(12) lgkmcnt(4)
    v_mfma_f32_32x32x16_bf16 v[124:139], v[172:175], v[24:27], v[124:139]
    ds_read_b64_tr_b16 v[188:189], v248 offset:5120
    ds_read_b64_tr_b16 v[190:191], v248 offset:5632
    v_mfma_f32_32x32x16_bf16 v[140:155], v[24:27], v[176:179], v[140:155]
    ds_read_b64_tr_b16 v[192:193], v248 offset:33792
    ds_read_b64_tr_b16 v[194:195], v248 offset:34304
    s_add_u32 s41, s43, 11264
    buffer_load_dwordx4 v[56:59], v1, s[4:7], s41 offen sc1
    buffer_load_dwordx2 v[204:205], v4, s[4:7], s44 offen offset:2048 sc1
    buffer_load_dwordx2 v[206:207], v4, s[4:7], s44 offen offset:2560 sc1
    buffer_load_dwordx2 v[208:209], v4, s[4:7], s44 offen offset:3072 sc1
    s_add_u32 s40, s62, 172032
    s_add_u32 m0, s0, 61440
    s_nop 0
    buffer_load_dwordx4 v251, s[28:31], s40 offen lds
    s_waitcnt vmcnt(16) lgkmcnt(4)
    v_mfma_f32_32x32x16_bf16 v[124:139], v[180:183], v[28:31], v[124:139]
    ds_read_b64_tr_b16 v[172:173], v248 offset:6144
    ds_read_b64_tr_b16 v[174:175], v248 offset:6656
    v_mfma_f32_32x32x16_bf16 v[140:155], v[28:31], v[184:187], v[140:155]
    ds_read_b64_tr_b16 v[176:177], v248 offset:34816
    ds_read_b64_tr_b16 v[178:179], v248 offset:35328
    s_add_u32 s41, s43, 12288
    buffer_load_dwordx4 v[60:63], v1, s[4:7], s41 offen sc1
    s_add_u32 s40, s62, 344064
    s_add_u32 m0, s0, 65536
    s_nop 0
    buffer_load_dwordx4 v251, s[28:31], s40 offen lds
    s_waitcnt vmcnt(17) lgkmcnt(4)
    v_mfma_f32_32x32x16_bf16 v[124:139], v[188:191], v[32:35], v[124:139]
    ds_read_b64_tr_b16 v[180:181], v248 offset:7168
    ds_read_b64_tr_b16 v[182:183], v248 offset:7680
    v_mfma_f32_32x32x16_bf16 v[140:155], v[32:35], v[192:195], v[140:155]
    ds_read_b64_tr_b16 v[184:185], v248 offset:35840
    ds_read_b64_tr_b16 v[186:187], v248 offset:36352
    s_add_u32 s41, s43, 13312
    buffer_load_dwordx4 v[64:67], v1, s[4:7], s41 offen sc1
    s_add_u32 s40, s62, 516096
    s_add_u32 m0, s0, 69632
    s_nop 0
    buffer_load_dwordx4 v251, s[28:31], s40 offen lds
    s_waitcnt vmcnt(18) lgkmcnt(4)
    v_mfma_f32_32x32x16_bf16 v[124:139], v[172:175], v[36:39], v[124:139]
    s_barrier
    ds_read_b64_tr_b16 v[188:189], v248 offset:8192
    ds_read_b64_tr_b16 v[190:191], v248 offset:8704
    v_mfma_f32_32x32x16_bf16 v[140:155], v[36:39], v[176:179], v[140:155]
    ds_read_b64_tr_b16 v[192:193], v248 offset:36864
    ds_read_b64_tr_b16 v[194:195], v248 offset:37376
    s_add_u32 s41, s43, 14336
    buffer_load_dwordx4 v[68:71], v1, s[4:7], s41 offen sc1
    s_add_u32 s40, s62, 688128
    s_add_u32 m0, s0, 73728
    s_nop 0
    buffer_load_dwordx4 v251, s[28:31], s40 offen lds
    s_waitcnt vmcnt(19) lgkmcnt(4)
    v_mfma_f32_32x32x16_bf16 v[124:139], v[180:183], v[40:43], v[124:139]
    ds_read_b64_tr_b16 v[172:173], v248 offset:9216
    ds_read_b64_tr_b16 v[174:175], v248 offset:9728
    v_mfma_f32_32x32x16_bf16 v[140:155], v[40:43], v[184:187], v[140:155]
    ds_read_b64_tr_b16 v[176:177], v248 offset:37888
    ds_read_b64_tr_b16 v[178:179], v248 offset:38400
    s_add_u32 s41, s43, 15360
    buffer_load_dwordx4 v[72:75], v1, s[4:7], s41 offen sc1
    s_add_u32 s40, s62, 860160
    s_add_u32 m0, s0, 77824
    s_nop 0
    buffer_load_dwordx4 v251, s[28:31], s40 offen lds
    s_waitcnt vmcnt(20) lgkmcnt(4)
    v_mfma_f32_32x32x16_bf16 v[124:139], v[188:191], v[44:47], v[124:139]
    ds_read_b64_tr_b16 v[180:181], v248 offset:10240
    ds_read_b64_tr_b16 v[182:183], v248 offset:10752
    v_mfma_f32_32x32x16_bf16 v[140:155], v[44:47], v[192:195], v[140:155]
    ds_read_b64_tr_b16 v[184:185], v248 offset:38912
    ds_read_b64_tr_b16 v[186:187], v248 offset:39424
    s_add_u32 s41, s43, 16384
    buffer_load_dwordx4 v[76:79], v1, s[4:7], s41 offen sc1
    s_add_u32 s40, s62, 1032192
    s_add_u32 m0, s0, 81920
    s_nop 0
    buffer_load_dwordx4 v251, s[28:31], s40 offen lds
    s_waitcnt vmcnt(21) lgkmcnt(4)
    v_mfma_f32_32x32x16_bf16 v[124:139], v[172:175], v[48:51], v[124:139]
    ds_read_b64_tr_b16 v[188:189], v248 offset:11264
    ds_read_b64_tr_b16 v[190:191], v248 offset:11776
    v_mfma_f32_32x32x16_bf16 v[140:155], v[48:51], v[176:179], v[140:155]
    ds_read_b64_tr_b16 v[192:193], v248 offset:39936
    ds_read_b64_tr_b16 v[194:195], v248 offset:40448
    s_add_u32 s41, s43, 17408
    buffer_load_dwordx4 v[80:83], v1, s[4:7], s41 offen sc1
    s_waitcnt vmcnt(21) lgkmcnt(4)
    v_mfma_f32_32x32x16_bf16 v[124:139], v[180:183], v[52:55], v[124:139]
    ds_read_b64_tr_b16 v[172:173], v248 offset:12288
    ds_read_b64_tr_b16 v[174:175], v248 offset:12800
    v_mfma_f32_32x32x16_bf16 v[140:155], v[52:55], v[184:187], v[140:155]
    ds_read_b64_tr_b16 v[176:177], v248 offset:40960
    ds_read_b64_tr_b16 v[178:179], v248 offset:41472
    s_add_u32 s41, s43, 18432
    buffer_load_dwordx4 v[84:87], v1, s[4:7], s41 offen sc1
    s_waitcnt vmcnt(16) lgkmcnt(4)
    v_mfma_f32_32x32x16_bf16 v[124:139], v[188:191], v[56:59], v[124:139]
    ds_read_b64_tr_b16 v[180:181], v248 offset:13312
    ds_read_b64_tr_b16 v[182:183], v248 offset:13824
    v_mfma_f32_32x32x16_bf16 v[140:155], v[56:59], v[192:195], v[140:155]
    ds_read_b64_tr_b16 v[184:185], v248 offset:41984
    ds_read_b64_tr_b16 v[186:187], v248 offset:42496
    s_add_u32 s41, s43, 19456
    buffer_load_dwordx4 v[88:91], v1, s[4:7], s41 offen sc1
    s_waitcnt vmcnt(12) lgkmcnt(4)
    v_mfma_f32_32x32x16_bf16 v[124:139], v[172:175], v[60:63], v[124:139]
    ds_read_b64_tr_b16 v[188:189], v248 offset:14336
    ds_read_b64_tr_b16 v[190:191], v248 offset:14848
    v_mfma_f32_32x32x16_bf16 v[140:155], v[60:63], v[176:179], v[140:155]
    ds_read_b64_tr_b16 v[192:193], v248 offset:43008
    ds_read_b64_tr_b16 v[194:195], v248 offset:43520
    s_add_u32 s41, s43, 20480
    buffer_load_dwordx4 v[92:95], v1, s[4:7], s41 offen sc1
    s_waitcnt vmcnt(11) lgkmcnt(4)
    v_mfma_f32_32x32x16_bf16 v[124:139], v[180:183], v[64:67], v[124:139]
    v_add_f32 v196, v196, v198
    v_add_f32 v197, v197, v199
    ds_read_b64_tr_b16 v[172:173], v248 offset:15360
    ds_read_b64_tr_b16 v[174:175], v248 offset:15872
    v_mfma_f32_32x32x16_bf16 v[140:155], v[64:67], v[184:187], v[140:155]
    v_add_f32 v196, v196, v200
    v_add_f32 v197, v197, v201
    v_add_f32 v196, v196, v202
    ds_read_b64_tr_b16 v[176:177], v248 offset:44032
    ds_read_b64_tr_b16 v[178:179], v248 offset:44544
    s_add_u32 s41, s43, 21504
    buffer_load_dwordx4 v[96:99], v1, s[4:7], s41 offen sc1
    s_waitcnt vmcnt(10) lgkmcnt(4)
    v_mfma_f32_32x32x16_bf16 v[124:139], v[188:191], v[68:71], v[124:139]
    v_add_f32 v197, v197, v203
    v_add_f32 v196, v196, v204
    v_add_f32 v197, v197, v205
    s_barrier
    ds_read_b64_tr_b16 v[180:181], v248 offset:16384
    ds_read_b64_tr_b16 v[182:183], v248 offset:16896
    v_mfma_f32_32x32x16_bf16 v[140:155], v[68:71], v[192:195], v[140:155]
    v_add_f32 v196, v196, v206
    v_add_f32 v197, v197, v207
    v_add_f32 v196, v196, v208
    ds_read_b64_tr_b16 v[184:185], v248 offset:45056
    ds_read_b64_tr_b16 v[186:187], v248 offset:45568
    s_add_u32 s41, s43, 22528
    buffer_load_dwordx4 v[100:103], v1, s[4:7], s41 offen sc1
    s_waitcnt vmcnt(9) lgkmcnt(4)
    v_mfma_f32_32x32x16_bf16 v[124:139], v[172:175], v[72:75], v[124:139]
    v_add_f32 v197, v197, v209
    v_mov_b32 v244, v196
    v_mov_b32 v245, v197
    ds_read_b64_tr_b16 v[188:189], v248 offset:17408
    ds_read_b64_tr_b16 v[190:191], v248 offset:17920
    v_mfma_f32_32x32x16_bf16 v[140:155], v[72:75], v[176:179], v[140:155]
    v_permlane32_swap_b32 v196, v244
    v_permlane32_swap_b32 v197, v245
    v_add_f32 v196, v196, v244
    ds_read_b64_tr_b16 v[192:193], v248 offset:46080
    ds_read_b64_tr_b16 v[194:195], v248 offset:46592
    s_add_u32 s41, s43, 23552
    buffer_load_dwordx4 v[104:107], v1, s[4:7], s41 offen sc1
    s_waitcnt vmcnt(8) lgkmcnt(4)
    v_mfma_f32_32x32x16_bf16 v[124:139], v[180:183], v[76:79], v[124:139]
    v_add_f32 v197, v197, v245
    v_mul_f32 v240, 0xbb124925, v196
    v_mul_f32 v241, 0x3b124925, v197
    ds_read_b64_tr_b16 v[172:173], v248 offset:18432
    ds_read_b64_tr_b16 v[174:175], v248 offset:18944
    v_mfma_f32_32x32x16_bf16 v[140:155], v[76:79], v[184:187], v[140:155]
    v_fma_f32 v241, -v240, v240, v241
    v_max_f32 v241, 0, v241
    v_add_f32 v241, 0x3727c5ac, v241
    ds_read_b64_tr_b16 v[176:177], v248 offset:47104
    ds_read_b64_tr_b16 v[178:179], v248 offset:47616
    s_add_u32 s41, s43, 24576
    buffer_load_dwordx4 v[108:111], v1, s[4:7], s41 offen sc1
    s_waitcnt vmcnt(7) lgkmcnt(4)
    v_mfma_f32_32x32x16_bf16 v[124:139], v[188:191], v[80:83], v[124:139]
    v_rsq_f32 v242, v241
    v_sqrt_f32 v243, v241
    v_cmp_eq_u32 vcc, 0, v3
    ds_read_b64_tr_b16 v[180:181], v248 offset:19456
    ds_read_b64_tr_b16 v[182:183], v248 offset:19968
    v_mfma_f32_32x32x16_bf16 v[140:155], v[80:83], v[192:195], v[140:155]
    v_mul_f32 v246, 0x3e8b97f6, v242
    v_cvt_pk_bf16_f32 v237, v240, v243
    v_mov_b32 v239, 0
    ds_read_b64_tr_b16 v[184:185], v248 offset:48128
    ds_read_b64_tr_b16 v[186:187], v248 offset:48640
    s_add_u32 s41, s43, 25600
    buffer_load_dwordx4 v[112:115], v1, s[4:7], s41 offen sc1
    s_waitcnt vmcnt(7) lgkmcnt(4)
    v_mfma_f32_32x32x16_bf16 v[124:139], v[172:175], v[84:87], v[124:139]
    v_lshlrev_b32 v244, 16, v237
    v_and_b32 v245, 0xffff0000, v237
    v_sub_f32 v236, v240, v244
    ds_read_b64_tr_b16 v[188:189], v248 offset:20480
    ds_read_b64_tr_b16 v[190:191], v248 offset:20992
    v_mfma_f32_32x32x16_bf16 v[140:155], v[84:87], v[176:179], v[140:155]
    v_sub_f32 v245, v243, v245
    v_cvt_pk_bf16_f32 v236, v244, v236
    v_cvt_pk_bf16_f32 v238, v245, v239
    ds_read_b64_tr_b16 v[192:193], v248 offset:49152
    ds_read_b64_tr_b16 v[194:195], v248 offset:49664
    s_add_u32 s41, s43, 26624
    buffer_load_dwordx4 v[116:119], v1, s[4:7], s41 offen sc1
    s_waitcnt vmcnt(7) lgkmcnt(4)
    v_mfma_f32_32x32x16_bf16 v[124:139], v[180:183], v[88:91], v[124:139]
    v_cndmask_b32 v247, 0, v246, vcc
    s_lshl_b32 s46, s3, 13
    s_add_u32 s46, s46, 86016
    ds_read_b64_tr_b16 v[172:173], v248 offset:21504
    ds_read_b64_tr_b16 v[174:175], v248 offset:22016
    v_mfma_f32_32x32x16_bf16 v[140:155], v[88:91], v[184:187], v[140:155]
    v_lshl_add_u32 v244, v2, 2, s46
    ds_write_b32 v244, v242
    ds_write_b32 v244, v6 offset:128
    ds_read_b64_tr_b16 v[176:177], v248 offset:50176
    ds_read_b64_tr_b16 v[178:179], v248 offset:50688
    s_add_u32 s41, s43, 27648
    buffer_load_dwordx4 v[120:123], v1, s[4:7], s41 offen sc1
    s_waitcnt vmcnt(7) lgkmcnt(6)
    v_mfma_f32_32x32x16_bf16 v[124:139], v[188:191], v[92:95], v[124:139]
    v_lshl_add_u32 v245, v3, 4, s46
    v_cmp_lt_u32 vcc, 27, v2
    v_add_u32 v244, 128, v245
    s_nop 0
    v_cndmask_b32 v245, v245, v244, vcc
    s_waitcnt lgkmcnt(2)
    ds_read_b128 v[196:199], v245 offset:0
    ds_read_b64_tr_b16 v[180:181], v248 offset:22528
    ds_read_b64_tr_b16 v[182:183], v248 offset:23040
    v_mfma_f32_32x32x16_bf16 v[140:155], v[92:95], v[192:195], v[140:155]
    ds_read_b128 v[200:203], v245 offset:32
    ds_read_b128 v[204:207], v245 offset:64
    ds_read_b128 v[208:211], v245 offset:96
    ds_read_b64_tr_b16 v[184:185], v248 offset:51200
    ds_read_b64_tr_b16 v[186:187], v248 offset:51712
    s_waitcnt vmcnt(6) lgkmcnt(8)
    v_mfma_f32_32x32x16_bf16 v[124:139], v[172:175], v[96:99], v[124:139]
    ds_read_b64_tr_b16 v[188:189], v248 offset:23552
    ds_read_b64_tr_b16 v[190:191], v248 offset:24064
    v_mfma_f32_32x32x16_bf16 v[140:155], v[96:99], v[176:179], v[140:155]
    ds_read_b64_tr_b16 v[192:193], v248 offset:52224
    ds_read_b64_tr_b16 v[194:195], v248 offset:52736
    s_add_u32 s58, s67, 73728
    buffer_load_dword v224, v6, s[4:7], s58 offen sc1
    s_waitcnt vmcnt(6) lgkmcnt(4)
    v_mfma_f32_32x32x16_bf16 v[124:139], v[180:183], v[100:103], v[124:139]
    s_barrier
    ds_read_b64_tr_b16 v[172:173], v248 offset:24576
    ds_read_b64_tr_b16 v[174:175], v248 offset:25088
    v_mfma_f32_32x32x16_bf16 v[140:155], v[100:103], v[184:187], v[140:155]
    ds_read_b64_tr_b16 v[176:177], v248 offset:53248
    ds_read_b64_tr_b16 v[178:179], v248 offset:53760
    s_waitcnt vmcnt(5) lgkmcnt(4)
    v_mfma_f32_32x32x16_bf16 v[124:139], v[188:191], v[104:107], v[124:139]
    ds_read_b64_tr_b16 v[180:181], v248 offset:25600
    ds_read_b64_tr_b16 v[182:183], v248 offset:26112
    v_mfma_f32_32x32x16_bf16 v[140:155], v[104:107], v[192:195], v[140:155]
    ds_read_b64_tr_b16 v[184:185], v248 offset:54272
    ds_read_b64_tr_b16 v[186:187], v248 offset:54784
    s_waitcnt vmcnt(4) lgkmcnt(4)
    v_mfma_f32_32x32x16_bf16 v[124:139], v[172:175], v[108:111], v[124:139]
    ds_read_b64_tr_b16 v[188:189], v248 offset:26624
    ds_read_b64_tr_b16 v[190:191], v248 offset:27136
    v_mfma_f32_32x32x16_bf16 v[140:155], v[108:111], v[176:179], v[140:155]
    ds_read_b64_tr_b16 v[192:193], v248 offset:55296
    ds_read_b64_tr_b16 v[194:195], v248 offset:55808
    s_waitcnt vmcnt(3) lgkmcnt(4)
    v_mfma_f32_32x32x16_bf16 v[124:139], v[180:183], v[112:115], v[124:139]
    ds_read_b64_tr_b16 v[172:173], v248 offset:27648
    ds_read_b64_tr_b16 v[174:175], v248 offset:28160
    v_mfma_f32_32x32x16_bf16 v[140:155], v[112:115], v[184:187], v[140:155]
    ds_read_b64_tr_b16 v[176:177], v248 offset:56320
    ds_read_b64_tr_b16 v[178:179], v248 offset:56832
    s_waitcnt vmcnt(2) lgkmcnt(4)
    v_mfma_f32_32x32x16_bf16 v[124:139], v[188:191], v[116:119], v[124:139]
    v_mfma_f32_32x32x16_bf16 v[140:155], v[116:119], v[192:195], v[140:155]
    s_waitcnt vmcnt(1) lgkmcnt(0)
    v_mfma_f32_32x32x16_bf16 v[124:139], v[172:175], v[120:123], v[124:139]
    v_mfma_f32_32x32x16_bf16 v[140:155], v[120:123], v[176:179], v[140:155]
    v_mfma_f32_32x32x16_bf16 v[124:139], a[244:247], v[236:239], v[124:139]
    v_mfma_f32_32x32x16_bf16 v[140:155], v[236:239], a[248:251], v[140:155]
    s_waitcnt vmcnt(0)
    s_nop 4
    s_branch r2c_41
r2p_40:
    s_add_u32 s50, s50, 1
    s_cmp_gt_u32 s50, 0x40000
    s_nop 0
    s_cbranch_scc1 r2x_42
    s_sleep 4
    buffer_load_dword v224, v6, s[4:7], s58 offen sc1
    s_waitcnt vmcnt(0)
r2c_41:
    v_readfirstlane_b32 s42, v224
    s_nop 0
    s_cmp_eq_u32 s42, 1
    s_cbranch_scc0 r2p_40
r2x_42:
    v_mul_f32 v124, v242, v124
    v_mul_f32 v125, v242, v125
    v_mul_f32 v126, v242, v126
    v_mul_f32 v127, v242, v127
    v_mul_f32 v128, v242, v128
    v_mul_f32 v129, v242, v129
    v_mul_f32 v130, v242, v130
    v_mul_f32 v131, v242, v131
    v_mul_f32 v132, v242, v132
    v_mul_f32 v133, v242, v133
    v_mul_f32 v134, v242, v134
    v_mul_f32 v135, v242, v135
    v_mul_f32 v136, v242, v136
    v_mul_f32 v137, v242, v137
    v_mul_f32 v138, v242, v138
    v_mul_f32 v139, v242, v139
    v_cvt_pk_bf16_f32 v212, v124, v125
    v_cvt_pk_bf16_f32 v213, v126, v127
    v_cvt_pk_bf16_f32 v214, v128, v129
    v_cvt_pk_bf16_f32 v215, v130, v131
    v_cvt_pk_bf16_f32 v216, v132, v133
    v_cvt_pk_bf16_f32 v217, v134, v135
    v_cvt_pk_bf16_f32 v218, v136, v137
    v_cvt_pk_bf16_f32 v219, v138, v139
    s_add_u32 s47, s66, 20971520
    buffer_store_dwordx4 v[212:215], v1, s[4:7], s47 offen sc1
    buffer_store_dwordx4 v[216:219], v1, s[4:7], s47 offen offset:1024 sc1
    s_barrier
    ds_read_b64_tr_b16 v[172:173], v248 offset:57344
    ds_read_b64_tr_b16 v[174:175], v248 offset:57856
    ds_read_b64_tr_b16 v[176:177], v248 offset:58368
    ds_read_b64_tr_b16 v[178:179], v248 offset:58880
    ds_read_b64_tr_b16 v[180:181], v248 offset:59392
    ds_read_b64_tr_b16 v[182:183], v248 offset:59904
    ds_read_b64_tr_b16 v[184:185], v248 offset:60416
    ds_read_b64_tr_b16 v[186:187], v248 offset:60928
    ds_read_b64_tr_b16 v[188:189], v248 offset:61440
    ds_read_b64_tr_b16 v[190:191], v248 offset:61952
    s_waitcnt lgkmcnt(8)
    v_mfma_f32_32x32x16_bf16 v[156:171], v[172:175], v[12:15], 0
    v_cmp_eq_u32 vcc, 28, v2
    s_nop 1
    v_cndmask_b32_e64 v245, 0, 1.0, vcc
    v_fma_f32 v140, v196, v140, v245
    v_fma_f32 v141, v197, v141, v245
    v_fma_f32 v142, v198, v142, v245
    v_fma_f32 v143, v199, v143, v245
    ds_read_b64_tr_b16 v[192:193], v248 offset:62464
    ds_read_b64_tr_b16 v[194:195], v248 offset:62976
    s_waitcnt lgkmcnt(8)
    v_mfma_f32_32x32x16_bf16 v[156:171], v[176:179], v[16:19], v[156:171]
    v_fma_f32 v144, v200, v144, v245
    v_fma_f32 v145, v201, v145, v245
    v_fma_f32 v146, v202, v146, v245
    v_fma_f32 v147, v203, v147, v245
    v_fma_f32 v148, v204, v148, v245
    ds_read_b64_tr_b16 v[172:173], v248 offset:63488
    ds_read_b64_tr_b16 v[174:175], v248 offset:64000
    s_waitcnt lgkmcnt(8)
    v_mfma_f32_32x32x16_bf16 v[156:171], v[180:183], v[20:23], v[156:171]
    v_fma_f32 v149, v205, v149, v245
    v_fma_f32 v150, v206, v150, v245
    v_fma_f32 v151, v207, v151, v245
    v_fma_f32 v152, v208, v152, v245
    v_fma_f32 v153, v209, v153, v245
    ds_read_b64_tr_b16 v[176:177], v248 offset:64512
    ds_read_b64_tr_b16 v[178:179], v248 offset:65024
    s_waitcnt lgkmcnt(8)
    v_mfma_f32_32x32x16_bf16 v[156:171], v[184:187], v[24:27], v[156:171]
    v_fma_f32 v154, v210, v154, v245
    v_fma_f32 v155, v211, v155, v245
    v_cvt_pk_bf16_f32 v228, v140, v141
    v_cvt_pk_bf16_f32 v229, v142, v143
    v_cvt_pk_bf16_f32 v230, v144, v145
    ds_read_b64_tr_b16 v[180:181], v249 offset:0
    ds_read_b64_tr_b16 v[182:183], v249 offset:512
    s_waitcnt lgkmcnt(8)
    v_mfma_f32_32x32x16_bf16 v[156:171], v[188:191], v[28:31], v[156:171]
    v_cvt_pk_bf16_f32 v231, v146, v147
    v_cvt_pk_bf16_f32 v232, v148, v149
    v_cvt_pk_bf16_f32 v233, v150, v151
    v_cvt_pk_bf16_f32 v234, v152, v153
    v_cvt_pk_bf16_f32 v235, v154, v155
    ds_read_b64_tr_b16 v[184:185], v249 offset:1024
    ds_read_b64_tr_b16 v[186:187], v249 offset:1536
    s_waitcnt lgkmcnt(8)
    v_mfma_f32_32x32x16_bf16 v[156:171], v[192:195], v[32:35], v[156:171]
    buffer_store_dwordx4 v[228:231], v1, s[4:7], s47 offen offset:2048 sc1
    buffer_store_dwordx4 v[232:235], v1, s[4:7], s47 offen offset:3072 sc1
    s_add_u32 s48, s3, 8
    s_cmp_eq_u32 s3, 3
    s_cselect_b32 s48, 6, s48
    s_lshl_b32 s48, s48, 12
    s_add_u32 s48, s48, 86016
    ds_read_b64_tr_b16 v[188:189], v249 offset:2048
    ds_read_b64_tr_b16 v[190:191], v249 offset:2560
    s_waitcnt lgkmcnt(8)
    v_mfma_f32_32x32x16_bf16 v[156:171], v[172:175], v[36:39], v[156:171]
    v_add_u32 v244, s48, v1
    ds_write_b128 v244, v[212:215]
    ds_write_b128 v244, v[216:219] offset:1024
    ds_write_b128 v244, v[228:231] offset:2048
    ds_write_b128 v244, v[232:235] offset:3072
    ds_read_b64_tr_b16 v[192:193], v249 offset:3072
    ds_read_b64_tr_b16 v[194:195], v249 offset:3584
    s_waitcnt lgkmcnt(12)
    v_mfma_f32_32x32x16_bf16 v[156:171], v[176:179], v[40:43], v[156:171]
    ds_read_b64_tr_b16 v[172:173], v249 offset:4096
    ds_read_b64_tr_b16 v[174:175], v249 offset:4608
    s_waitcnt lgkmcnt(12)
    v_mfma_f32_32x32x16_bf16 v[156:171], v[180:183], v[44:47], v[156:171]
    ds_read_b64_tr_b16 v[176:177], v249 offset:5120
    ds_read_b64_tr_b16 v[178:179], v249 offset:5632
    s_waitcnt lgkmcnt(12)
    v_mfma_f32_32x32x16_bf16 v[156:171], v[184:187], v[48:51], v[156:171]
    ds_read_b64_tr_b16 v[180:181], v249 offset:6144
    ds_read_b64_tr_b16 v[182:183], v249 offset:6656
    s_waitcnt lgkmcnt(12)
    v_mfma_f32_32x32x16_bf16 v[156:171], v[188:191], v[52:55], v[156:171]
    ds_read_b64_tr_b16 v[184:185], v249 offset:7168
    ds_read_b64_tr_b16 v[186:187], v249 offset:7680
    s_waitcnt lgkmcnt(8)
    v_mfma_f32_32x32x16_bf16 v[156:171], v[192:195], v[56:59], v[156:171]
    ds_read_b64_tr_b16 v[188:189], v249 offset:8192
    ds_read_b64_tr_b16 v[190:191], v249 offset:8704
    s_waitcnt lgkmcnt(8)
    v_mfma_f32_32x32x16_bf16 v[156:171], v[172:175], v[60:63], v[156:171]
    ds_read_b64_tr_b16 v[192:193], v249 offset:9216
    ds_read_b64_tr_b16 v[194:195], v249 offset:9728
    s_waitcnt lgkmcnt(8)
    v_mfma_f32_32x32x16_bf16 v[156:171], v[176:179], v[64:67], v[156:171]
    ds_read_b64_tr_b16 v[172:173], v249 offset:10240
    ds_read_b64_tr_b16 v[174:175], v249 offset:10752
    s_waitcnt lgkmcnt(8)
    v_mfma_f32_32x32x16_bf16 v[156:171], v[180:183], v[68:71], v[156:171]
    ds_read_b64_tr_b16 v[176:177], v249 offset:11264
    ds_read_b64_tr_b16 v[178:179], v249 offset:11776
    s_waitcnt lgkmcnt(8)
    v_mfma_f32_32x32x16_bf16 v[156:171], v[184:187], v[72:75], v[156:171]
    ds_read_b64_tr_b16 v[180:181], v249 offset:12288
    ds_read_b64_tr_b16 v[182:183], v249 offset:12800
    s_waitcnt lgkmcnt(8)
    v_mfma_f32_32x32x16_bf16 v[156:171], v[188:191], v[76:79], v[156:171]
    ds_read_b64_tr_b16 v[184:185], v249 offset:13312
    ds_read_b64_tr_b16 v[186:187], v249 offset:13824
    s_waitcnt lgkmcnt(8)
    v_mfma_f32_32x32x16_bf16 v[156:171], v[192:195], v[80:83], v[156:171]
    ds_read_b64_tr_b16 v[188:189], v249 offset:14336
    ds_read_b64_tr_b16 v[190:191], v249 offset:14848
    s_waitcnt lgkmcnt(8)
    v_mfma_f32_32x32x16_bf16 v[156:171], v[172:175], v[84:87], v[156:171]
    ds_read_b64_tr_b16 v[192:193], v249 offset:15360
    ds_read_b64_tr_b16 v[194:195], v249 offset:15872
    s_waitcnt lgkmcnt(8)
    v_mfma_f32_32x32x16_bf16 v[156:171], v[176:179], v[88:91], v[156:171]
    ds_read_b64_tr_b16 v[172:173], v249 offset:16384
    ds_read_b64_tr_b16 v[174:175], v249 offset:16896
    s_waitcnt lgkmcnt(8)
    v_mfma_f32_32x32x16_bf16 v[156:171], v[180:183], v[92:95], v[156:171]
    ds_read_b64_tr_b16 v[176:177], v249 offset:17408
    ds_read_b64_tr_b16 v[178:179], v249 offset:17920
    s_waitcnt lgkmcnt(8)
    v_mfma_f32_32x32x16_bf16 v[156:171], v[184:187], v[96:99], v[156:171]
    ds_read_b64_tr_b16 v[180:181], v249 offset:18432
    ds_read_b64_tr_b16 v[182:183], v249 offset:18944
    s_waitcnt lgkmcnt(8)
    v_mfma_f32_32x32x16_bf16 v[156:171], v[188:191], v[100:103], v[156:171]
    ds_read_b64_tr_b16 v[184:185], v249 offset:19456
    ds_read_b64_tr_b16 v[186:187], v249 offset:19968
    s_waitcnt lgkmcnt(8)
    v_mfma_f32_32x32x16_bf16 v[156:171], v[192:195], v[104:107], v[156:171]
    s_waitcnt lgkmcnt(6)
    v_mfma_f32_32x32x16_bf16 v[156:171], v[172:175], v[108:111], v[156:171]
    s_waitcnt lgkmcnt(4)
    v_mfma_f32_32x32x16_bf16 v[156:171], v[176:179], v[112:115], v[156:171]
    s_waitcnt lgkmcnt(2)
    v_mfma_f32_32x32x16_bf16 v[156:171], v[180:183], v[116:119], v[156:171]
    s_waitcnt lgkmcnt(0)
    v_mfma_f32_32x32x16_bf16 v[156:171], v[184:187], v[120:123], v[156:171]
    v_mfma_f32_32x32x16_bf16 v[156:171], a[240:243], v[236:239], v[156:171]
    s_lshl_b32 s42, s20, 2
    s_lshl_b32 s43, s3, 1
    s_add_u32 s42, s42, s43
    s_sub_i32 s42, s42, 8
    s_max_i32 s45, s42, 0
    s_lshl_b32 s43, s21, 6
    s_add_u32 s43, s43, s45
    s_lshl_b32 s43, s43, 12
    s_add_u32 s43, s43, 20971520
    s_add_u32 s44, s43, 4096
    s_cmp_lt_i32 s42, 0
    s_cbranch_scc1 hm_47
    buffer_load_dwordx4 v[172:175], v1, s[4:7], s43 offen offset:0 sc1
    buffer_load_dwordx4 v[176:179], v1, s[4:7], s43 offen offset:1024 sc1
    buffer_load_dwordx4 v[180:183], v1, s[4:7], s43 offen offset:2048 sc1
    buffer_load_dwordx4 v[184:187], v1, s[4:7], s43 offen offset:3072 sc1
    buffer_load_dwordx4 v[188:191], v1, s[4:7], s44 offen offset:0 sc1
    buffer_load_dwordx4 v[192:195], v1, s[4:7], s44 offen offset:1024 sc1
    buffer_load_dwordx4 v[196:199], v1, s[4:7], s44 offen offset:2048 sc1
    buffer_load_dwordx4 v[200:203], v1, s[4:7], s44 offen offset:3072 sc1
hm_47:
    s_mov_b32 s46, 0xf149f2ca
    v_mov_b32 v220, s46
    s_cmp_ge_u32 s22, 8
    s_cselect_b32 s47, 0, s46
    v_mov_b32 v248, s47
    v_lshlrev_b32 v245, 2, v3
    v_sub_u32 v245, v2, v245
    v_cmp_le_i32 vcc, 0, v245
    s_nop 1
    v_cndmask_b32_e64 v140, v220, 0, vcc
    v_cndmask_b32 v12, v248, v220, vcc
    v_cmp_le_i32 vcc, 1, v245
    s_nop 1
    v_cndmask_b32_e64 v141, v220, 0, vcc
    v_cndmask_b32 v13, v248, v220, vcc
    v_cmp_le_i32 vcc, 2, v245
    s_nop 1
    v_cndmask_b32_e64 v142, v220, 0, vcc
    v_cndmask_b32 v14, v248, v220, vcc
    v_cmp_le_i32 vcc, 3, v245
    s_nop 1
    v_cndmask_b32_e64 v143, v220, 0, vcc
    v_cndmask_b32 v15, v248, v220, vcc
    v_cmp_le_i32 vcc, 8, v245
    s_nop 1
    v_cndmask_b32_e64 v144, v220, 0, vcc
    v_cndmask_b32 v16, v248, v220, vcc
    v_cmp_le_i32 vcc, 9, v245
    s_nop 1
    v_cndmask_b32_e64 v145, v220, 0, vcc
    v_cndmask_b32 v17, v248, v220, vcc
    v_cmp_le_i32 vcc, 10, v245
    s_nop 1
    v_cndmask_b32_e64 v146, v220, 0, vcc
    v_cndmask_b32 v18, v248, v220, vcc
    v_cmp_le_i32 vcc, 11, v245
    s_nop 1
    v_cndmask_b32_e64 v147, v220, 0, vcc
    v_cndmask_b32 v19, v248, v220, vcc
    v_cmp_le_i32 vcc, 16, v245
    s_nop 1
    v_cndmask_b32_e64 v148, v220, 0, vcc
    v_cndmask_b32 v20, v248, v220, vcc
    v_cmp_le_i32 vcc, 17, v245
    s_nop 1
    v_cndmask_b32_e64 v149, v220, 0, vcc
    v_cndmask_b32 v21, v248, v220, vcc
    v_cmp_le_i32 vcc, 18, v245
    s_nop 1
    v_cndmask_b32_e64 v150, v220, 0, vcc
    v_cndmask_b32 v22, v248, v220, vcc
    v_cmp_le_i32 vcc, 19, v245
    s_nop 1
    v_cndmask_b32_e64 v151, v220, 0, vcc
    v_cndmask_b32 v23, v248, v220, vcc
    v_cmp_le_i32 vcc, 24, v245
    s_nop 1
    v_cndmask_b32_e64 v152, v220, 0, vcc
    v_cndmask_b32 v24, v248, v220, vcc
    v_cmp_le_i32 vcc, 25, v245
    s_nop 1
    v_cndmask_b32_e64 v153, v220, 0, vcc
    v_cndmask_b32 v25, v248, v220, vcc
    v_cmp_le_i32 vcc, 26, v245
    s_nop 1
    v_cndmask_b32_e64 v154, v220, 0, vcc
    v_cndmask_b32 v26, v248, v220, vcc
    v_cmp_le_i32 vcc, 27, v245
    s_nop 1
    v_cndmask_b32_e64 v155, v220, 0, vcc
    v_cndmask_b32 v27, v248, v220, vcc
    s_cmp_ge_u32 s22, 8
    s_cbranch_scc1 mski_43
    s_cmp_ge_u32 s22, 7
    s_cselect_b32 s47, 0, s46
    v_mov_b32 v28, s47
    v_mov_b32 v29, s47
    v_mov_b32 v30, s47
    v_mov_b32 v31, s47
    v_mov_b32 v32, s47
    v_mov_b32 v33, s47
    v_mov_b32 v34, s47
    v_mov_b32 v35, s47
    v_mov_b32 v36, s47
    v_mov_b32 v37, s47
    v_mov_b32 v38, s47
    v_mov_b32 v39, s47
    v_mov_b32 v40, s47
    v_mov_b32 v41, s47
    v_mov_b32 v42, s47
    v_mov_b32 v43, s47
    s_cmp_ge_u32 s22, 6
    s_cselect_b32 s47, 0, s46
    v_mov_b32 v44, s47
    v_mov_b32 v45, s47
    v_mov_b32 v46, s47
    v_mov_b32 v47, s47
    v_mov_b32 v48, s47
    v_mov_b32 v49, s47
    v_mov_b32 v50, s47
    v_mov_b32 v51, s47
    v_mov_b32 v52, s47
    v_mov_b32 v53, s47
    v_mov_b32 v54, s47
    v_mov_b32 v55, s47
    v_mov_b32 v56, s47
    v_mov_b32 v57, s47
    v_mov_b32 v58, s47
    v_mov_b32 v59, s47
    s_cmp_ge_u32 s22, 5
    s_cselect_b32 s47, 0, s46
    v_mov_b32 v60, s47
    v_mov_b32 v61, s47
    v_mov_b32 v62, s47
    v_mov_b32 v63, s47
    v_mov_b32 v64, s47
    v_mov_b32 v65, s47
    v_mov_b32 v66, s47
    v_mov_b32 v67, s47
    v_mov_b32 v68, s47
    v_mov_b32 v69, s47
    v_mov_b32 v70, s47
    v_mov_b32 v71, s47
    v_mov_b32 v72, s47
    v_mov_b32 v73, s47
    v_mov_b32 v74, s47
    v_mov_b32 v75, s47
    s_cmp_ge_u32 s22, 4
    s_cselect_b32 s47, 0, s46
    v_mov_b32 v76, s47
    v_mov_b32 v77, s47
    v_mov_b32 v78, s47
    v_mov_b32 v79, s47
    v_mov_b32 v80, s47
    v_mov_b32 v81, s47
    v_mov_b32 v82, s47
    v_mov_b32 v83, s47
    v_mov_b32 v84, s47
    v_mov_b32 v85, s47
    v_mov_b32 v86, s47
    v_mov_b32 v87, s47
    v_mov_b32 v88, s47
    v_mov_b32 v89, s47
    v_mov_b32 v90, s47
    v_mov_b32 v91, s47
    s_cmp_ge_u32 s22, 3
    s_cselect_b32 s47, 0, s46
    v_mov_b32 v92, s47
    v_mov_b32 v93, s47
    v_mov_b32 v94, s47
    v_mov_b32 v95, s47
    v_mov_b32 v96, s47
    v_mov_b32 v97, s47
    v_mov_b32 v98, s47
    v_mov_b32 v99, s47
    v_mov_b32 v100, s47
    v_mov_b32 v101, s47
    v_mov_b32 v102, s47
    v_mov_b32 v103, s47
    v_mov_b32 v104, s47
    v_mov_b32 v105, s47
    v_mov_b32 v106, s47
    v_mov_b32 v107, s47
    s_cmp_ge_u32 s22, 2
    s_cselect_b32 s47, 0, s46
    v_mov_b32 v108, s47
    v_mov_b32 v109, s47
    v_mov_b32 v110, s47
    v_mov_b32 v111, s47
    v_mov_b32 v112, s47
    v_mov_b32 v113, s47
    v_mov_b32 v114, s47
    v_mov_b32 v115, s47
    v_mov_b32 v116, s47
    v_mov_b32 v117, s47
    v_mov_b32 v118, s47
    v_mov_b32 v119, s47
    v_mov_b32 v120, s47
    v_mov_b32 v121, s47
    v_mov_b32 v122, s47
    v_mov_b32 v123, s47
    s_cmp_ge_u32 s22, 1
    s_cselect_b32 s47, 0, s46
    v_mov_b32 v124, s47
    v_mov_b32 v125, s47
    v_mov_b32 v126, s47
    v_mov_b32 v127, s47
    v_mov_b32 v128, s47
    v_mov_b32 v129, s47
    v_mov_b32 v130, s47
    v_mov_b32 v131, s47
    v_mov_b32 v132, s47
    v_mov_b32 v133, s47
    v_mov_b32 v134, s47
    v_mov_b32 v135, s47
    v_mov_b32 v136, s47
    v_mov_b32 v137, s47
    v_mov_b32 v138, s47
    v_mov_b32 v139, s47
mski_43:
    v_cmp_eq_u32 vcc, 0, v3
    v_mov_b32 v209, 0x3f803f80
    v_mov_b32 v206, 0
    v_mov_b32 v207, 0
    v_cndmask_b32 v208, 0, v209, vcc
    v_mov_b32 v209, 0x3f80
    v_mov_b32 v210, 0
    v_mov_b32 v211, 0
    v_cndmask_b32 v209, 0, v209, vcc
    v_mul_f32 v156, v246, v156
    v_mul_f32 v157, v246, v157
    v_mul_f32 v158, v246, v158
    v_mul_f32 v159, v246, v159
    v_mul_f32 v160, v246, v160
    v_mul_f32 v161, v246, v161
    v_mul_f32 v162, v246, v162
    v_mul_f32 v163, v246, v163
    v_mul_f32 v164, v246, v164
    v_mul_f32 v165, v246, v165
    v_mul_f32 v166, v246, v166
    v_mul_f32 v167, v246, v167
    v_mul_f32 v168, v247, v168
    v_mul_f32 v169, v247, v169
    v_mul_f32 v170, v247, v170
    v_mul_f32 v171, v247, v171
    v_cvt_pk_bf16_f32 v236, v156, v157
    v_cvt_pk_bf16_f32 v237, v158, v159
    v_cvt_pk_bf16_f32 v238, v160, v161
    v_cvt_pk_bf16_f32 v239, v162, v163
    v_cvt_pk_bf16_f32 v240, v164, v165
    v_cvt_pk_bf16_f32 v241, v166, v167
    v_cvt_pk_bf16_f32 v242, v168, v169
    v_cvt_pk_bf16_f32 v243, v170, v171
    v_mfma_f32_32x32x16_bf16 v[140:155], v[212:215], v[236:239], v[140:155]
    s_nop 0
    v_mfma_f32_32x32x16_bf16 v[140:155], v[216:219], v[240:243], v[140:155]
    v_bfe_u32 v251, v0, 2, 3
    v_mul_u32_u24 v251, 3584, v251
    v_and_b32 v11, 3, v0
    v_lshl_add_u32 v251, v11, 4, v251
    v_lshl_add_u32 v251, v3, 6, v251
    s_mov_b32 s26, s1
    s_cmp_lt_i32 s42, 0
    s_cbranch_scc0 hl_44
    v_mov_b32 v172, 0
    v_mov_b32 v173, 0
    v_mov_b32 v174, 0
    v_mov_b32 v175, 0
    v_mov_b32 v176, 0
    v_mov_b32 v177, 0
    v_mov_b32 v178, 0
    v_mov_b32 v179, 0
    v_mov_b32 v180, 0
    v_mov_b32 v181, 0
    v_mov_b32 v182, 0
    v_mov_b32 v183, 0
    v_mov_b32 v184, 0
    v_mov_b32 v185, 0
    v_mov_b32 v186, 0
    v_mov_b32 v187, 0
    v_mov_b32 v188, 0
    v_mov_b32 v189, 0
    v_mov_b32 v190, 0
    v_mov_b32 v191, 0
    v_mov_b32 v192, 0
    v_mov_b32 v193, 0
    v_mov_b32 v194, 0
    v_mov_b32 v195, 0
    v_mov_b32 v196, 0
    v_mov_b32 v197, 0
    v_mov_b32 v198, 0
    v_mov_b32 v199, 0
    v_mov_b32 v200, 0
    v_mov_b32 v201, 0
    v_mov_b32 v202, 0
    v_mov_b32 v203, 0
    s_waitcnt vmcnt(0)
    s_branch hd_45
hr_46:
    s_add_u32 s50, s50, 1
    s_cmp_gt_u32 s50, 0x40000
    s_cbranch_scc1 hd_45
    s_sleep 2
    buffer_load_dwordx4 v[172:175], v1, s[4:7], s43 offen offset:0 sc1
    buffer_load_dwordx4 v[176:179], v1, s[4:7], s43 offen offset:1024 sc1
    buffer_load_dwordx4 v[180:183], v1, s[4:7], s43 offen offset:2048 sc1
    buffer_load_dwordx4 v[184:187], v1, s[4:7], s43 offen offset:3072 sc1
    buffer_load_dwordx4 v[188:191], v1, s[4:7], s44 offen offset:0 sc1
    buffer_load_dwordx4 v[192:195], v1, s[4:7], s44 offen offset:1024 sc1
    buffer_load_dwordx4 v[196:199], v1, s[4:7], s44 offen offset:2048 sc1
    buffer_load_dwordx4 v[200:203], v1, s[4:7], s44 offen offset:3072 sc1
hl_44:
    s_waitcnt vmcnt(0)
    v_max_u32 v249, v172, v173
    v_max3_u32 v249, v174, v175, v249
    v_max3_u32 v249, v176, v177, v249
    v_max3_u32 v249, v178, v179, v249
    v_max3_u32 v249, v180, v181, v249
    v_max3_u32 v249, v182, v183, v249
    v_max3_u32 v249, v184, v185, v249
    v_max3_u32 v249, v186, v187, v249
    v_max3_u32 v249, v188, v189, v249
    v_max3_u32 v249, v190, v191, v249
    v_max3_u32 v249, v192, v193, v249
    v_max3_u32 v249, v194, v195, v249
    v_max3_u32 v249, v196, v197, v249
    v_max3_u32 v249, v198, v199, v249
    v_max3_u32 v249, v200, v201, v249
    v_max3_u32 v249, v202, v203, v249
    v_cmp_eq_u32 vcc, -1, v249
    s_nop 0
    s_cmp_eq_u64 vcc, 0
    s_cbranch_scc0 hr_46
hd_45:
    s_lshl_b32 s42, s3, 13
    s_add_u32 s42, s42, 86016
    v_add_u32 v249, s42, v1
    ds_write_b128 v249, v[172:175] offset:0
    ds_write_b128 v249, v[176:179] offset:1024
    ds_write_b128 v249, v[180:183] offset:2048
    ds_write_b128 v249, v[184:187] offset:3072
    ds_write_b128 v249, v[188:191] offset:4096
    ds_write_b128 v249, v[192:195] offset:5120
    ds_write_b128 v249, v[196:199] offset:6144
    ds_write_b128 v249, v[200:203] offset:7168
    s_lshl_b32 s42, s3, 12
    s_add_u32 s42, s42, 86016
    v_add_u32 v250, s42, v1
    v_max_f32 v244, v140, v141
    v_max3_f32 v244, v142, v143, v244
    v_max3_f32 v244, v144, v145, v244
    v_max3_f32 v244, v146, v147, v244
    v_max3_f32 v244, v148, v149, v244
    v_max3_f32 v244, v150, v151, v244
    v_max3_f32 v244, v152, v153, v244
    v_max3_f32 v244, v154, v155, v244
    s_waitcnt lgkmcnt(0)
    s_barrier
    v_and_b32 v11, 15, v0
    v_lshlrev_b32 v11, 13, v11
    s_add_u32 s49, s72, s94
    buffer_load_dword v9, v252, s[4:7], s49 offen sc1
    s_add_u32 s49, s67, 0
    buffer_load_dword v9, v11, s[4:7], s49 offen sc1
    s_cmp_ge_u32 s22, 8
    s_cbranch_scc0 qks_48
    ds_read_b128 v[172:175], v250 offset:0
    ds_read_b128 v[176:179], v250 offset:1024
    ds_read_b128 v[180:183], v250 offset:4096
    ds_read_b128 v[184:187], v250 offset:5120
    ds_read_b128 v[188:191], v250 offset:8192
    ds_read_b128 v[192:195], v250 offset:9216
    ds_read_b128 v[196:199], v250 offset:12288
    ds_read_b128 v[200:203], v250 offset:13312
    s_waitcnt lgkmcnt(6)
    v_mfma_f32_32x32x16_bf16 v[12:27], v[172:175], v[236:239], v[12:27]
    v_mfma_f32_32x32x16_bf16 v[12:27], v[176:179], v[240:243], v[12:27]
    ds_read_b128 v[172:175], v250 offset:16384
    ds_read_b128 v[176:179], v250 offset:17408
    s_waitcnt lgkmcnt(6)
    v_mfma_f32_32x32x16_bf16 v[28:43], v[180:183], v[236:239], 0
    v_mfma_f32_32x32x16_bf16 v[28:43], v[184:187], v[240:243], v[28:43]
    ds_read_b128 v[180:183], v250 offset:20480
    ds_read_b128 v[184:187], v250 offset:21504
    s_waitcnt lgkmcnt(6)
    v_mfma_f32_32x32x16_bf16 v[44:59], v[188:191], v[236:239], 0
    v_mfma_f32_32x32x16_bf16 v[44:59], v[192:195], v[240:243], v[44:59]
    s_nop 1
    v_max3_f32 v244, v12, v13, v244
    v_max3_f32 v244, v14, v15, v244
    v_max3_f32 v244, v16, v17, v244
    v_max3_f32 v244, v18, v19, v244
    v_max3_f32 v244, v20, v21, v244
    v_max3_f32 v244, v22, v23, v244
    v_max3_f32 v244, v24, v25, v244
    v_max3_f32 v244, v26, v27, v244
    ds_read_b128 v[188:191], v250 offset:24576
    ds_read_b128 v[192:195], v250 offset:25600
    s_waitcnt lgkmcnt(6)
    v_mfma_f32_32x32x16_bf16 v[60:75], v[196:199], v[236:239], 0
    v_mfma_f32_32x32x16_bf16 v[60:75], v[200:203], v[240:243], v[60:75]
    v_max3_f32 v244, v28, v29, v244
    v_max3_f32 v244, v30, v31, v244
    v_max3_f32 v244, v32, v33, v244
    v_max3_f32 v244, v34, v35, v244
    v_max3_f32 v244, v36, v37, v244
    v_max3_f32 v244, v38, v39, v244
    v_max3_f32 v244, v40, v41, v244
    v_max3_f32 v244, v42, v43, v244
    ds_read_b128 v[196:199], v250 offset:28672
    ds_read_b128 v[200:203], v250 offset:29696
    s_waitcnt lgkmcnt(6)
    v_mfma_f32_32x32x16_bf16 v[76:91], v[172:175], v[236:239], 0
    v_mfma_f32_32x32x16_bf16 v[76:91], v[176:179], v[240:243], v[76:91]
    v_max3_f32 v244, v44, v45, v244
    v_max3_f32 v244, v46, v47, v244
    v_max3_f32 v244, v48, v49, v244
    v_max3_f32 v244, v50, v51, v244
    v_max3_f32 v244, v52, v53, v244
    v_max3_f32 v244, v54, v55, v244
    v_max3_f32 v244, v56, v57, v244
    v_max3_f32 v244, v58, v59, v244
    s_waitcnt lgkmcnt(4)
    v_mfma_f32_32x32x16_bf16 v[92:107], v[180:183], v[236:239], 0
    v_mfma_f32_32x32x16_bf16 v[92:107], v[184:187], v[240:243], v[92:107]
    v_max3_f32 v244, v60, v61, v244
    v_max3_f32 v244, v62, v63, v244
    v_max3_f32 v244, v64, v65, v244
    v_max3_f32 v244, v66, v67, v244
    v_max3_f32 v244, v68, v69, v244
    v_max3_f32 v244, v70, v71, v244
    v_max3_f32 v244, v72, v73, v244
    v_max3_f32 v244, v74, v75, v244
    s_waitcnt lgkmcnt(2)
    v_mfma_f32_32x32x16_bf16 v[108:123], v[188:191], v[236:239], 0
    v_mfma_f32_32x32x16_bf16 v[108:123], v[192:195], v[240:243], v[108:123]
    v_max3_f32 v244, v76, v77, v244
    v_max3_f32 v244, v78, v79, v244
    v_max3_f32 v244, v80, v81, v244
    v_max3_f32 v244, v82, v83, v244
    v_max3_f32 v244, v84, v85, v244
    v_max3_f32 v244, v86, v87, v244
    v_max3_f32 v244, v88, v89, v244
    v_max3_f32 v244, v90, v91, v244
    s_waitcnt lgkmcnt(0)
    v_mfma_f32_32x32x16_bf16 v[124:139], v[196:199], v[236:239], 0
    v_mfma_f32_32x32x16_bf16 v[124:139], v[200:203], v[240:243], v[124:139]
    v_max3_f32 v244, v92, v93, v244
    v_max3_f32 v244, v94, v95, v244
    v_max3_f32 v244, v96, v97, v244
    v_max3_f32 v244, v98, v99, v244
    v_max3_f32 v244, v100, v101, v244
    v_max3_f32 v244, v102, v103, v244
    v_max3_f32 v244, v104, v105, v244
    v_max3_f32 v244, v106, v107, v244
    s_branch qkd_49
qks_48:
    ds_read_b128 v[172:175], v250 offset:0
    ds_read_b128 v[176:179], v250 offset:1024
    ds_read_b128 v[180:183], v250 offset:4096
    ds_read_b128 v[184:187], v250 offset:5120
    ds_read_b128 v[188:191], v250 offset:8192
    ds_read_b128 v[192:195], v250 offset:9216
    ds_read_b128 v[196:199], v250 offset:12288
    ds_read_b128 v[200:203], v250 offset:13312
    s_waitcnt lgkmcnt(6)
    v_mfma_f32_32x32x16_bf16 v[12:27], v[172:175], v[236:239], v[12:27]
    v_mfma_f32_32x32x16_bf16 v[12:27], v[176:179], v[240:243], v[12:27]
    ds_read_b128 v[172:175], v250 offset:16384
    ds_read_b128 v[176:179], v250 offset:17408
    s_waitcnt lgkmcnt(6)
    v_mfma_f32_32x32x16_bf16 v[28:43], v[180:183], v[236:239], v[28:43]
    v_mfma_f32_32x32x16_bf16 v[28:43], v[184:187], v[240:243], v[28:43]
    ds_read_b128 v[180:183], v250 offset:20480
    ds_read_b128 v[184:187], v250 offset:21504
    s_waitcnt lgkmcnt(6)
    v_mfma_f32_32x32x16_bf16 v[44:59], v[188:191], v[236:239], v[44:59]
    v_mfma_f32_32x32x16_bf16 v[44:59], v[192:195], v[240:243], v[44:59]
    s_nop 1
    v_max3_f32 v244, v12, v13, v244
    v_max3_f32 v244, v14, v15, v244
    v_max3_f32 v244, v16, v17, v244
    v_max3_f32 v244, v18, v19, v244
    v_max3_f32 v244, v20, v21, v244
    v_max3_f32 v244, v22, v23, v244
    v_max3_f32 v244, v24, v25, v244
    v_max3_f32 v244, v26, v27, v244
    ds_read_b128 v[188:191], v250 offset:24576
    ds_read_b128 v[192:195], v250 offset:25600
    s_waitcnt lgkmcnt(6)
    v_mfma_f32_32x32x16_bf16 v[60:75], v[196:199], v[236:239], v[60:75]
    v_mfma_f32_32x32x16_bf16 v[60:75], v[200:203], v[240:243], v[60:75]
    v_max3_f32 v244, v28, v29, v244
    v_max3_f32 v244, v30, v31, v244
    v_max3_f32 v244, v32, v33, v244
    v_max3_f32 v244, v34, v35, v244
    v_max3_f32 v244, v36, v37, v244
    v_max3_f32 v244, v38, v39, v244
    v_max3_f32 v244, v40, v41, v244
    v_max3_f32 v244, v42, v43, v244
    ds_read_b128 v[196:199], v250 offset:28672
    ds_read_b128 v[200:203], v250 offset:29696
    s_waitcnt lgkmcnt(6)
    v_mfma_f32_32x32x16_bf16 v[76:91], v[172:175], v[236:239], v[76:91]
    v_mfma_f32_32x32x16_bf16 v[76:91], v[176:179], v[240:243], v[76:91]
    v_max3_f32 v244, v44, v45, v244
    v_max3_f32 v244, v46, v47, v244
    v_max3_f32 v244, v48, v49, v244
    v_max3_f32 v244, v50, v51, v244
    v_max3_f32 v244, v52, v53, v244
    v_max3_f32 v244, v54, v55, v244
    v_max3_f32 v244, v56, v57, v244
    v_max3_f32 v244, v58, v59, v244
    s_waitcnt lgkmcnt(4)
    v_mfma_f32_32x32x16_bf16 v[92:107], v[180:183], v[236:239], v[92:107]
    v_mfma_f32_32x32x16_bf16 v[92:107], v[184:187], v[240:243], v[92:107]
    v_max3_f32 v244, v60, v61, v244
    v_max3_f32 v244, v62, v63, v244
    v_max3_f32 v244, v64, v65, v244
    v_max3_f32 v244, v66, v67, v244
    v_max3_f32 v244, v68, v69, v244
    v_max3_f32 v244, v70, v71, v244
    v_max3_f32 v244, v72, v73, v244
    v_max3_f32 v244, v74, v75, v244
    s_waitcnt lgkmcnt(2)
    v_mfma_f32_32x32x16_bf16 v[108:123], v[188:191], v[236:239], v[108:123]
    v_mfma_f32_32x32x16_bf16 v[108:123], v[192:195], v[240:243], v[108:123]
    v_max3_f32 v244, v76, v77, v244
    v_max3_f32 v244, v78, v79, v244
    v_max3_f32 v244, v80, v81, v244
    v_max3_f32 v244, v82, v83, v244
    v_max3_f32 v244, v84, v85, v244
    v_max3_f32 v244, v86, v87, v244
    v_max3_f32 v244, v88, v89, v244
    v_max3_f32 v244, v90, v91, v244
    s_waitcnt lgkmcnt(0)
    v_mfma_f32_32x32x16_bf16 v[124:139], v[196:199], v[236:239], v[124:139]
    v_mfma_f32_32x32x16_bf16 v[124:139], v[200:203], v[240:243], v[124:139]
    v_max3_f32 v244, v92, v93, v244
    v_max3_f32 v244, v94, v95, v244
    v_max3_f32 v244, v96, v97, v244
    v_max3_f32 v244, v98, v99, v244
    v_max3_f32 v244, v100, v101, v244
    v_max3_f32 v244, v102, v103, v244
    v_max3_f32 v244, v104, v105, v244
    v_max3_f32 v244, v106, v107, v244
qkd_49:
    ds_read_b128 v[172:175], v250 offset:2048
    ds_read_b128 v[176:179], v250 offset:3072
    ds_read_b128 v[180:183], v250 offset:6144
    ds_read_b128 v[184:187], v250 offset:7168
    ds_read_b128 v[188:191], v250 offset:10240
    ds_read_b128 v[192:195], v250 offset:11264
    v_max3_f32 v244, v108, v109, v244
    v_max3_f32 v244, v110, v111, v244
    v_max3_f32 v244, v112, v113, v244
    v_max3_f32 v244, v114, v115, v244
    v_max3_f32 v244, v116, v117, v244
    s_add_u32 s40, s68, 0
    s_add_u32 m0, s0, 0
    s_nop 0
    buffer_load_dwordx4 v251, s[24:27], s40 offen lds
    v_max3_f32 v244, v118, v119, v244
    v_max3_f32 v244, v120, v121, v244
    v_max3_f32 v244, v122, v123, v244
    v_max3_f32 v244, v124, v125, v244
    v_max3_f32 v244, v126, v127, v244
    v_max3_f32 v244, v128, v129, v244
    v_max3_f32 v244, v130, v131, v244
    v_max3_f32 v244, v132, v133, v244
    v_max3_f32 v244, v134, v135, v244
    v_max3_f32 v244, v136, v137, v244
    v_max3_f32 v244, v138, v139, v244
    s_add_u32 s40, s68, 114688
    s_add_u32 m0, s0, 4096
    s_nop 0
    buffer_load_dwordx4 v251, s[24:27], s40 offen lds
    v_mov_b32 v245, v244
    s_nop 1
    v_permlane32_swap_b32 v244, v245
    v_max_f32 v244, v244, v245
    v_sub_f32 v244, 0, v244
    v_and_b32 v245, 0xffff0000, v244
    v_sub_f32 v244, v244, v245
    v_and_b32 v249, 0xffff0000, v244
    v_sub_f32 v244, v244, v249
    v_lshrrev_b32 v245, 16, v245
    v_or_b32 v204, v245, v249
    v_lshrrev_b32 v205, 16, v244
    s_add_u32 s40, s68, 229376
    s_add_u32 m0, s0, 8192
    s_nop 0
    buffer_load_dwordx4 v251, s[24:27], s40 offen lds
    v_mfma_f32_32x32x16_bf16 v[140:155], v[208:211], v[204:207], v[140:155]
    v_mfma_f32_32x32x16_bf16 v[12:27], v[208:211], v[204:207], v[12:27]
    s_nop 10
    v_exp_f32 v140, v140
    v_exp_f32 v141, v141
    v_exp_f32 v142, v142
    v_exp_f32 v143, v143
    v_exp_f32 v144, v144
    v_exp_f32 v145, v145
    v_exp_f32 v146, v146
    v_exp_f32 v147, v147
    v_mfma_f32_32x32x16_bf16 v[28:43], v[208:211], v[204:207], v[28:43]
    s_add_u32 s40, s68, 344064
    s_add_u32 m0, s0, 12288
    s_nop 0
    buffer_load_dwordx4 v251, s[24:27], s40 offen lds
    v_exp_f32 v148, v148
    v_exp_f32 v149, v149
    v_exp_f32 v150, v150
    v_exp_f32 v151, v151
    v_cvt_pk_bf16_f32 v140, v140, v141
    v_cvt_pk_bf16_f32 v141, v142, v143
    v_cvt_pk_bf16_f32 v142, v144, v145
    v_cvt_pk_bf16_f32 v143, v146, v147
    v_exp_f32 v152, v152
    v_exp_f32 v153, v153
    v_exp_f32 v154, v154
    s_add_u32 s40, s68, 458752
    s_add_u32 m0, s0, 16384
    s_nop 0
    buffer_load_dwordx4 v251, s[24:27], s40 offen lds
    v_exp_f32 v155, v155
    v_mfma_f32_32x32x16_bf16 v[156:171], v[228:231], v[140:143], 0
    v_cvt_pk_bf16_f32 v144, v148, v149
    v_cvt_pk_bf16_f32 v145, v150, v151
    v_cvt_pk_bf16_f32 v146, v152, v153
    v_cvt_pk_bf16_f32 v147, v154, v155
    s_nop 1
    v_mfma_f32_32x32x16_bf16 v[156:171], v[232:235], v[144:147], v[156:171]
    v_exp_f32 v12, v12
    v_exp_f32 v13, v13
    v_exp_f32 v14, v14
    v_exp_f32 v15, v15
    s_add_u32 s40, s68, 573440
    s_add_u32 m0, s0, 20480
    s_nop 0
    buffer_load_dwordx4 v251, s[24:27], s40 offen lds
    v_exp_f32 v16, v16
    v_exp_f32 v17, v17
    v_exp_f32 v18, v18
    v_exp_f32 v19, v19
    v_mfma_f32_32x32x16_bf16 v[44:59], v[208:211], v[204:207], v[44:59]
    v_exp_f32 v20, v20
    v_exp_f32 v21, v21
    v_exp_f32 v22, v22
    v_exp_f32 v23, v23
    v_cvt_pk_bf16_f32 v12, v12, v13
    v_cvt_pk_bf16_f32 v13, v14, v15
    s_add_u32 s40, s68, 688128
    s_add_u32 m0, s0, 24576
    s_nop 0
    buffer_load_dwordx4 v251, s[24:27], s40 offen lds
    v_cvt_pk_bf16_f32 v14, v16, v17
    v_cvt_pk_bf16_f32 v15, v18, v19
    v_exp_f32 v24, v24
    v_exp_f32 v25, v25
    v_exp_f32 v26, v26
    v_exp_f32 v27, v27
    s_waitcnt lgkmcnt(4)
    v_mfma_f32_32x32x16_bf16 v[156:171], v[172:175], v[12:15], v[156:171]
    v_cvt_pk_bf16_f32 v16, v20, v21
    v_cvt_pk_bf16_f32 v17, v22, v23
    v_cvt_pk_bf16_f32 v18, v24, v25
    s_add_u32 s40, s68, 802816
    s_add_u32 m0, s0, 28672
    s_nop 0
    buffer_load_dwordx4 v251, s[24:27], s40 offen lds
    v_cvt_pk_bf16_f32 v19, v26, v27
    s_nop 1
    v_mfma_f32_32x32x16_bf16 v[156:171], v[176:179], v[16:19], v[156:171]
    ds_read_b128 v[196:199], v250 offset:14336
    ds_read_b128 v[200:203], v250 offset:15360
    v_exp_f32 v28, v28
    v_exp_f32 v29, v29
    v_exp_f32 v30, v30
    v_exp_f32 v31, v31
    v_exp_f32 v32, v32
    v_exp_f32 v33, v33
    v_exp_f32 v34, v34
    s_add_u32 s40, s68, 917504
    s_add_u32 m0, s0, 32768
    s_nop 0
    buffer_load_dwordx4 v251, s[24:27], s40 offen lds
    v_exp_f32 v35, v35
    v_mfma_f32_32x32x16_bf16 v[60:75], v[208:211], v[204:207], v[60:75]
    v_exp_f32 v36, v36
    v_exp_f32 v37, v37
    v_exp_f32 v38, v38
    v_exp_f32 v39, v39
    v_cvt_pk_bf16_f32 v28, v28, v29
    v_cvt_pk_bf16_f32 v29, v30, v31
    v_cvt_pk_bf16_f32 v30, v32, v33
    v_cvt_pk_bf16_f32 v31, v34, v35
    v_exp_f32 v40, v40
    s_add_u32 s40, s68, 1032192
    s_add_u32 m0, s0, 36864
    s_nop 0
    buffer_load_dwordx4 v251, s[24:27], s40 offen lds
    v_exp_f32 v41, v41
    v_exp_f32 v42, v42
    v_exp_f32 v43, v43
    s_waitcnt lgkmcnt(4)
    v_mfma_f32_32x32x16_bf16 v[156:171], v[180:183], v[28:31], v[156:171]
    v_cvt_pk_bf16_f32 v32, v36, v37
    v_cvt_pk_bf16_f32 v33, v38, v39
    v_cvt_pk_bf16_f32 v34, v40, v41
    v_cvt_pk_bf16_f32 v35, v42, v43
    s_nop 1
    v_mfma_f32_32x32x16_bf16 v[156:171], v[184:187], v[32:35], v[156:171]
    ds_read_b128 v[172:175], v250 offset:18432
    s_add_u32 s40, s68, 1146880
    s_add_u32 m0, s0, 40960
    s_nop 0
    buffer_load_dwordx4 v251, s[24:27], s40 offen lds
    ds_read_b128 v[176:179], v250 offset:19456
    v_exp_f32 v44, v44
    v_exp_f32 v45, v45
    v_exp_f32 v46, v46
    v_exp_f32 v47, v47
    v_exp_f32 v48, v48
    v_exp_f32 v49, v49
    v_exp_f32 v50, v50
    v_exp_f32 v51, v51
    v_mfma_f32_32x32x16_bf16 v[76:91], v[208:211], v[204:207], v[76:91]
    v_exp_f32 v52, v52
    s_add_u32 s40, s68, 1261568
    s_add_u32 m0, s0, 45056
    s_nop 0
    buffer_load_dwordx4 v251, s[24:27], s40 offen lds
    v_exp_f32 v53, v53
    v_exp_f32 v54, v54
    v_exp_f32 v55, v55
    v_cvt_pk_bf16_f32 v44, v44, v45
    v_cvt_pk_bf16_f32 v45, v46, v47
    v_cvt_pk_bf16_f32 v46, v48, v49
    v_cvt_pk_bf16_f32 v47, v50, v51
    v_exp_f32 v56, v56
    v_exp_f32 v57, v57
    v_exp_f32 v58, v58
    v_exp_f32 v59, v59
    s_add_u32 s40, s68, 1376256
    s_add_u32 m0, s0, 49152
    s_nop 0
    buffer_load_dwordx4 v251, s[24:27], s40 offen lds
    s_waitcnt lgkmcnt(4)
    v_mfma_f32_32x32x16_bf16 v[156:171], v[188:191], v[44:47], v[156:171]
    v_cvt_pk_bf16_f32 v48, v52, v53
    v_cvt_pk_bf16_f32 v49, v54, v55
    v_cvt_pk_bf16_f32 v50, v56, v57
    v_cvt_pk_bf16_f32 v51, v58, v59
    s_nop 1
    v_mfma_f32_32x32x16_bf16 v[156:171], v[192:195], v[48:51], v[156:171]
    ds_read_b128 v[180:183], v250 offset:22528
    ds_read_b128 v[184:187], v250 offset:23552
    v_exp_f32 v60, v60
    v_exp_f32 v61, v61
    s_add_u32 s40, s68, 1490944
    s_add_u32 m0, s0, 53248
    s_nop 0
    buffer_load_dwordx4 v251, s[24:27], s40 offen lds
    v_exp_f32 v62, v62
    v_exp_f32 v63, v63
    v_exp_f32 v64, v64
    v_exp_f32 v65, v65
    v_exp_f32 v66, v66
    v_exp_f32 v67, v67
    v_mfma_f32_32x32x16_bf16 v[92:107], v[208:211], v[204:207], v[92:107]
    v_exp_f32 v68, v68
    v_exp_f32 v69, v69
    v_exp_f32 v70, v70
    v_exp_f32 v71, v71
    s_add_u32 s40, s68, 128
    s_add_u32 m0, s0, 57344
    s_nop 0
    buffer_load_dwordx4 v251, s[24:27], s40 offen lds
    v_cvt_pk_bf16_f32 v60, v60, v61
    v_cvt_pk_bf16_f32 v61, v62, v63
    v_cvt_pk_bf16_f32 v62, v64, v65
    v_cvt_pk_bf16_f32 v63, v66, v67
    v_exp_f32 v72, v72
    v_exp_f32 v73, v73
    v_exp_f32 v74, v74
    v_exp_f32 v75, v75
    s_waitcnt lgkmcnt(4)
    v_mfma_f32_32x32x16_bf16 v[156:171], v[196:199], v[60:63], v[156:171]
    v_cvt_pk_bf16_f32 v64, v68, v69
    s_add_u32 s40, s68, 114816
    s_add_u32 m0, s0, 61440
    s_nop 0
    buffer_load_dwordx4 v251, s[24:27], s40 offen lds
    v_cvt_pk_bf16_f32 v65, v70, v71
    v_cvt_pk_bf16_f32 v66, v72, v73
    v_cvt_pk_bf16_f32 v67, v74, v75
    s_nop 1
    v_mfma_f32_32x32x16_bf16 v[156:171], v[200:203], v[64:67], v[156:171]
    ds_read_b128 v[188:191], v250 offset:26624
    ds_read_b128 v[192:195], v250 offset:27648
    v_exp_f32 v76, v76
    v_exp_f32 v77, v77
    v_exp_f32 v78, v78
    v_exp_f32 v79, v79
    v_exp_f32 v80, v80
    s_add_u32 s40, s68, 229504
    s_add_u32 m0, s0, 65536
    s_nop 0
    buffer_load_dwordx4 v251, s[24:27], s40 offen lds
    v_exp_f32 v81, v81
    v_exp_f32 v82, v82
    v_exp_f32 v83, v83
    v_mfma_f32_32x32x16_bf16 v[108:123], v[208:211], v[204:207], v[108:123]
    v_exp_f32 v84, v84
    v_exp_f32 v85, v85
    v_exp_f32 v86, v86
    v_exp_f32 v87, v87
    v_cvt_pk_bf16_f32 v76, v76, v77
    v_cvt_pk_bf16_f32 v77, v78, v79
    v_cvt_pk_bf16_f32 v78, v80, v81
    s_add_u32 s40, s68, 344192
    s_add_u32 m0, s0, 69632
    s_nop 0
    buffer_load_dwordx4 v251, s[24:27], s40 offen lds
    v_cvt_pk_bf16_f32 v79, v82, v83
    v_exp_f32 v88, v88
    v_exp_f32 v89, v89
    v_exp_f32 v90, v90
    v_exp_f32 v91, v91
    s_waitcnt lgkmcnt(4)
    v_mfma_f32_32x32x16_bf16 v[156:171], v[172:175], v[76:79], v[156:171]
    v_cvt_pk_bf16_f32 v80, v84, v85
    v_cvt_pk_bf16_f32 v81, v86, v87
    v_cvt_pk_bf16_f32 v82, v88, v89
    v_cvt_pk_bf16_f32 v83, v90, v91
    s_add_u32 s40, s68, 458880
    s_add_u32 m0, s0, 73728
    s_nop 0
    buffer_load_dwordx4 v251, s[24:27], s40 offen lds
    v_mfma_f32_32x32x16_bf16 v[156:171], v[176:179], v[80:83], v[156:171]
    ds_read_b128 v[196:199], v250 offset:30720
    ds_read_b128 v[200:203], v250 offset:31744
    v_exp_f32 v92, v92
    v_exp_f32 v93, v93
    v_exp_f32 v94, v94
    v_exp_f32 v95, v95
    v_exp_f32 v96, v96
    v_exp_f32 v97, v97
    v_exp_f32 v98, v98
    v_exp_f32 v99, v99
    s_add_u32 s40, s68, 573568
    s_add_u32 m0, s0, 77824
    s_nop 0
    buffer_load_dwordx4 v251, s[24:27], s40 offen lds
    v_mfma_f32_32x32x16_bf16 v[124:139], v[208:211], v[204:207], v[124:139]
    v_exp_f32 v100, v100
    v_exp_f32 v101, v101
    v_exp_f32 v102, v102
    v_exp_f32 v103, v103
    v_cvt_pk_bf16_f32 v92, v92, v93
    v_cvt_pk_bf16_f32 v93, v94, v95
    v_cvt_pk_bf16_f32 v94, v96, v97
    v_cvt_pk_bf16_f32 v95, v98, v99
    v_exp_f32 v104, v104
    v_exp_f32 v105, v105
    s_add_u32 s40, s68, 688256
    s_add_u32 m0, s0, 81920
    s_nop 0
    buffer_load_dwordx4 v251, s[24:27], s40 offen lds
    v_exp_f32 v106, v106
    v_exp_f32 v107, v107
    s_waitcnt lgkmcnt(4)
    v_mfma_f32_32x32x16_bf16 v[156:171], v[180:183], v[92:95], v[156:171]
    v_cvt_pk_bf16_f32 v96, v100, v101
    v_cvt_pk_bf16_f32 v97, v102, v103
    v_cvt_pk_bf16_f32 v98, v104, v105
    v_cvt_pk_bf16_f32 v99, v106, v107
    s_nop 1
    v_mfma_f32_32x32x16_bf16 v[156:171], v[184:187], v[96:99], v[156:171]
    v_exp_f32 v108, v108
    v_exp_f32 v109, v109
    v_exp_f32 v110, v110
    v_exp_f32 v111, v111
    v_exp_f32 v112, v112
    v_exp_f32 v113, v113
    v_exp_f32 v114, v114
    v_exp_f32 v115, v115
    v_exp_f32 v116, v116
    v_exp_f32 v117, v117
    v_exp_f32 v118, v118
    v_exp_f32 v119, v119
    v_cvt_pk_bf16_f32 v108, v108, v109
    v_cvt_pk_bf16_f32 v109, v110, v111
    v_cvt_pk_bf16_f32 v110, v112, v113
    v_cvt_pk_bf16_f32 v111, v114, v115
    v_exp_f32 v120, v120
    v_exp_f32 v121, v121
    v_exp_f32 v122, v122
    v_exp_f32 v123, v123
    s_waitcnt lgkmcnt(2)
    v_mfma_f32_32x32x16_bf16 v[156:171], v[188:191], v[108:111], v[156:171]
    v_cvt_pk_bf16_f32 v112, v116, v117
    v_cvt_pk_bf16_f32 v113, v118, v119
    v_cvt_pk_bf16_f32 v114, v120, v121
    v_cvt_pk_bf16_f32 v115, v122, v123
    s_nop 1
    v_mfma_f32_32x32x16_bf16 v[156:171], v[192:195], v[112:115], v[156:171]
    v_exp_f32 v124, v124
    v_exp_f32 v125, v125
    v_exp_f32 v126, v126
    v_exp_f32 v127, v127
    v_exp_f32 v128, v128
    v_exp_f32 v129, v129
    v_exp_f32 v130, v130
    v_exp_f32 v131, v131
    v_exp_f32 v132, v132
    v_exp_f32 v133, v133
    v_exp_f32 v134, v134
    v_exp_f32 v135, v135
    v_cvt_pk_bf16_f32 v124, v124, v125
    v_cvt_pk_bf16_f32 v125, v126, v127
    v_cvt_pk_bf16_f32 v126, v128, v129
    v_cvt_pk_bf16_f32 v127, v130, v131
    v_exp_f32 v136, v136
    v_exp_f32 v137, v137
    v_exp_f32 v138, v138
    v_exp_f32 v139, v139
    s_waitcnt lgkmcnt(0)
    v_mfma_f32_32x32x16_bf16 v[156:171], v[196:199], v[124:127], v[156:171]
    v_cvt_pk_bf16_f32 v128, v132, v133
    v_cvt_pk_bf16_f32 v129, v134, v135
    v_cvt_pk_bf16_f32 v130, v136, v137
    v_cvt_pk_bf16_f32 v131, v138, v139
    s_nop 1
    v_mfma_f32_32x32x16_bf16 v[156:171], v[200:203], v[128:131], v[156:171]
    s_nop 11
    v_mov_b32 v245, v168
    v_mov_b32 v249, v168
    s_nop 1
    v_permlane32_swap_b32 v245, v249
    v_rcp_f32 v249, v249
    v_cmp_eq_u32 vcc, 0, v3
    s_nop 1
    v_cndmask_b32 v245, 0, v249, vcc
    v_mul_f32 v156, v249, v156
    v_mul_f32 v157, v249, v157
    v_mul_f32 v158, v249, v158
    v_mul_f32 v159, v249, v159
    v_mul_f32 v160, v249, v160
    v_mul_f32 v161, v249, v161
    v_mul_f32 v162, v249, v162
    v_mul_f32 v163, v249, v163
    v_mul_f32 v164, v249, v164
    v_mul_f32 v165, v249, v165
    v_mul_f32 v166, v249, v166
    v_mul_f32 v167, v249, v167
    v_mul_f32 v168, v245, v168
    v_mul_f32 v169, v245, v169
    v_mul_f32 v170, v245, v170
    v_mul_f32 v171, v245, v171
    v_cvt_pk_bf16_f32 v172, v156, v157
    v_cvt_pk_bf16_f32 v173, v158, v159
    v_cvt_pk_bf16_f32 v174, v160, v161
    v_cvt_pk_bf16_f32 v175, v162, v163
    v_cvt_pk_bf16_f32 v176, v164, v165
    v_cvt_pk_bf16_f32 v177, v166, v167
    v_cvt_pk_bf16_f32 v178, v168, v169
    v_cvt_pk_bf16_f32 v179, v170, v171
    s_add_u32 s42, s72, s94
    buffer_store_dwordx4 v[172:175], v1, s[4:7], s42 offen
    buffer_store_dwordx4 v[176:179], v1, s[4:7], s42 offen offset:1024
    s_lshl_b32 s43, s21, 2
    s_add_u32 s75, s43, s67
    s_add_u32 s43, s75, 32768
    s_waitcnt vmcnt(0)
    s_mov_b64 exec, 1
    s_cmp_eq_u32 s19, 0
    s_cbranch_scc0 pubs_50
    buffer_store_dword v10, v6, s[4:7], s43 offen
    s_branch pubd_51
pubs_50:
    buffer_wbl2 sc1
    s_waitcnt vmcnt(0)
    buffer_store_dword v10, v6, s[4:7], s43 offen sc1
pubd_51:
    s_mov_b64 exec, -1
    s_nop 0
    s_waitcnt lgkmcnt(0)
    s_barrier
    s_cmp_ge_u32 s21, 14
    s_cbranch_scc1 idle1
    s_add_u32 s40, s68, 802944
    s_add_u32 m0, s0, 86016
    s_nop 0
    buffer_load_dwordx4 v251, s[24:27], s40 offen lds
    s_add_u32 s40, s68, 917632
    s_add_u32 m0, s0, 90112
    s_nop 0
    buffer_load_dwordx4 v251, s[24:27], s40 offen lds
    s_add_u32 s40, s68, 1032320
    s_add_u32 m0, s0, 94208
    s_nop 0
    buffer_load_dwordx4 v251, s[24:27], s40 offen lds
    s_add_u32 s40, s68, 1147008
    s_add_u32 m0, s0, 98304
    s_nop 0
    buffer_load_dwordx4 v251, s[24:27], s40 offen lds
    s_add_u32 s40, s68, 1261696
    s_add_u32 m0, s0, 102400
    s_nop 0
    buffer_load_dwordx4 v251, s[24:27], s40 offen lds
    s_add_u32 s40, s68, 1376384
    s_add_u32 m0, s0, 106496
    s_nop 0
    buffer_load_dwordx4 v251, s[24:27], s40 offen lds
    s_add_u32 s40, s68, 1491072
    s_add_u32 m0, s0, 110592
    s_nop 0
    buffer_load_dwordx4 v251, s[24:27], s40 offen lds
    s_add_u32 s45, s70, s88
    s_add_u32 s41, s45, 0
    buffer_load_dwordx4 v[172:175], v1, s[4:7], s41 offen sc1
    s_add_u32 s41, s45, 1024
    buffer_load_dwordx4 v[176:179], v1, s[4:7], s41 offen sc1
    s_add_u32 s42, s67, 32768
poll_52:
    s_add_u32 s50, s50, 1
    s_cmp_gt_u32 s50, 0x40000
    s_cbranch_scc1 pollx_53
    buffer_load_dword v9, v5, s[4:7], s42 offen sc1
    s_waitcnt vmcnt(0)
    v_cmp_eq_u32 vcc, 1, v9
    s_nop 0
    s_and_b32 s51, vcc_lo, 0xffff
    s_cmp_eq_u32 s51, 0xffff
    s_cbranch_scc0 poll_52
pollx_53:
    s_cmp_eq_u32 s19, 0
    s_cbranch_scc1 acq_54
    buffer_inv sc1
    s_waitcnt vmcnt(0)
acq_54:
    s_add_u32 s43, s73, s94
    s_add_u32 s41, s43, 0
    buffer_load_dwordx4 v[12:15], v1, s[4:7], s41 offen sc1
    s_add_u32 s41, s43, 1024
    buffer_load_dwordx4 v[16:19], v1, s[4:7], s41 offen sc1
    s_add_u32 s41, s43, 2048
    buffer_load_dwordx4 v[20:23], v1, s[4:7], s41 offen sc1
    s_add_u32 s41, s43, 3072
    buffer_load_dwordx4 v[24:27], v1, s[4:7], s41 offen sc1
    s_add_u32 s41, s43, 4096
    buffer_load_dwordx4 v[28:31], v1, s[4:7], s41 offen sc1
    s_add_u32 s41, s43, 5120
    buffer_load_dwordx4 v[32:35], v1, s[4:7], s41 offen sc1
    s_add_u32 s41, s43, 6144
    buffer_load_dwordx4 v[36:39], v1, s[4:7], s41 offen sc1
    s_add_u32 s41, s43, 7168
    buffer_load_dwordx4 v[40:43], v1, s[4:7], s41 offen sc1
    ds_read_b64_tr_b16 v[156:157], v254 offset:0
    ds_read_b64_tr_b16 v[158:159], v254 offset:512
    ds_read_b64_tr_b16 v[160:161], v254 offset:1024
    ds_read_b64_tr_b16 v[162:163], v254 offset:1536
    ds_read_b64_tr_b16 v[164:165], v254 offset:1792
    ds_read_b64_tr_b16 v[166:167], v254 offset:2304
    v_lshlrev_b32 v140, 16, v172
    v_and_b32 v141, 0xffff0000, v172
    v_lshlrev_b32 v142, 16, v173
    v_and_b32 v143, 0xffff0000, v173
    v_lshlrev_b32 v144, 16, v174
    v_and_b32 v145, 0xffff0000, v174
    v_lshlrev_b32 v146, 16, v175
    v_and_b32 v147, 0xffff0000, v175
    v_lshlrev_b32 v148, 16, v176
    v_and_b32 v149, 0xffff0000, v176
    v_lshlrev_b32 v150, 16, v177
    v_and_b32 v151, 0xffff0000, v177
    v_lshlrev_b32 v152, 16, v178
    v_and_b32 v153, 0xffff0000, v178
    v_lshlrev_b32 v154, 16, v179
    v_and_b32 v155, 0xffff0000, v179
    s_waitcnt vmcnt(7) lgkmcnt(4)
    s_nop 0
    v_mfma_f32_32x32x16_bf16 v[140:155], v[156:159], v[12:15], v[140:155]
    ds_read_b64_tr_b16 v[168:169], v254 offset:2816
    ds_read_b64_tr_b16 v[170:171], v254 offset:3328
    s_add_u32 s41, s43, 8192
    buffer_load_dwordx4 v[44:47], v1, s[4:7], s41 offen sc1
    s_waitcnt vmcnt(7) lgkmcnt(4)
    v_mfma_f32_32x32x16_bf16 v[140:155], v[160:163], v[16:19], v[140:155]
    ds_read_b64_tr_b16 v[156:157], v254 offset:3584
    ds_read_b64_tr_b16 v[158:159], v254 offset:4096
    s_add_u32 s41, s43, 9216
    buffer_load_dwordx4 v[48:51], v1, s[4:7], s41 offen sc1
    s_waitcnt vmcnt(7) lgkmcnt(4)
    v_mfma_f32_32x32x16_bf16 v[140:155], v[164:167], v[20:23], v[140:155]
    ds_read_b64_tr_b16 v[160:161], v254 offset:4608
    ds_read_b64_tr_b16 v[162:163], v254 offset:5120
    s_add_u32 s41, s43, 10240
    buffer_load_dwordx4 v[52:55], v1, s[4:7], s41 offen sc1
    s_waitcnt vmcnt(7) lgkmcnt(4)
    v_mfma_f32_32x32x16_bf16 v[140:155], v[168:171], v[24:27], v[140:155]
    ds_read_b64_tr_b16 v[164:165], v254 offset:5376
    ds_read_b64_tr_b16 v[166:167], v254 offset:5888
    s_add_u32 s41, s43, 11264
    buffer_load_dwordx4 v[56:59], v1, s[4:7], s41 offen sc1
    s_waitcnt vmcnt(7) lgkmcnt(4)
    v_mfma_f32_32x32x16_bf16 v[140:155], v[156:159], v[28:31], v[140:155]
    ds_read_b64_tr_b16 v[168:169], v254 offset:6400
    ds_read_b64_tr_b16 v[170:171], v254 offset:6912
    s_add_u32 s41, s43, 12288
    buffer_load_dwordx4 v[60:63], v1, s[4:7], s41 offen sc1
    s_waitcnt vmcnt(7) lgkmcnt(4)
    v_mfma_f32_32x32x16_bf16 v[140:155], v[160:163], v[32:35], v[140:155]
    ds_read_b64_tr_b16 v[156:157], v254 offset:7168
    ds_read_b64_tr_b16 v[158:159], v254 offset:7680
    s_add_u32 s41, s43, 13312
    buffer_load_dwordx4 v[64:67], v1, s[4:7], s41 offen sc1
    s_waitcnt vmcnt(7) lgkmcnt(4)
    v_mfma_f32_32x32x16_bf16 v[140:155], v[164:167], v[36:39], v[140:155]
    ds_read_b64_tr_b16 v[160:161], v254 offset:8192
    ds_read_b64_tr_b16 v[162:163], v254 offset:8704
    s_add_u32 s41, s43, 14336
    buffer_load_dwordx4 v[68:71], v1, s[4:7], s41 offen sc1
    s_waitcnt vmcnt(7) lgkmcnt(4)
    v_mfma_f32_32x32x16_bf16 v[140:155], v[168:171], v[40:43], v[140:155]
    ds_read_b64_tr_b16 v[164:165], v254 offset:8960
    ds_read_b64_tr_b16 v[166:167], v254 offset:9472
    s_add_u32 s41, s43, 15360
    buffer_load_dwordx4 v[72:75], v1, s[4:7], s41 offen sc1
    s_waitcnt vmcnt(7) lgkmcnt(4)
    v_mfma_f32_32x32x16_bf16 v[140:155], v[156:159], v[44:47], v[140:155]
    ds_read_b64_tr_b16 v[168:169], v254 offset:9984
    ds_read_b64_tr_b16 v[170:171], v254 offset:10496
    s_add_u32 s41, s43, 16384
    buffer_load_dwordx4 v[76:79], v1, s[4:7], s41 offen sc1
    s_waitcnt vmcnt(7) lgkmcnt(4)
    v_mfma_f32_32x32x16_bf16 v[140:155], v[160:163], v[48:51], v[140:155]
    ds_read_b64_tr_b16 v[156:157], v254 offset:10752
    ds_read_b64_tr_b16 v[158:159], v254 offset:11264
    s_add_u32 s41, s43, 17408
    buffer_load_dwordx4 v[80:83], v1, s[4:7], s41 offen sc1
    s_waitcnt vmcnt(7) lgkmcnt(4)
    v_mfma_f32_32x32x16_bf16 v[140:155], v[164:167], v[52:55], v[140:155]
    ds_read_b64_tr_b16 v[160:161], v254 offset:11776
    ds_read_b64_tr_b16 v[162:163], v254 offset:12288
    s_add_u32 s41, s43, 18432
    buffer_load_dwordx4 v[84:87], v1, s[4:7], s41 offen sc1
    s_waitcnt vmcnt(7) lgkmcnt(4)
    v_mfma_f32_32x32x16_bf16 v[140:155], v[168:171], v[56:59], v[140:155]
    ds_read_b64_tr_b16 v[164:165], v254 offset:12544
    ds_read_b64_tr_b16 v[166:167], v254 offset:13056
    s_add_u32 s41, s43, 19456
    buffer_load_dwordx4 v[88:91], v1, s[4:7], s41 offen sc1
    s_waitcnt vmcnt(7) lgkmcnt(4)
    v_mfma_f32_32x32x16_bf16 v[140:155], v[156:159], v[60:63], v[140:155]
    ds_read_b64_tr_b16 v[168:169], v254 offset:13568
    ds_read_b64_tr_b16 v[170:171], v254 offset:14080
    s_add_u32 s41, s43, 20480
    buffer_load_dwordx4 v[92:95], v1, s[4:7], s41 offen sc1
    s_waitcnt vmcnt(7) lgkmcnt(4)
    v_mfma_f32_32x32x16_bf16 v[140:155], v[160:163], v[64:67], v[140:155]
    ds_read_b64_tr_b16 v[156:157], v254 offset:14336
    ds_read_b64_tr_b16 v[158:159], v254 offset:14848
    s_add_u32 s41, s43, 21504
    buffer_load_dwordx4 v[96:99], v1, s[4:7], s41 offen sc1
    s_waitcnt vmcnt(7) lgkmcnt(4)
    v_mfma_f32_32x32x16_bf16 v[140:155], v[164:167], v[68:71], v[140:155]
    ds_read_b64_tr_b16 v[160:161], v254 offset:15360
    ds_read_b64_tr_b16 v[162:163], v254 offset:15872
    s_add_u32 s41, s43, 22528
    buffer_load_dwordx4 v[100:103], v1, s[4:7], s41 offen sc1
    s_waitcnt vmcnt(7) lgkmcnt(4)
    v_mfma_f32_32x32x16_bf16 v[140:155], v[168:171], v[72:75], v[140:155]
    ds_read_b64_tr_b16 v[164:165], v254 offset:16128
    ds_read_b64_tr_b16 v[166:167], v254 offset:16640
    s_add_u32 s41, s43, 23552
    buffer_load_dwordx4 v[104:107], v1, s[4:7], s41 offen sc1
    s_waitcnt vmcnt(7) lgkmcnt(4)
    v_mfma_f32_32x32x16_bf16 v[140:155], v[156:159], v[76:79], v[140:155]
    ds_read_b64_tr_b16 v[168:169], v254 offset:17152
    ds_read_b64_tr_b16 v[170:171], v254 offset:17664
    s_add_u32 s41, s43, 24576
    buffer_load_dwordx4 v[108:111], v1, s[4:7], s41 offen sc1
    s_waitcnt vmcnt(7) lgkmcnt(4)
    v_mfma_f32_32x32x16_bf16 v[140:155], v[160:163], v[80:83], v[140:155]
    ds_read_b64_tr_b16 v[156:157], v254 offset:17920
    ds_read_b64_tr_b16 v[158:159], v254 offset:18432
    s_add_u32 s41, s43, 25600
    buffer_load_dwordx4 v[112:115], v1, s[4:7], s41 offen sc1
    s_waitcnt vmcnt(7) lgkmcnt(4)
    v_mfma_f32_32x32x16_bf16 v[140:155], v[164:167], v[84:87], v[140:155]
    ds_read_b64_tr_b16 v[160:161], v254 offset:18944
    ds_read_b64_tr_b16 v[162:163], v254 offset:19456
    s_add_u32 s41, s43, 26624
    buffer_load_dwordx4 v[116:119], v1, s[4:7], s41 offen sc1
    s_waitcnt vmcnt(7) lgkmcnt(4)
    v_mfma_f32_32x32x16_bf16 v[140:155], v[168:171], v[88:91], v[140:155]
    ds_read_b64_tr_b16 v[164:165], v254 offset:19712
    ds_read_b64_tr_b16 v[166:167], v254 offset:20224
    s_add_u32 s41, s43, 27648
    buffer_load_dwordx4 v[120:123], v1, s[4:7], s41 offen sc1
    s_waitcnt vmcnt(7) lgkmcnt(4)
    v_mfma_f32_32x32x16_bf16 v[140:155], v[156:159], v[92:95], v[140:155]
    ds_read_b64_tr_b16 v[168:169], v254 offset:20736
    ds_read_b64_tr_b16 v[170:171], v254 offset:21248
    s_add_u32 s41, s43, 28672
    buffer_load_dwordx4 v[124:127], v1, s[4:7], s41 offen sc1
    s_waitcnt vmcnt(7) lgkmcnt(4)
    v_mfma_f32_32x32x16_bf16 v[140:155], v[160:163], v[96:99], v[140:155]
    ds_read_b64_tr_b16 v[156:157], v254 offset:21504
    ds_read_b64_tr_b16 v[158:159], v254 offset:22016
    s_add_u32 s41, s43, 29696
    buffer_load_dwordx4 v[128:131], v1, s[4:7], s41 offen sc1
    s_waitcnt vmcnt(7) lgkmcnt(4)
    v_mfma_f32_32x32x16_bf16 v[140:155], v[164:167], v[100:103], v[140:155]
    ds_read_b64_tr_b16 v[160:161], v254 offset:22528
    ds_read_b64_tr_b16 v[162:163], v254 offset:23040
    s_add_u32 s41, s43, 30720
    buffer_load_dwordx4 v[132:135], v1, s[4:7], s41 offen sc1
    s_waitcnt vmcnt(7) lgkmcnt(4)
    v_mfma_f32_32x32x16_bf16 v[140:155], v[168:171], v[104:107], v[140:155]
    ds_read_b64_tr_b16 v[164:165], v254 offset:23296
    ds_read_b64_tr_b16 v[166:167], v254 offset:23808
    s_add_u32 s41, s43, 31744
    buffer_load_dwordx4 v[136:139], v1, s[4:7], s41 offen sc1
    s_waitcnt vmcnt(7) lgkmcnt(4)
    v_mfma_f32_32x32x16_bf16 v[140:155], v[156:159], v[108:111], v[140:155]
    ds_read_b64_tr_b16 v[168:169], v254 offset:24320
    ds_read_b64_tr_b16 v[170:171], v254 offset:24832
    s_waitcnt vmcnt(6) lgkmcnt(4)
    v_mfma_f32_32x32x16_bf16 v[140:155], v[160:163], v[112:115], v[140:155]
    ds_read_b64_tr_b16 v[156:157], v254 offset:25088
    ds_read_b64_tr_b16 v[158:159], v254 offset:25600
    s_waitcnt vmcnt(5) lgkmcnt(4)
    v_mfma_f32_32x32x16_bf16 v[140:155], v[164:167], v[116:119], v[140:155]
    ds_read_b64_tr_b16 v[160:161], v254 offset:26112
    ds_read_b64_tr_b16 v[162:163], v254 offset:26624
    s_waitcnt vmcnt(4) lgkmcnt(4)
    v_mfma_f32_32x32x16_bf16 v[140:155], v[168:171], v[120:123], v[140:155]
    ds_read_b64_tr_b16 v[164:165], v254 offset:26880
    ds_read_b64_tr_b16 v[166:167], v254 offset:27392
    s_waitcnt vmcnt(3) lgkmcnt(4)
    v_mfma_f32_32x32x16_bf16 v[140:155], v[156:159], v[124:127], v[140:155]
    ds_read_b64_tr_b16 v[168:169], v254 offset:27904
    ds_read_b64_tr_b16 v[170:171], v254 offset:28416
    s_waitcnt vmcnt(2) lgkmcnt(4)
    v_mfma_f32_32x32x16_bf16 v[140:155], v[160:163], v[128:131], v[140:155]
    s_waitcnt vmcnt(1) lgkmcnt(2)
    v_mfma_f32_32x32x16_bf16 v[140:155], v[164:167], v[132:135], v[140:155]
    s_waitcnt vmcnt(0) lgkmcnt(0)
    v_mfma_f32_32x32x16_bf16 v[140:155], v[168:171], v[136:139], v[140:155]
    s_add_u32 s45, s70, s89
    s_add_u32 s46, s71, s92
    s_nop 9
    v_cvt_pk_bf16_f32 v180, v140, v141
    v_cvt_pk_bf16_f32 v181, v142, v143
    v_cvt_pk_bf16_f32 v182, v144, v145
    v_cvt_pk_bf16_f32 v183, v146, v147
    v_cvt_pk_bf16_f32 v184, v148, v149
    v_cvt_pk_bf16_f32 v185, v150, v151
    v_cvt_pk_bf16_f32 v186, v152, v153
    v_cvt_pk_bf16_f32 v187, v154, v155
    buffer_store_dwordx4 v[180:183], v1, s[4:7], s45 offen
    buffer_store_dwordx4 v[184:187], v1, s[4:7], s45 offen offset:1024
    v_pk_add_f32 v[192:193], v[140:141], v[142:143]
    v_pk_mul_f32 v[194:195], v[140:141], v[140:141]
    v_pk_fma_f32 v[194:195], v[142:143], v[142:143], v[194:195]
    v_pk_add_f32 v[192:193], v[192:193], v[144:145]
    v_pk_fma_f32 v[194:195], v[144:145], v[144:145], v[194:195]
    v_pk_add_f32 v[192:193], v[192:193], v[146:147]
    v_pk_fma_f32 v[194:195], v[146:147], v[146:147], v[194:195]
    v_pk_add_f32 v[192:193], v[192:193], v[148:149]
    v_pk_fma_f32 v[194:195], v[148:149], v[148:149], v[194:195]
    v_pk_add_f32 v[192:193], v[192:193], v[150:151]
    v_pk_fma_f32 v[194:195], v[150:151], v[150:151], v[194:195]
    v_pk_add_f32 v[192:193], v[192:193], v[152:153]
    v_pk_fma_f32 v[194:195], v[152:153], v[152:153], v[194:195]
    v_pk_add_f32 v[192:193], v[192:193], v[154:155]
    v_pk_fma_f32 v[194:195], v[154:155], v[154:155], v[194:195]
    v_add_f32 v188, v192, v193
    v_add_f32 v189, v194, v195
    v_mov_b32 v190, v188
    v_mov_b32 v191, v189
    s_nop 0
    v_permlane32_swap_b32 v188, v190
    v_permlane32_swap_b32 v189, v191
    v_add_f32 v188, v188, v190
    v_add_f32 v189, v189, v191
    v_lshlrev_b32 v190, 3, v2
    buffer_store_dwordx2 v[188:189], v190, s[4:7], s46 offen
    s_add_u32 s43, s75, 40960
    s_waitcnt vmcnt(0)
    s_mov_b64 exec, 1
    s_cmp_eq_u32 s19, 0
    s_cbranch_scc0 pubs_55
    buffer_store_dword v10, v6, s[4:7], s43 offen
    s_branch pubd_56
pubs_55:
    buffer_wbl2 sc1
    s_waitcnt vmcnt(0)
    buffer_store_dword v10, v6, s[4:7], s43 offen sc1
pubd_56:
    s_mov_b64 exec, -1
    s_nop 0
    s_barrier
    s_add_u32 s42, s67, 40960
poll_57:
    s_add_u32 s50, s50, 1
    s_cmp_gt_u32 s50, 0x40000
    s_cbranch_scc1 pollx_58
    buffer_load_dword v9, v5, s[4:7], s42 offen sc1
    s_waitcnt vmcnt(0)
    v_cmp_eq_u32 vcc, 1, v9
    s_nop 0
    s_and_b32 s51, vcc_lo, 0x3fff
    s_cmp_eq_u32 s51, 0x3fff
    s_cbranch_scc0 poll_57
pollx_58:
    s_cmp_eq_u32 s19, 0
    s_cbranch_scc1 acq_59
    buffer_inv sc1
    s_waitcnt vmcnt(0)
acq_59:
    s_add_u32 s43, s64, s89
    s_add_u32 s44, s65, s92
    s_add_u32 s41, s43, 0
    buffer_load_dwordx4 v[12:15], v1, s[4:7], s41 offen sc1
    s_add_u32 s41, s43, 1024
    buffer_load_dwordx4 v[16:19], v1, s[4:7], s41 offen sc1
    s_add_u32 s41, s43, 2048
    buffer_load_dwordx4 v[20:23], v1, s[4:7], s41 offen sc1
    s_add_u32 s41, s43, 3072
    buffer_load_dwordx4 v[24:27], v1, s[4:7], s41 offen sc1
    s_add_u32 s41, s43, 4096
    buffer_load_dwordx4 v[28:31], v1, s[4:7], s41 offen sc1
    s_add_u32 s41, s43, 5120
    buffer_load_dwordx4 v[32:35], v1, s[4:7], s41 offen sc1
    s_add_u32 s41, s43, 6144
    buffer_load_dwordx4 v[36:39], v1, s[4:7], s41 offen sc1
    s_add_u32 s41, s43, 7168
    buffer_load_dwordx4 v[40:43], v1, s[4:7], s41 offen sc1
    ds_read_b64_tr_b16 v[188:189], v7 offset:0
    ds_read_b64_tr_b16 v[190:191], v7 offset:1024
    ds_read_b64_tr_b16 v[192:193], v7 offset:512
    ds_read_b64_tr_b16 v[194:195], v7 offset:1536
    ds_read_b64_tr_b16 v[196:197], v7 offset:57344
    ds_read_b64_tr_b16 v[198:199], v7 offset:58368
    ds_read_b64_tr_b16 v[200:201], v7 offset:2048
    ds_read_b64_tr_b16 v[202:203], v7 offset:3072
    ds_read_b64_tr_b16 v[204:205], v7 offset:2560
    ds_read_b64_tr_b16 v[206:207], v7 offset:3584
    ds_read_b64_tr_b16 v[208:209], v7 offset:59392
    ds_read_b64_tr_b16 v[210:211], v7 offset:60416
    s_waitcnt vmcnt(7) lgkmcnt(10)
    v_mfma_f32_32x32x16_bf16 v[124:139], v[188:191], v[12:15], 0
    ds_read_b64_tr_b16 v[188:189], v7 offset:4096
    ds_read_b64_tr_b16 v[190:191], v7 offset:5120
    s_waitcnt lgkmcnt(10)
    v_mfma_f32_32x32x16_bf16 v[140:155], v[192:195], v[12:15], 0
    ds_read_b64_tr_b16 v[192:193], v7 offset:4608
    ds_read_b64_tr_b16 v[194:195], v7 offset:5632
    s_waitcnt lgkmcnt(10)
    v_mfma_f32_32x32x16_bf16 v[156:171], v[196:199], v[12:15], 0
    ds_read_b64_tr_b16 v[196:197], v7 offset:61440
    ds_read_b64_tr_b16 v[198:199], v7 offset:62464
    s_add_u32 s41, s43, 8192
    buffer_load_dwordx4 v[44:47], v1, s[4:7], s41 offen sc1
    s_waitcnt vmcnt(7) lgkmcnt(10)
    v_mfma_f32_32x32x16_bf16 v[124:139], v[200:203], v[16:19], v[124:139]
    ds_read_b64_tr_b16 v[200:201], v7 offset:6144
    ds_read_b64_tr_b16 v[202:203], v7 offset:7168
    s_waitcnt lgkmcnt(10)
    v_mfma_f32_32x32x16_bf16 v[140:155], v[204:207], v[16:19], v[140:155]
    ds_read_b64_tr_b16 v[204:205], v7 offset:6656
    ds_read_b64_tr_b16 v[206:207], v7 offset:7680
    s_waitcnt lgkmcnt(10)
    v_mfma_f32_32x32x16_bf16 v[156:171], v[208:211], v[16:19], v[156:171]
    ds_read_b64_tr_b16 v[208:209], v7 offset:63488
    ds_read_b64_tr_b16 v[210:211], v7 offset:64512
    s_add_u32 s41, s43, 9216
    buffer_load_dwordx4 v[48:51], v1, s[4:7], s41 offen sc1
    s_waitcnt vmcnt(7) lgkmcnt(10)
    v_mfma_f32_32x32x16_bf16 v[124:139], v[188:191], v[20:23], v[124:139]
    ds_read_b64_tr_b16 v[188:189], v7 offset:8192
    ds_read_b64_tr_b16 v[190:191], v7 offset:9216
    s_waitcnt lgkmcnt(10)
    v_mfma_f32_32x32x16_bf16 v[140:155], v[192:195], v[20:23], v[140:155]
    ds_read_b64_tr_b16 v[192:193], v7 offset:8704
    ds_read_b64_tr_b16 v[194:195], v7 offset:9728
    s_waitcnt lgkmcnt(10)
    v_mfma_f32_32x32x16_bf16 v[156:171], v[196:199], v[20:23], v[156:171]
    ds_read_b64_tr_b16 v[196:197], v8 offset:0
    ds_read_b64_tr_b16 v[198:199], v8 offset:1024
    s_add_u32 s41, s43, 10240
    buffer_load_dwordx4 v[52:55], v1, s[4:7], s41 offen sc1
    buffer_load_dwordx2 v[212:213], v4, s[4:7], s44 offen offset:0 sc1
    buffer_load_dwordx2 v[214:215], v4, s[4:7], s44 offen offset:512 sc1
    buffer_load_dwordx2 v[216:217], v4, s[4:7], s44 offen offset:1024 sc1
    buffer_load_dwordx2 v[218:219], v4, s[4:7], s44 offen offset:1536 sc1
    s_waitcnt vmcnt(11) lgkmcnt(10)
    v_mfma_f32_32x32x16_bf16 v[124:139], v[200:203], v[24:27], v[124:139]
    ds_read_b64_tr_b16 v[200:201], v7 offset:10240
    ds_read_b64_tr_b16 v[202:203], v7 offset:11264
    s_waitcnt lgkmcnt(10)
    v_mfma_f32_32x32x16_bf16 v[140:155], v[204:207], v[24:27], v[140:155]
    ds_read_b64_tr_b16 v[204:205], v7 offset:10752
    ds_read_b64_tr_b16 v[206:207], v7 offset:11776
    s_waitcnt lgkmcnt(10)
    v_mfma_f32_32x32x16_bf16 v[156:171], v[208:211], v[24:27], v[156:171]
    ds_read_b64_tr_b16 v[208:209], v8 offset:2048
    ds_read_b64_tr_b16 v[210:211], v8 offset:3072
    s_add_u32 s41, s43, 11264
    buffer_load_dwordx4 v[56:59], v1, s[4:7], s41 offen sc1
    buffer_load_dwordx2 v[220:221], v4, s[4:7], s44 offen offset:2048 sc1
    buffer_load_dwordx2 v[222:223], v4, s[4:7], s44 offen offset:2560 sc1
    buffer_load_dwordx2 v[224:225], v4, s[4:7], s44 offen offset:3072 sc1
    s_waitcnt vmcnt(14) lgkmcnt(10)
    v_mfma_f32_32x32x16_bf16 v[124:139], v[188:191], v[28:31], v[124:139]
    ds_read_b64_tr_b16 v[188:189], v7 offset:12288
    ds_read_b64_tr_b16 v[190:191], v7 offset:13312
    s_waitcnt lgkmcnt(10)
    v_mfma_f32_32x32x16_bf16 v[140:155], v[192:195], v[28:31], v[140:155]
    ds_read_b64_tr_b16 v[192:193], v7 offset:12800
    ds_read_b64_tr_b16 v[194:195], v7 offset:13824
    s_waitcnt lgkmcnt(10)
    v_mfma_f32_32x32x16_bf16 v[156:171], v[196:199], v[28:31], v[156:171]
    ds_read_b64_tr_b16 v[196:197], v8 offset:4096
    ds_read_b64_tr_b16 v[198:199], v8 offset:5120
    s_add_u32 s41, s43, 12288
    buffer_load_dwordx4 v[60:63], v1, s[4:7], s41 offen sc1
    s_waitcnt vmcnt(14) lgkmcnt(10)
    v_mfma_f32_32x32x16_bf16 v[124:139], v[200:203], v[32:35], v[124:139]
    ds_read_b64_tr_b16 v[200:201], v7 offset:14336
    ds_read_b64_tr_b16 v[202:203], v7 offset:15360
    s_waitcnt lgkmcnt(10)
    v_mfma_f32_32x32x16_bf16 v[140:155], v[204:207], v[32:35], v[140:155]
    ds_read_b64_tr_b16 v[204:205], v7 offset:14848
    ds_read_b64_tr_b16 v[206:207], v7 offset:15872
    s_waitcnt lgkmcnt(10)
    v_mfma_f32_32x32x16_bf16 v[156:171], v[208:211], v[32:35], v[156:171]
    ds_read_b64_tr_b16 v[208:209], v8 offset:6144
    ds_read_b64_tr_b16 v[210:211], v8 offset:7168
    s_add_u32 s41, s43, 13312
    buffer_load_dwordx4 v[64:67], v1, s[4:7], s41 offen sc1
    s_waitcnt vmcnt(14) lgkmcnt(10)
    v_mfma_f32_32x32x16_bf16 v[124:139], v[188:191], v[36:39], v[124:139]
    ds_read_b64_tr_b16 v[188:189], v7 offset:16384
    ds_read_b64_tr_b16 v[190:191], v7 offset:17408
    s_waitcnt lgkmcnt(10)
    v_mfma_f32_32x32x16_bf16 v[140:155], v[192:195], v[36:39], v[140:155]
    ds_read_b64_tr_b16 v[192:193], v7 offset:16896
    ds_read_b64_tr_b16 v[194:195], v7 offset:17920
    s_waitcnt lgkmcnt(10)
    v_mfma_f32_32x32x16_bf16 v[156:171], v[196:199], v[36:39], v[156:171]
    ds_read_b64_tr_b16 v[196:197], v8 offset:8192
    ds_read_b64_tr_b16 v[198:199], v8 offset:9216
    s_add_u32 s41, s43, 14336
    buffer_load_dwordx4 v[68:71], v1, s[4:7], s41 offen sc1
    s_waitcnt vmcnt(14) lgkmcnt(10)
    v_mfma_f32_32x32x16_bf16 v[124:139], v[200:203], v[40:43], v[124:139]
    ds_read_b64_tr_b16 v[200:201], v7 offset:18432
    ds_read_b64_tr_b16 v[202:203], v7 offset:19456
    s_waitcnt lgkmcnt(10)
    v_mfma_f32_32x32x16_bf16 v[140:155], v[204:207], v[40:43], v[140:155]
    ds_read_b64_tr_b16 v[204:205], v7 offset:18944
    ds_read_b64_tr_b16 v[206:207], v7 offset:19968
    s_waitcnt lgkmcnt(10)
    v_mfma_f32_32x32x16_bf16 v[156:171], v[208:211], v[40:43], v[156:171]
    ds_read_b64_tr_b16 v[208:209], v8 offset:10240
    ds_read_b64_tr_b16 v[210:211], v8 offset:11264
    s_add_u32 s41, s43, 15360
    buffer_load_dwordx4 v[72:75], v1, s[4:7], s41 offen sc1
    s_waitcnt vmcnt(14) lgkmcnt(10)
    v_mfma_f32_32x32x16_bf16 v[124:139], v[188:191], v[44:47], v[124:139]
    ds_read_b64_tr_b16 v[188:189], v7 offset:20480
    ds_read_b64_tr_b16 v[190:191], v7 offset:21504
    s_waitcnt lgkmcnt(10)
    v_mfma_f32_32x32x16_bf16 v[140:155], v[192:195], v[44:47], v[140:155]
    ds_read_b64_tr_b16 v[192:193], v7 offset:20992
    ds_read_b64_tr_b16 v[194:195], v7 offset:22016
    s_waitcnt lgkmcnt(10)
    v_mfma_f32_32x32x16_bf16 v[156:171], v[196:199], v[44:47], v[156:171]
    ds_read_b64_tr_b16 v[196:197], v8 offset:12288
    ds_read_b64_tr_b16 v[198:199], v8 offset:13312
    s_add_u32 s41, s43, 16384
    buffer_load_dwordx4 v[76:79], v1, s[4:7], s41 offen sc1
    s_waitcnt vmcnt(14) lgkmcnt(10)
    v_mfma_f32_32x32x16_bf16 v[124:139], v[200:203], v[48:51], v[124:139]
    ds_read_b64_tr_b16 v[200:201], v7 offset:22528
    ds_read_b64_tr_b16 v[202:203], v7 offset:23552
    s_waitcnt lgkmcnt(10)
    v_mfma_f32_32x32x16_bf16 v[140:155], v[204:207], v[48:51], v[140:155]
    ds_read_b64_tr_b16 v[204:205], v7 offset:23040
    ds_read_b64_tr_b16 v[206:207], v7 offset:24064
    s_waitcnt lgkmcnt(10)
    v_mfma_f32_32x32x16_bf16 v[156:171], v[208:211], v[48:51], v[156:171]
    ds_read_b64_tr_b16 v[208:209], v8 offset:14336
    ds_read_b64_tr_b16 v[210:211], v8 offset:15360
    s_add_u32 s41, s43, 17408
    buffer_load_dwordx4 v[80:83], v1, s[4:7], s41 offen sc1
    s_waitcnt vmcnt(14) lgkmcnt(10)
    v_mfma_f32_32x32x16_bf16 v[124:139], v[188:191], v[52:55], v[124:139]
    ds_read_b64_tr_b16 v[188:189], v7 offset:24576
    ds_read_b64_tr_b16 v[190:191], v7 offset:25600
    s_waitcnt lgkmcnt(10)
    v_mfma_f32_32x32x16_bf16 v[140:155], v[192:195], v[52:55], v[140:155]
    ds_read_b64_tr_b16 v[192:193], v7 offset:25088
    ds_read_b64_tr_b16 v[194:195], v7 offset:26112
    s_waitcnt lgkmcnt(10)
    v_mfma_f32_32x32x16_bf16 v[156:171], v[196:199], v[52:55], v[156:171]
    ds_read_b64_tr_b16 v[196:197], v8 offset:16384
    ds_read_b64_tr_b16 v[198:199], v8 offset:17408
    s_add_u32 s41, s43, 18432
    buffer_load_dwordx4 v[84:87], v1, s[4:7], s41 offen sc1
    s_waitcnt vmcnt(10) lgkmcnt(10)
    v_mfma_f32_32x32x16_bf16 v[124:139], v[200:203], v[56:59], v[124:139]
    ds_read_b64_tr_b16 v[200:201], v7 offset:26624
    ds_read_b64_tr_b16 v[202:203], v7 offset:27648
    s_waitcnt lgkmcnt(10)
    v_mfma_f32_32x32x16_bf16 v[140:155], v[204:207], v[56:59], v[140:155]
    ds_read_b64_tr_b16 v[204:205], v7 offset:27136
    ds_read_b64_tr_b16 v[206:207], v7 offset:28160
    s_waitcnt lgkmcnt(10)
    v_mfma_f32_32x32x16_bf16 v[156:171], v[208:211], v[56:59], v[156:171]
    ds_read_b64_tr_b16 v[208:209], v8 offset:18432
    ds_read_b64_tr_b16 v[210:211], v8 offset:19456
    s_add_u32 s41, s43, 19456
    buffer_load_dwordx4 v[88:91], v1, s[4:7], s41 offen sc1
    s_waitcnt vmcnt(7) lgkmcnt(10)
    v_mfma_f32_32x32x16_bf16 v[124:139], v[188:191], v[60:63], v[124:139]
    ds_read_b64_tr_b16 v[188:189], v7 offset:28672
    ds_read_b64_tr_b16 v[190:191], v7 offset:29696
    s_waitcnt lgkmcnt(10)
    v_mfma_f32_32x32x16_bf16 v[140:155], v[192:195], v[60:63], v[140:155]
    ds_read_b64_tr_b16 v[192:193], v7 offset:29184
    ds_read_b64_tr_b16 v[194:195], v7 offset:30208
    s_waitcnt lgkmcnt(10)
    v_mfma_f32_32x32x16_bf16 v[156:171], v[196:199], v[60:63], v[156:171]
    ds_read_b64_tr_b16 v[196:197], v8 offset:20480
    ds_read_b64_tr_b16 v[198:199], v8 offset:21504
    s_add_u32 s41, s43, 20480
    buffer_load_dwordx4 v[92:95], v1, s[4:7], s41 offen sc1
    s_waitcnt vmcnt(7) lgkmcnt(10)
    v_mfma_f32_32x32x16_bf16 v[124:139], v[200:203], v[64:67], v[124:139]
    ds_read_b64_tr_b16 v[200:201], v7 offset:30720
    ds_read_b64_tr_b16 v[202:203], v7 offset:31744
    s_waitcnt lgkmcnt(10)
    v_mfma_f32_32x32x16_bf16 v[140:155], v[204:207], v[64:67], v[140:155]
    v_add_f32 v212, v212, v214
    ds_read_b64_tr_b16 v[204:205], v7 offset:31232
    ds_read_b64_tr_b16 v[206:207], v7 offset:32256
    s_waitcnt lgkmcnt(10)
    v_mfma_f32_32x32x16_bf16 v[156:171], v[208:211], v[64:67], v[156:171]
    v_add_f32 v213, v213, v215
    v_add_f32 v212, v212, v216
    ds_read_b64_tr_b16 v[208:209], v8 offset:22528
    ds_read_b64_tr_b16 v[210:211], v8 offset:23552
    s_add_u32 s41, s43, 21504
    buffer_load_dwordx4 v[96:99], v1, s[4:7], s41 offen sc1
    s_waitcnt vmcnt(7) lgkmcnt(10)
    v_mfma_f32_32x32x16_bf16 v[124:139], v[188:191], v[68:71], v[124:139]
    v_add_f32 v213, v213, v217
    v_add_f32 v212, v212, v218
    ds_read_b64_tr_b16 v[188:189], v7 offset:32768
    ds_read_b64_tr_b16 v[190:191], v7 offset:33792
    s_waitcnt lgkmcnt(10)
    v_mfma_f32_32x32x16_bf16 v[140:155], v[192:195], v[68:71], v[140:155]
    v_add_f32 v213, v213, v219
    v_add_f32 v212, v212, v220
    ds_read_b64_tr_b16 v[192:193], v7 offset:33280
    ds_read_b64_tr_b16 v[194:195], v7 offset:34304
    s_waitcnt lgkmcnt(10)
    v_mfma_f32_32x32x16_bf16 v[156:171], v[196:199], v[68:71], v[156:171]
    v_add_f32 v213, v213, v221
    v_add_f32 v212, v212, v222
    ds_read_b64_tr_b16 v[196:197], v8 offset:24576
    ds_read_b64_tr_b16 v[198:199], v8 offset:25600
    s_add_u32 s41, s43, 22528
    buffer_load_dwordx4 v[100:103], v1, s[4:7], s41 offen sc1
    s_waitcnt vmcnt(7) lgkmcnt(10)
    v_mfma_f32_32x32x16_bf16 v[124:139], v[200:203], v[72:75], v[124:139]
    v_add_f32 v213, v213, v223
    v_add_f32 v212, v212, v224
    ds_read_b64_tr_b16 v[200:201], v7 offset:34816
    ds_read_b64_tr_b16 v[202:203], v7 offset:35840
    s_waitcnt lgkmcnt(10)
    v_mfma_f32_32x32x16_bf16 v[140:155], v[204:207], v[72:75], v[140:155]
    v_add_f32 v213, v213, v225
    v_mov_b32 v248, v212
    ds_read_b64_tr_b16 v[204:205], v7 offset:35328
    ds_read_b64_tr_b16 v[206:207], v7 offset:36352
    s_waitcnt lgkmcnt(10)
    v_mfma_f32_32x32x16_bf16 v[156:171], v[208:211], v[72:75], v[156:171]
    v_mov_b32 v249, v213
    v_permlane32_swap_b32 v212, v248
    ds_read_b64_tr_b16 v[208:209], v8 offset:26624
    ds_read_b64_tr_b16 v[210:211], v8 offset:27648
    s_add_u32 s41, s43, 23552
    buffer_load_dwordx4 v[104:107], v1, s[4:7], s41 offen sc1
    s_waitcnt vmcnt(7) lgkmcnt(10)
    v_mfma_f32_32x32x16_bf16 v[124:139], v[188:191], v[76:79], v[124:139]
    v_permlane32_swap_b32 v213, v249
    v_add_f32 v212, v212, v248
    ds_read_b64_tr_b16 v[188:189], v7 offset:36864
    ds_read_b64_tr_b16 v[190:191], v7 offset:37888
    s_waitcnt lgkmcnt(10)
    v_mfma_f32_32x32x16_bf16 v[140:155], v[192:195], v[76:79], v[140:155]
    v_add_f32 v213, v213, v249
    v_mul_f32 v244, 0xbb124925, v212
    ds_read_b64_tr_b16 v[192:193], v7 offset:37376
    ds_read_b64_tr_b16 v[194:195], v7 offset:38400
    s_waitcnt lgkmcnt(10)
    v_mfma_f32_32x32x16_bf16 v[156:171], v[196:199], v[76:79], v[156:171]
    v_mul_f32 v245, 0x3b124925, v213
    v_fma_f32 v245, -v244, v244, v245
    ds_read_b64_tr_b16 v[196:197], v8 offset:28672
    ds_read_b64_tr_b16 v[198:199], v8 offset:29696
    s_add_u32 s41, s43, 24576
    buffer_load_dwordx4 v[108:111], v1, s[4:7], s41 offen sc1
    s_waitcnt vmcnt(7) lgkmcnt(10)
    v_mfma_f32_32x32x16_bf16 v[124:139], v[200:203], v[80:83], v[124:139]
    v_max_f32 v245, 0, v245
    v_add_f32 v248, 0x3727c5ac, v245
    ds_read_b64_tr_b16 v[200:201], v7 offset:38912
    ds_read_b64_tr_b16 v[202:203], v7 offset:39936
    s_waitcnt lgkmcnt(10)
    v_mfma_f32_32x32x16_bf16 v[140:155], v[204:207], v[80:83], v[140:155]
    v_rcp_f32 v249, v248
    s_nop 0
    v_mul_f32 v249, v249, v245
    ds_read_b64_tr_b16 v[204:205], v7 offset:39424
    ds_read_b64_tr_b16 v[206:207], v7 offset:40448
    s_waitcnt lgkmcnt(10)
    v_mfma_f32_32x32x16_bf16 v[156:171], v[208:211], v[80:83], v[156:171]
    v_add_f32 v249, 0x3727c5ac, v249
    v_mul_f32 v248, v248, v249
    ds_read_b64_tr_b16 v[208:209], v8 offset:30720
    ds_read_b64_tr_b16 v[210:211], v8 offset:31744
    s_add_u32 s41, s43, 25600
    buffer_load_dwordx4 v[112:115], v1, s[4:7], s41 offen sc1
    s_waitcnt vmcnt(7) lgkmcnt(10)
    v_mfma_f32_32x32x16_bf16 v[124:139], v[188:191], v[84:87], v[124:139]
    v_rsq_f32 v246, v248
    v_sqrt_f32 v247, v248
    ds_read_b64_tr_b16 v[188:189], v7 offset:40960
    ds_read_b64_tr_b16 v[190:191], v7 offset:41984
    s_waitcnt lgkmcnt(10)
    v_mfma_f32_32x32x16_bf16 v[140:155], v[192:195], v[84:87], v[140:155]
    v_mul_f32 v250, 0xc0135761, v246
    v_mul_f32 v248, v246, v246
    ds_read_b64_tr_b16 v[192:193], v7 offset:41472
    ds_read_b64_tr_b16 v[194:195], v7 offset:42496
    s_waitcnt lgkmcnt(10)
    v_mfma_f32_32x32x16_bf16 v[156:171], v[196:199], v[84:87], v[156:171]
    v_mul_f32 v251, 0x3d372713, v250
    v_mul_f32 v251, v251, v248
    ds_read_b64_tr_b16 v[196:197], v8 offset:32768
    ds_read_b64_tr_b16 v[198:199], v8 offset:33792
    s_add_u32 s41, s43, 26624
    buffer_load_dwordx4 v[116:119], v1, s[4:7], s41 offen sc1
    s_waitcnt vmcnt(7) lgkmcnt(10)
    v_mfma_f32_32x32x16_bf16 v[124:139], v[200:203], v[88:91], v[124:139]
    v_cvt_pk_bf16_f32 v241, v244, v247
    v_mov_b32 v243, 0
    ds_read_b64_tr_b16 v[200:201], v7 offset:43008
    ds_read_b64_tr_b16 v[202:203], v7 offset:44032
    s_waitcnt lgkmcnt(10)
    v_mfma_f32_32x32x16_bf16 v[140:155], v[204:207], v[88:91], v[140:155]
    v_lshlrev_b32 v248, 16, v241
    v_and_b32 v249, 0xffff0000, v241
    ds_read_b64_tr_b16 v[204:205], v7 offset:43520
    ds_read_b64_tr_b16 v[206:207], v7 offset:44544
    s_waitcnt lgkmcnt(10)
    v_mfma_f32_32x32x16_bf16 v[156:171], v[208:211], v[88:91], v[156:171]
    v_sub_f32 v240, v244, v248
    v_sub_f32 v249, v247, v249
    ds_read_b64_tr_b16 v[208:209], v8 offset:34816
    ds_read_b64_tr_b16 v[210:211], v8 offset:35840
    s_add_u32 s41, s43, 27648
    buffer_load_dwordx4 v[120:123], v1, s[4:7], s41 offen sc1
    s_waitcnt vmcnt(7) lgkmcnt(10)
    v_mfma_f32_32x32x16_bf16 v[124:139], v[188:191], v[92:95], v[124:139]
    v_cvt_pk_bf16_f32 v240, v248, v240
    v_cvt_pk_bf16_f32 v242, v249, v243
    ds_read_b64_tr_b16 v[188:189], v7 offset:45056
    ds_read_b64_tr_b16 v[190:191], v7 offset:46080
    s_waitcnt lgkmcnt(10)
    v_mfma_f32_32x32x16_bf16 v[140:155], v[192:195], v[92:95], v[140:155]
    ds_read_b64_tr_b16 v[192:193], v7 offset:45568
    ds_read_b64_tr_b16 v[194:195], v7 offset:46592
    s_waitcnt lgkmcnt(10)
    v_mfma_f32_32x32x16_bf16 v[156:171], v[196:199], v[92:95], v[156:171]
    ds_read_b64_tr_b16 v[196:197], v8 offset:36864
    ds_read_b64_tr_b16 v[198:199], v8 offset:37888
    s_waitcnt vmcnt(6) lgkmcnt(10)
    v_mfma_f32_32x32x16_bf16 v[124:139], v[200:203], v[96:99], v[124:139]
    ds_read_b64_tr_b16 v[200:201], v7 offset:47104
    ds_read_b64_tr_b16 v[202:203], v7 offset:48128
    s_waitcnt lgkmcnt(10)
    v_mfma_f32_32x32x16_bf16 v[140:155], v[204:207], v[96:99], v[140:155]
    ds_read_b64_tr_b16 v[204:205], v7 offset:47616
    ds_read_b64_tr_b16 v[206:207], v7 offset:48640
    s_waitcnt lgkmcnt(10)
    v_mfma_f32_32x32x16_bf16 v[156:171], v[208:211], v[96:99], v[156:171]
    ds_read_b64_tr_b16 v[208:209], v8 offset:38912
    ds_read_b64_tr_b16 v[210:211], v8 offset:39936
    s_waitcnt vmcnt(5) lgkmcnt(10)
    v_mfma_f32_32x32x16_bf16 v[124:139], v[188:191], v[100:103], v[124:139]
    ds_read_b64_tr_b16 v[188:189], v7 offset:49152
    ds_read_b64_tr_b16 v[190:191], v7 offset:50176
    s_waitcnt lgkmcnt(10)
    v_mfma_f32_32x32x16_bf16 v[140:155], v[192:195], v[100:103], v[140:155]
    ds_read_b64_tr_b16 v[192:193], v7 offset:49664
    ds_read_b64_tr_b16 v[194:195], v7 offset:50688
    s_waitcnt lgkmcnt(10)
    v_mfma_f32_32x32x16_bf16 v[156:171], v[196:199], v[100:103], v[156:171]
    ds_read_b64_tr_b16 v[196:197], v8 offset:40960
    ds_read_b64_tr_b16 v[198:199], v8 offset:41984
    s_waitcnt vmcnt(4) lgkmcnt(10)
    v_mfma_f32_32x32x16_bf16 v[124:139], v[200:203], v[104:107], v[124:139]
    ds_read_b64_tr_b16 v[200:201], v7 offset:51200
    ds_read_b64_tr_b16 v[202:203], v7 offset:52224
    s_waitcnt lgkmcnt(10)
    v_mfma_f32_32x32x16_bf16 v[140:155], v[204:207], v[104:107], v[140:155]
    ds_read_b64_tr_b16 v[204:205], v7 offset:51712
    ds_read_b64_tr_b16 v[206:207], v7 offset:52736
    s_waitcnt lgkmcnt(10)
    v_mfma_f32_32x32x16_bf16 v[156:171], v[208:211], v[104:107], v[156:171]
    ds_read_b64_tr_b16 v[208:209], v8 offset:43008
    ds_read_b64_tr_b16 v[210:211], v8 offset:44032
    s_waitcnt vmcnt(3) lgkmcnt(10)
    v_mfma_f32_32x32x16_bf16 v[124:139], v[188:191], v[108:111], v[124:139]
    ds_read_b64_tr_b16 v[188:189], v7 offset:53248
    ds_read_b64_tr_b16 v[190:191], v7 offset:54272
    s_waitcnt lgkmcnt(10)
    v_mfma_f32_32x32x16_bf16 v[140:155], v[192:195], v[108:111], v[140:155]
    ds_read_b64_tr_b16 v[192:193], v7 offset:53760
    ds_read_b64_tr_b16 v[194:195], v7 offset:54784
    s_waitcnt lgkmcnt(10)
    v_mfma_f32_32x32x16_bf16 v[156:171], v[196:199], v[108:111], v[156:171]
    ds_read_b64_tr_b16 v[196:197], v8 offset:45056
    ds_read_b64_tr_b16 v[198:199], v8 offset:46080
    s_waitcnt vmcnt(2) lgkmcnt(10)
    v_mfma_f32_32x32x16_bf16 v[124:139], v[200:203], v[112:115], v[124:139]
    ds_read_b64_tr_b16 v[200:201], v7 offset:55296
    ds_read_b64_tr_b16 v[202:203], v7 offset:56320
    s_waitcnt lgkmcnt(10)
    v_mfma_f32_32x32x16_bf16 v[140:155], v[204:207], v[112:115], v[140:155]
    ds_read_b64_tr_b16 v[204:205], v7 offset:55808
    ds_read_b64_tr_b16 v[206:207], v7 offset:56832
    s_waitcnt lgkmcnt(10)
    v_mfma_f32_32x32x16_bf16 v[156:171], v[208:211], v[112:115], v[156:171]
    ds_read_b64_tr_b16 v[208:209], v8 offset:47104
    ds_read_b64_tr_b16 v[210:211], v8 offset:48128
    s_waitcnt vmcnt(1) lgkmcnt(10)
    v_mfma_f32_32x32x16_bf16 v[124:139], v[188:191], v[116:119], v[124:139]
    s_waitcnt lgkmcnt(8)
    v_mfma_f32_32x32x16_bf16 v[140:155], v[192:195], v[116:119], v[140:155]
    s_waitcnt lgkmcnt(6)
    v_mfma_f32_32x32x16_bf16 v[156:171], v[196:199], v[116:119], v[156:171]
    s_waitcnt vmcnt(0) lgkmcnt(4)
    v_mfma_f32_32x32x16_bf16 v[124:139], v[200:203], v[120:123], v[124:139]
    s_waitcnt lgkmcnt(2)
    v_mfma_f32_32x32x16_bf16 v[140:155], v[204:207], v[120:123], v[140:155]
    s_waitcnt lgkmcnt(0)
    v_mfma_f32_32x32x16_bf16 v[156:171], v[208:211], v[120:123], v[156:171]
    v_mfma_f32_32x32x16_bf16 v[124:139], a[224:227], v[240:243], v[124:139]
    v_mfma_f32_32x32x16_bf16 v[140:155], a[228:231], v[240:243], v[140:155]
    v_mfma_f32_32x32x16_bf16 v[156:171], a[232:235], v[240:243], v[156:171]
    s_add_u32 s46, s74, s96
    s_lshl_b32 s47, s21, 11
    s_sub_u32 s45, s46, s47
    s_add_u32 s45, s45, 57344
    s_add_u32 s47, s47, s73
    s_add_u32 s47, s47, s98
    s_add_u32 s58, s75, 49152
    s_add_u32 s59, s75, 57344
    ds_read_b64_tr_b16 v[188:189], v7 offset:57856
    ds_read_b64_tr_b16 v[190:191], v7 offset:58880
    ds_read_b64_tr_b16 v[192:193], v7 offset:59904
    ds_read_b64_tr_b16 v[194:195], v7 offset:60928
    ds_read_b64_tr_b16 v[196:197], v7 offset:61952
    ds_read_b64_tr_b16 v[198:199], v7 offset:62976
    ds_read_b64_tr_b16 v[200:201], v7 offset:64000
    ds_read_b64_tr_b16 v[202:203], v7 offset:65024
    ds_read_b64_tr_b16 v[204:205], v8 offset:512
    ds_read_b64_tr_b16 v[206:207], v8 offset:1536
    s_waitcnt lgkmcnt(6)
    v_mfma_f32_32x32x16_bf16 v[172:187], v[188:191], v[12:15], 0
    ds_read_b64_tr_b16 v[208:209], v8 offset:2560
    ds_read_b64_tr_b16 v[210:211], v8 offset:3584
    v_mfma_f32_32x32x16_bf16 v[172:187], v[192:195], v[16:19], v[172:187]
    v_mul_f32 v212, v124, v124
    v_mul_f32 v213, v125, v125
    v_mul_f32 v214, v126, v126
    v_mul_f32 v215, v127, v127
    ds_read_b64_tr_b16 v[188:189], v8 offset:4608
    ds_read_b64_tr_b16 v[190:191], v8 offset:5632
    s_waitcnt lgkmcnt(6)
    v_mfma_f32_32x32x16_bf16 v[172:187], v[196:199], v[20:23], v[172:187]
    v_fma_f32 v212, v212, v251, v250
    v_fma_f32 v213, v213, v251, v250
    v_fma_f32 v214, v214, v251, v250
    v_fma_f32 v215, v215, v251, v250
    ds_read_b64_tr_b16 v[192:193], v8 offset:6656
    ds_read_b64_tr_b16 v[194:195], v8 offset:7680
    v_mfma_f32_32x32x16_bf16 v[172:187], v[200:203], v[24:27], v[172:187]
    v_mul_f32 v212, v212, v124
    v_mul_f32 v213, v213, v125
    v_mul_f32 v214, v214, v126
    v_mul_f32 v215, v215, v127
    v_exp_f32 v212, v212
    ds_read_b64_tr_b16 v[196:197], v8 offset:8704
    ds_read_b64_tr_b16 v[198:199], v8 offset:9728
    s_waitcnt lgkmcnt(6)
    v_mfma_f32_32x32x16_bf16 v[172:187], v[204:207], v[28:31], v[172:187]
    v_exp_f32 v213, v213
    v_exp_f32 v214, v214
    v_exp_f32 v215, v215
    v_fma_f32 v212, v212, v247, v247
    ds_read_b64_tr_b16 v[200:201], v8 offset:10752
    ds_read_b64_tr_b16 v[202:203], v8 offset:11776
    v_mfma_f32_32x32x16_bf16 v[172:187], v[208:211], v[32:35], v[172:187]
    v_fma_f32 v213, v213, v247, v247
    v_fma_f32 v214, v214, v247, v247
    v_fma_f32 v215, v215, v247, v247
    v_rcp_f32 v212, v212
    v_rcp_f32 v213, v213
    ds_read_b64_tr_b16 v[204:205], v8 offset:12800
    ds_read_b64_tr_b16 v[206:207], v8 offset:13824
    s_waitcnt lgkmcnt(6)
    v_mfma_f32_32x32x16_bf16 v[172:187], v[188:191], v[36:39], v[172:187]
    v_rcp_f32 v214, v214
    v_rcp_f32 v215, v215
    v_mul_f32 v124, v124, v212
    v_mul_f32 v125, v125, v213
    ds_read_b64_tr_b16 v[208:209], v8 offset:14848
    ds_read_b64_tr_b16 v[210:211], v8 offset:15872
    v_mfma_f32_32x32x16_bf16 v[172:187], v[192:195], v[40:43], v[172:187]
    v_mul_f32 v126, v126, v214
    v_mul_f32 v127, v127, v215
    v_cvt_pk_bf16_f32 v220, v124, v125
    v_cvt_pk_bf16_f32 v221, v126, v127
    ds_read_b64_tr_b16 v[188:189], v8 offset:16896
    ds_read_b64_tr_b16 v[190:191], v8 offset:17920
    s_waitcnt lgkmcnt(6)
    v_mfma_f32_32x32x16_bf16 v[172:187], v[196:199], v[44:47], v[172:187]
    v_mul_f32 v212, v128, v128
    v_mul_f32 v213, v129, v129
    v_mul_f32 v214, v130, v130
    v_mul_f32 v215, v131, v131
    v_fma_f32 v212, v212, v251, v250
    ds_read_b64_tr_b16 v[192:193], v8 offset:18944
    ds_read_b64_tr_b16 v[194:195], v8 offset:19968
    v_mfma_f32_32x32x16_bf16 v[172:187], v[200:203], v[48:51], v[172:187]
    v_fma_f32 v213, v213, v251, v250
    v_fma_f32 v214, v214, v251, v250
    v_fma_f32 v215, v215, v251, v250
    v_mul_f32 v212, v212, v128
    ds_read_b64_tr_b16 v[196:197], v8 offset:20992
    ds_read_b64_tr_b16 v[198:199], v8 offset:22016
    s_waitcnt lgkmcnt(6)
    v_mfma_f32_32x32x16_bf16 v[172:187], v[204:207], v[52:55], v[172:187]
    v_mul_f32 v213, v213, v129
    v_mul_f32 v214, v214, v130
    v_mul_f32 v215, v215, v131
    v_exp_f32 v212, v212
    v_exp_f32 v213, v213
    ds_read_b64_tr_b16 v[200:201], v8 offset:23040
    ds_read_b64_tr_b16 v[202:203], v8 offset:24064
    v_mfma_f32_32x32x16_bf16 v[172:187], v[208:211], v[56:59], v[172:187]
    v_exp_f32 v214, v214
    v_exp_f32 v215, v215
    v_fma_f32 v212, v212, v247, v247
    v_fma_f32 v213, v213, v247, v247
    ds_read_b64_tr_b16 v[204:205], v8 offset:25088
    ds_read_b64_tr_b16 v[206:207], v8 offset:26112
    s_waitcnt lgkmcnt(6)
    v_mfma_f32_32x32x16_bf16 v[172:187], v[188:191], v[60:63], v[172:187]
    v_fma_f32 v214, v214, v247, v247
    v_fma_f32 v215, v215, v247, v247
    v_rcp_f32 v212, v212
    v_rcp_f32 v213, v213
    ds_read_b64_tr_b16 v[208:209], v8 offset:27136
    ds_read_b64_tr_b16 v[210:211], v8 offset:28160
    v_mfma_f32_32x32x16_bf16 v[172:187], v[192:195], v[64:67], v[172:187]
    v_rcp_f32 v214, v214
    v_rcp_f32 v215, v215
    v_mul_f32 v128, v128, v212
    v_mul_f32 v129, v129, v213
    v_mul_f32 v130, v130, v214
    ds_read_b64_tr_b16 v[188:189], v8 offset:29184
    ds_read_b64_tr_b16 v[190:191], v8 offset:30208
    s_waitcnt lgkmcnt(6)
    v_mfma_f32_32x32x16_bf16 v[172:187], v[196:199], v[68:71], v[172:187]
    v_mul_f32 v131, v131, v215
    v_cvt_pk_bf16_f32 v222, v128, v129
    v_cvt_pk_bf16_f32 v223, v130, v131
    v_mul_f32 v212, v132, v132
    ds_read_b64_tr_b16 v[192:193], v8 offset:31232
    ds_read_b64_tr_b16 v[194:195], v8 offset:32256
    v_mfma_f32_32x32x16_bf16 v[172:187], v[200:203], v[72:75], v[172:187]
    v_mul_f32 v213, v133, v133
    v_mul_f32 v214, v134, v134
    v_mul_f32 v215, v135, v135
    v_fma_f32 v212, v212, v251, v250
    v_fma_f32 v213, v213, v251, v250
    ds_read_b64_tr_b16 v[196:197], v8 offset:33280
    ds_read_b64_tr_b16 v[198:199], v8 offset:34304
    s_waitcnt lgkmcnt(6)
    v_mfma_f32_32x32x16_bf16 v[172:187], v[204:207], v[76:79], v[172:187]
    v_fma_f32 v214, v214, v251, v250
    v_fma_f32 v215, v215, v251, v250
    v_mul_f32 v212, v212, v132
    v_mul_f32 v213, v213, v133
    ds_read_b64_tr_b16 v[200:201], v8 offset:35328
    ds_read_b64_tr_b16 v[202:203], v8 offset:36352
    v_mfma_f32_32x32x16_bf16 v[172:187], v[208:211], v[80:83], v[172:187]
    v_mul_f32 v214, v214, v134
    v_mul_f32 v215, v215, v135
    v_exp_f32 v212, v212
    v_exp_f32 v213, v213
    ds_read_b64_tr_b16 v[204:205], v8 offset:37376
    ds_read_b64_tr_b16 v[206:207], v8 offset:38400
    s_waitcnt lgkmcnt(6)
    v_mfma_f32_32x32x16_bf16 v[172:187], v[188:191], v[84:87], v[172:187]
    v_exp_f32 v214, v214
    v_exp_f32 v215, v215
    v_fma_f32 v212, v212, v247, v247
    v_fma_f32 v213, v213, v247, v247
    v_fma_f32 v214, v214, v247, v247
    ds_read_b64_tr_b16 v[208:209], v8 offset:39424
    ds_read_b64_tr_b16 v[210:211], v8 offset:40448
    v_mfma_f32_32x32x16_bf16 v[172:187], v[192:195], v[88:91], v[172:187]
    v_fma_f32 v215, v215, v247, v247
    v_rcp_f32 v212, v212
    v_rcp_f32 v213, v213
    v_rcp_f32 v214, v214
    ds_read_b64_tr_b16 v[188:189], v8 offset:41472
    ds_read_b64_tr_b16 v[190:191], v8 offset:42496
    s_waitcnt lgkmcnt(6)
    v_mfma_f32_32x32x16_bf16 v[172:187], v[196:199], v[92:95], v[172:187]
    v_rcp_f32 v215, v215
    v_mul_f32 v132, v132, v212
    v_mul_f32 v133, v133, v213
    v_mul_f32 v134, v134, v214
    v_mul_f32 v135, v135, v215
    ds_read_b64_tr_b16 v[192:193], v8 offset:43520
    ds_read_b64_tr_b16 v[194:195], v8 offset:44544
    v_mfma_f32_32x32x16_bf16 v[172:187], v[200:203], v[96:99], v[172:187]
    v_cvt_pk_bf16_f32 v224, v132, v133
    v_cvt_pk_bf16_f32 v225, v134, v135
    v_mul_f32 v212, v136, v136
    v_mul_f32 v213, v137, v137
    ds_read_b64_tr_b16 v[196:197], v8 offset:45568
    ds_read_b64_tr_b16 v[198:199], v8 offset:46592
    s_waitcnt lgkmcnt(6)
    v_mfma_f32_32x32x16_bf16 v[172:187], v[204:207], v[100:103], v[172:187]
    v_mul_f32 v214, v138, v138
    v_mul_f32 v215, v139, v139
    v_fma_f32 v212, v212, v251, v250
    v_fma_f32 v213, v213, v251, v250
    ds_read_b64_tr_b16 v[200:201], v8 offset:47616
    ds_read_b64_tr_b16 v[202:203], v8 offset:48640
    v_mfma_f32_32x32x16_bf16 v[172:187], v[208:211], v[104:107], v[172:187]
    v_fma_f32 v214, v214, v251, v250
    v_fma_f32 v215, v215, v251, v250
    v_mul_f32 v212, v212, v136
    v_mul_f32 v213, v213, v137
    v_mul_f32 v214, v214, v138
    s_waitcnt lgkmcnt(4)
    v_mfma_f32_32x32x16_bf16 v[172:187], v[188:191], v[108:111], v[172:187]
    v_mul_f32 v215, v215, v139
    v_exp_f32 v212, v212
    v_exp_f32 v213, v213
    v_exp_f32 v214, v214
    v_mfma_f32_32x32x16_bf16 v[172:187], v[192:195], v[112:115], v[172:187]
    v_exp_f32 v215, v215
    v_fma_f32 v212, v212, v247, v247
    v_fma_f32 v213, v213, v247, v247
    v_fma_f32 v214, v214, v247, v247
    v_fma_f32 v215, v215, v247, v247
    s_waitcnt lgkmcnt(0)
    v_mfma_f32_32x32x16_bf16 v[172:187], v[196:199], v[116:119], v[172:187]
    v_rcp_f32 v212, v212
    v_rcp_f32 v213, v213
    v_rcp_f32 v214, v214
    v_rcp_f32 v215, v215
    v_mfma_f32_32x32x16_bf16 v[172:187], v[200:203], v[120:123], v[172:187]
    v_mul_f32 v136, v136, v212
    v_mul_f32 v137, v137, v213
    v_mul_f32 v138, v138, v214
    v_mul_f32 v139, v139, v215
    v_mfma_f32_32x32x16_bf16 v[172:187], a[236:239], v[240:243], v[172:187]
    v_cvt_pk_bf16_f32 v226, v136, v137
    v_cvt_pk_bf16_f32 v227, v138, v139
    buffer_store_dwordx4 v[220:223], v1, s[4:7], s46 offen offset:0
    buffer_store_dwordx4 v[224:227], v1, s[4:7], s46 offen offset:1024
    v_mov_b32 v188, v250
    v_mov_b32 v189, v250
    v_mov_b32 v190, v251
    v_mov_b32 v191, v251
    v_mov_b32 v192, v247
    v_mov_b32 v193, v247
    v_pk_mul_f32 v[212:213], v[140:141], v[140:141]
    v_pk_mul_f32 v[214:215], v[142:143], v[142:143]
    v_pk_mul_f32 v[216:217], v[144:145], v[144:145]
    v_pk_mul_f32 v[218:219], v[146:147], v[146:147]
    v_pk_fma_f32 v[212:213], v[212:213], v[190:191], v[188:189]
    v_pk_fma_f32 v[214:215], v[214:215], v[190:191], v[188:189]
    v_pk_fma_f32 v[216:217], v[216:217], v[190:191], v[188:189]
    v_pk_fma_f32 v[218:219], v[218:219], v[190:191], v[188:189]
    v_pk_mul_f32 v[212:213], v[212:213], v[140:141]
    v_pk_mul_f32 v[214:215], v[214:215], v[142:143]
    v_pk_mul_f32 v[216:217], v[216:217], v[144:145]
    v_pk_mul_f32 v[218:219], v[218:219], v[146:147]
    v_exp_f32 v212, v212
    v_exp_f32 v213, v213
    v_exp_f32 v214, v214
    v_exp_f32 v215, v215
    v_exp_f32 v216, v216
    v_exp_f32 v217, v217
    v_exp_f32 v218, v218
    v_exp_f32 v219, v219
    v_pk_fma_f32 v[212:213], v[212:213], v[192:193], v[192:193]
    v_pk_fma_f32 v[214:215], v[214:215], v[192:193], v[192:193]
    v_pk_fma_f32 v[216:217], v[216:217], v[192:193], v[192:193]
    v_pk_fma_f32 v[218:219], v[218:219], v[192:193], v[192:193]
    v_rcp_f32 v212, v212
    v_rcp_f32 v213, v213
    v_rcp_f32 v214, v214
    v_rcp_f32 v215, v215
    v_rcp_f32 v216, v216
    v_rcp_f32 v217, v217
    v_rcp_f32 v218, v218
    v_rcp_f32 v219, v219
    v_pk_mul_f32 v[140:141], v[140:141], v[212:213]
    v_pk_mul_f32 v[142:143], v[142:143], v[214:215]
    v_pk_mul_f32 v[144:145], v[144:145], v[216:217]
    v_pk_mul_f32 v[146:147], v[146:147], v[218:219]
    v_cvt_pk_bf16_f32 v228, v140, v141
    v_cvt_pk_bf16_f32 v229, v142, v143
    v_cvt_pk_bf16_f32 v230, v144, v145
    v_cvt_pk_bf16_f32 v231, v146, v147
    v_pk_mul_f32 v[212:213], v[148:149], v[148:149]
    v_pk_mul_f32 v[214:215], v[150:151], v[150:151]
    v_pk_mul_f32 v[216:217], v[152:153], v[152:153]
    v_pk_mul_f32 v[218:219], v[154:155], v[154:155]
    v_pk_fma_f32 v[212:213], v[212:213], v[190:191], v[188:189]
    v_pk_fma_f32 v[214:215], v[214:215], v[190:191], v[188:189]
    v_pk_fma_f32 v[216:217], v[216:217], v[190:191], v[188:189]
    v_pk_fma_f32 v[218:219], v[218:219], v[190:191], v[188:189]
    v_pk_mul_f32 v[212:213], v[212:213], v[148:149]
    v_pk_mul_f32 v[214:215], v[214:215], v[150:151]
    v_pk_mul_f32 v[216:217], v[216:217], v[152:153]
    v_pk_mul_f32 v[218:219], v[218:219], v[154:155]
    v_exp_f32 v212, v212
    v_exp_f32 v213, v213
    v_exp_f32 v214, v214
    v_exp_f32 v215, v215
    v_exp_f32 v216, v216
    v_exp_f32 v217, v217
    v_exp_f32 v218, v218
    v_exp_f32 v219, v219
    v_pk_fma_f32 v[212:213], v[212:213], v[192:193], v[192:193]
    v_pk_fma_f32 v[214:215], v[214:215], v[192:193], v[192:193]
    v_pk_fma_f32 v[216:217], v[216:217], v[192:193], v[192:193]
    v_pk_fma_f32 v[218:219], v[218:219], v[192:193], v[192:193]
    v_rcp_f32 v212, v212
    v_rcp_f32 v213, v213
    v_rcp_f32 v214, v214
    v_rcp_f32 v215, v215
    v_rcp_f32 v216, v216
    v_rcp_f32 v217, v217
    v_rcp_f32 v218, v218
    v_rcp_f32 v219, v219
    v_pk_mul_f32 v[148:149], v[148:149], v[212:213]
    v_pk_mul_f32 v[150:151], v[150:151], v[214:215]
    v_pk_mul_f32 v[152:153], v[152:153], v[216:217]
    v_pk_mul_f32 v[154:155], v[154:155], v[218:219]
    v_cvt_pk_bf16_f32 v232, v148, v149
    v_cvt_pk_bf16_f32 v233, v150, v151
    v_cvt_pk_bf16_f32 v234, v152, v153
    v_cvt_pk_bf16_f32 v235, v154, v155
    buffer_store_dwordx4 v[228:231], v1, s[4:7], s46 offen offset:2048
    buffer_store_dwordx4 v[232:235], v1, s[4:7], s46 offen offset:3072
    v_pk_mul_f32 v[212:213], v[156:157], v[156:157]
    v_pk_mul_f32 v[214:215], v[158:159], v[158:159]
    v_pk_mul_f32 v[216:217], v[160:161], v[160:161]
    v_pk_mul_f32 v[218:219], v[162:163], v[162:163]
    v_pk_fma_f32 v[212:213], v[212:213], v[190:191], v[188:189]
    v_pk_fma_f32 v[214:215], v[214:215], v[190:191], v[188:189]
    v_pk_fma_f32 v[216:217], v[216:217], v[190:191], v[188:189]
    v_pk_fma_f32 v[218:219], v[218:219], v[190:191], v[188:189]
    v_pk_mul_f32 v[212:213], v[212:213], v[156:157]
    v_pk_mul_f32 v[214:215], v[214:215], v[158:159]
    v_pk_mul_f32 v[216:217], v[216:217], v[160:161]
    v_pk_mul_f32 v[218:219], v[218:219], v[162:163]
    v_exp_f32 v212, v212
    v_exp_f32 v213, v213
    v_exp_f32 v214, v214
    v_exp_f32 v215, v215
    v_exp_f32 v216, v216
    v_exp_f32 v217, v217
    v_exp_f32 v218, v218
    v_exp_f32 v219, v219
    v_pk_fma_f32 v[212:213], v[212:213], v[192:193], v[192:193]
    v_pk_fma_f32 v[214:215], v[214:215], v[192:193], v[192:193]
    v_pk_fma_f32 v[216:217], v[216:217], v[192:193], v[192:193]
    v_pk_fma_f32 v[218:219], v[218:219], v[192:193], v[192:193]
    v_rcp_f32 v212, v212
    v_rcp_f32 v213, v213
    v_rcp_f32 v214, v214
    v_rcp_f32 v215, v215
    v_rcp_f32 v216, v216
    v_rcp_f32 v217, v217
    v_rcp_f32 v218, v218
    v_rcp_f32 v219, v219
    v_pk_mul_f32 v[156:157], v[156:157], v[212:213]
    v_pk_mul_f32 v[158:159], v[158:159], v[214:215]
    v_pk_mul_f32 v[160:161], v[160:161], v[216:217]
    v_pk_mul_f32 v[162:163], v[162:163], v[218:219]
    s_waitcnt vmcnt(0)
    s_mov_b64 exec, 1
    s_cmp_eq_u32 s19, 0
    s_cbranch_scc0 pubs_60
    buffer_store_dword v10, v6, s[4:7], s58 offen
    s_branch pubd_61
pubs_60:
    buffer_wbl2 sc1
    s_waitcnt vmcnt(0)
    buffer_store_dword v10, v6, s[4:7], s58 offen sc1
pubd_61:
    s_mov_b64 exec, -1
    s_nop 0
    v_cvt_pk_bf16_f32 v220, v156, v157
    v_cvt_pk_bf16_f32 v221, v158, v159
    v_cvt_pk_bf16_f32 v222, v160, v161
    v_cvt_pk_bf16_f32 v223, v162, v163
    v_pk_mul_f32 v[212:213], v[164:165], v[164:165]
    v_pk_mul_f32 v[214:215], v[166:167], v[166:167]
    v_pk_mul_f32 v[216:217], v[168:169], v[168:169]
    v_pk_mul_f32 v[218:219], v[170:171], v[170:171]
    v_pk_fma_f32 v[212:213], v[212:213], v[190:191], v[188:189]
    v_pk_fma_f32 v[214:215], v[214:215], v[190:191], v[188:189]
    v_pk_fma_f32 v[216:217], v[216:217], v[190:191], v[188:189]
    v_pk_fma_f32 v[218:219], v[218:219], v[190:191], v[188:189]
    v_pk_mul_f32 v[212:213], v[212:213], v[164:165]
    v_pk_mul_f32 v[214:215], v[214:215], v[166:167]
    v_pk_mul_f32 v[216:217], v[216:217], v[168:169]
    v_pk_mul_f32 v[218:219], v[218:219], v[170:171]
    v_exp_f32 v212, v212
    v_exp_f32 v213, v213
    v_exp_f32 v214, v214
    v_exp_f32 v215, v215
    v_exp_f32 v216, v216
    v_exp_f32 v217, v217
    v_exp_f32 v218, v218
    v_exp_f32 v219, v219
    v_pk_fma_f32 v[212:213], v[212:213], v[192:193], v[192:193]
    v_pk_fma_f32 v[214:215], v[214:215], v[192:193], v[192:193]
    v_pk_fma_f32 v[216:217], v[216:217], v[192:193], v[192:193]
    v_pk_fma_f32 v[218:219], v[218:219], v[192:193], v[192:193]
    v_rcp_f32 v212, v212
    v_rcp_f32 v213, v213
    v_rcp_f32 v214, v214
    v_rcp_f32 v215, v215
    v_rcp_f32 v216, v216
    v_rcp_f32 v217, v217
    v_rcp_f32 v218, v218
    v_rcp_f32 v219, v219
    v_pk_mul_f32 v[164:165], v[164:165], v[212:213]
    v_pk_mul_f32 v[166:167], v[166:167], v[214:215]
    v_pk_mul_f32 v[168:169], v[168:169], v[216:217]
    v_pk_mul_f32 v[170:171], v[170:171], v[218:219]
    v_cvt_pk_bf16_f32 v224, v164, v165
    v_cvt_pk_bf16_f32 v225, v166, v167
    v_cvt_pk_bf16_f32 v226, v168, v169
    v_cvt_pk_bf16_f32 v227, v170, v171
    buffer_store_dwordx4 v[220:223], v1, s[4:7], s45 offen offset:0
    buffer_store_dwordx4 v[224:227], v1, s[4:7], s45 offen offset:1024
    s_waitcnt lgkmcnt(0)
    s_barrier
    v_bfe_u32 v11, v0, 4, 1
    v_lshl_add_u32 v5, v11, 7, v5
    s_add_u32 s42, s86, 49152
    s_add_u32 s48, s84, s89
poll_62:
    s_add_u32 s50, s50, 1
    s_cmp_gt_u32 s50, 0x40000
    s_cbranch_scc1 pollx_63
    buffer_load_dword v9, v5, s[4:7], s42 offen sc1
    s_waitcnt vmcnt(0)
    v_cmp_eq_u32 vcc, 1, v9
    s_nop 0
    s_and_b32 s51, vcc_lo, 0x3fff3fff
    s_cmp_eq_u32 s51, 0x3fff3fff
    s_cbranch_scc0 poll_62
pollx_63:
    s_cmp_eq_u32 s19, 0
    s_cbranch_scc1 acq_64
    buffer_inv sc1
    s_waitcnt vmcnt(0)
acq_64:
    s_add_u32 s41, s48, 0
    buffer_load_dwordx4 v[140:143], v1, s[4:7], s41 offen sc1
    s_add_u32 s41, s48, 1024
    buffer_load_dwordx4 v[144:147], v1, s[4:7], s41 offen sc1
    s_add_u32 s42, s86, 57344
    s_add_u32 s43, s80, s96
    s_add_u32 s44, s81, s96
    s_add_u32 s52, s43, 57344
    s_add_u32 s53, s44, 57344
    s_add_u32 s54, s99, s98
    s_add_u32 s55, s100, s98
    s_cmp_lt_u32 s3, 2
    s_cselect_b32 s52, s52, s54
    s_cselect_b32 s53, s53, s55
    s_add_u32 s41, s43, 0
    buffer_load_dwordx4 v[12:15], v1, s[4:7], s41 offen sc1
    s_add_u32 s41, s44, 0
    buffer_load_dwordx4 v[16:19], v1, s[4:7], s41 offen sc1
    s_add_u32 s41, s43, 4096
    buffer_load_dwordx4 v[20:23], v1, s[4:7], s41 offen sc1
    s_add_u32 s41, s44, 4096
    buffer_load_dwordx4 v[24:27], v1, s[4:7], s41 offen sc1
    s_add_u32 s41, s43, 8192
    buffer_load_dwordx4 v[28:31], v1, s[4:7], s41 offen sc1
    s_add_u32 s41, s44, 8192
    buffer_load_dwordx4 v[32:35], v1, s[4:7], s41 offen sc1
    v_cmp_eq_u32 vcc, 0, v3
    v_mov_b32 v152, 0x3f80
    s_nop 0
    v_cndmask_b32 v148, 0, v253, vcc
    v_mov_b32 v149, 0
    v_mov_b32 v150, 0
    v_mov_b32 v151, 0
    v_mov_b32 v153, 0
    v_mov_b32 v154, 0
    v_mov_b32 v155, 0
    v_pk_mul_f32 v[212:213], v[172:173], v[172:173]
    v_pk_mul_f32 v[214:215], v[174:175], v[174:175]
    v_pk_mul_f32 v[216:217], v[176:177], v[176:177]
    v_pk_mul_f32 v[218:219], v[178:179], v[178:179]
    v_pk_fma_f32 v[212:213], v[212:213], v[190:191], v[188:189]
    v_pk_fma_f32 v[214:215], v[214:215], v[190:191], v[188:189]
    s_add_u32 s41, s43, 12288
    buffer_load_dwordx4 v[36:39], v1, s[4:7], s41 offen sc1
    v_pk_fma_f32 v[216:217], v[216:217], v[190:191], v[188:189]
    v_pk_fma_f32 v[218:219], v[218:219], v[190:191], v[188:189]
    v_pk_mul_f32 v[212:213], v[212:213], v[172:173]
    v_pk_mul_f32 v[214:215], v[214:215], v[174:175]
    v_pk_mul_f32 v[216:217], v[216:217], v[176:177]
    v_pk_mul_f32 v[218:219], v[218:219], v[178:179]
    s_add_u32 s41, s44, 12288
    buffer_load_dwordx4 v[40:43], v1, s[4:7], s41 offen sc1
    v_exp_f32 v212, v212
    v_exp_f32 v213, v213
    v_exp_f32 v214, v214
    v_exp_f32 v215, v215
    v_exp_f32 v216, v216
    v_exp_f32 v217, v217
    s_add_u32 s41, s43, 16384
    buffer_load_dwordx4 v[44:47], v1, s[4:7], s41 offen sc1
    v_exp_f32 v218, v218
    v_exp_f32 v219, v219
    v_pk_fma_f32 v[212:213], v[212:213], v[192:193], v[192:193]
    v_pk_fma_f32 v[214:215], v[214:215], v[192:193], v[192:193]
    v_pk_fma_f32 v[216:217], v[216:217], v[192:193], v[192:193]
    v_pk_fma_f32 v[218:219], v[218:219], v[192:193], v[192:193]
    s_add_u32 s41, s44, 16384
    buffer_load_dwordx4 v[48:51], v1, s[4:7], s41 offen sc1
    v_rcp_f32 v212, v212
    v_rcp_f32 v213, v213
    v_rcp_f32 v214, v214
    v_rcp_f32 v215, v215
    v_rcp_f32 v216, v216
    v_rcp_f32 v217, v217
    s_add_u32 s41, s43, 20480
    buffer_load_dwordx4 v[52:55], v1, s[4:7], s41 offen sc1
    v_rcp_f32 v218, v218
    v_rcp_f32 v219, v219
    v_pk_mul_f32 v[172:173], v[172:173], v[212:213]
    v_pk_mul_f32 v[174:175], v[174:175], v[214:215]
    v_pk_mul_f32 v[176:177], v[176:177], v[216:217]
    v_pk_mul_f32 v[178:179], v[178:179], v[218:219]
    s_add_u32 s41, s44, 20480
    buffer_load_dwordx4 v[56:59], v1, s[4:7], s41 offen sc1
    v_cvt_pk_bf16_f32 v228, v172, v173
    v_cvt_pk_bf16_f32 v229, v174, v175
    v_cvt_pk_bf16_f32 v230, v176, v177
    v_cvt_pk_bf16_f32 v231, v178, v179
    v_pk_mul_f32 v[212:213], v[180:181], v[180:181]
    v_pk_mul_f32 v[214:215], v[182:183], v[182:183]
    v_pk_mul_f32 v[216:217], v[184:185], v[184:185]
    v_pk_mul_f32 v[218:219], v[186:187], v[186:187]
    v_pk_fma_f32 v[212:213], v[212:213], v[190:191], v[188:189]
    v_pk_fma_f32 v[214:215], v[214:215], v[190:191], v[188:189]
    v_pk_fma_f32 v[216:217], v[216:217], v[190:191], v[188:189]
    v_pk_fma_f32 v[218:219], v[218:219], v[190:191], v[188:189]
    v_pk_mul_f32 v[212:213], v[212:213], v[180:181]
    v_pk_mul_f32 v[214:215], v[214:215], v[182:183]
    v_pk_mul_f32 v[216:217], v[216:217], v[184:185]
    v_pk_mul_f32 v[218:219], v[218:219], v[186:187]
    v_exp_f32 v212, v212
    v_exp_f32 v213, v213
    v_exp_f32 v214, v214
    v_exp_f32 v215, v215
    v_exp_f32 v216, v216
    v_exp_f32 v217, v217
    v_exp_f32 v218, v218
    v_exp_f32 v219, v219
    v_pk_fma_f32 v[212:213], v[212:213], v[192:193], v[192:193]
    v_pk_fma_f32 v[214:215], v[214:215], v[192:193], v[192:193]
    v_pk_fma_f32 v[216:217], v[216:217], v[192:193], v[192:193]
    v_pk_fma_f32 v[218:219], v[218:219], v[192:193], v[192:193]
    v_rcp_f32 v212, v212
    v_rcp_f32 v213, v213
    v_rcp_f32 v214, v214
    v_rcp_f32 v215, v215
    v_rcp_f32 v216, v216
    v_rcp_f32 v217, v217
    v_rcp_f32 v218, v218
    v_rcp_f32 v219, v219
    v_pk_mul_f32 v[180:181], v[180:181], v[212:213]
    v_pk_mul_f32 v[182:183], v[182:183], v[214:215]
    v_pk_mul_f32 v[184:185], v[184:185], v[216:217]
    v_pk_mul_f32 v[186:187], v[186:187], v[218:219]
    v_cvt_pk_bf16_f32 v232, v180, v181
    v_cvt_pk_bf16_f32 v233, v182, v183
    v_cvt_pk_bf16_f32 v234, v184, v185
    v_cvt_pk_bf16_f32 v235, v186, v187
    buffer_store_dwordx4 v[228:231], v1, s[4:7], s47 offen offset:0
    buffer_store_dwordx4 v[232:235], v1, s[4:7], s47 offen offset:1024
    s_waitcnt vmcnt(14)
    v_lshlrev_b32 v76, 16, v140
    v_and_b32 v77, 0xffff0000, v140
    v_lshlrev_b32 v78, 16, v141
    v_and_b32 v79, 0xffff0000, v141
    v_lshlrev_b32 v80, 16, v142
    v_and_b32 v81, 0xffff0000, v142
    v_lshlrev_b32 v82, 16, v143
    v_and_b32 v83, 0xffff0000, v143
    v_lshlrev_b32 v84, 16, v144
    v_and_b32 v85, 0xffff0000, v144
    v_lshlrev_b32 v86, 16, v145
    v_and_b32 v87, 0xffff0000, v145
    v_lshlrev_b32 v88, 16, v146
    v_and_b32 v89, 0xffff0000, v146
    v_lshlrev_b32 v90, 16, v147
    v_and_b32 v91, 0xffff0000, v147
    s_nop 1
    v_mfma_f32_32x32x16_bf16 v[76:91], v[148:151], v[152:155], v[76:91]
    s_waitcnt vmcnt(12)
    v_mfma_f32_32x32x16_bf16 v[76:91], a[0:3], v[12:15], v[76:91]
    v_mfma_f32_32x32x16_bf16 v[92:107], a[112:115], v[12:15], 0
    s_add_u32 s41, s43, 24576
    buffer_load_dwordx4 v[60:63], v1, s[4:7], s41 offen sc1
    v_mfma_f32_32x32x16_bf16 v[108:123], a[0:3], v[16:19], 0
    v_mfma_f32_32x32x16_bf16 v[124:139], a[112:115], v[16:19], 0
    s_add_u32 s41, s44, 24576
    buffer_load_dwordx4 v[64:67], v1, s[4:7], s41 offen sc1
    s_waitcnt vmcnt(12)
    v_mfma_f32_32x32x16_bf16 v[76:91], a[4:7], v[20:23], v[76:91]
    v_mfma_f32_32x32x16_bf16 v[92:107], a[116:119], v[20:23], v[92:107]
    s_add_u32 s41, s43, 28672
    buffer_load_dwordx4 v[68:71], v1, s[4:7], s41 offen sc1
    v_mfma_f32_32x32x16_bf16 v[108:123], a[4:7], v[24:27], v[108:123]
    v_mfma_f32_32x32x16_bf16 v[124:139], a[116:119], v[24:27], v[124:139]
    s_add_u32 s41, s44, 28672
    buffer_load_dwordx4 v[72:75], v1, s[4:7], s41 offen sc1
    s_waitcnt vmcnt(4)
    s_mov_b64 exec, 1
    s_cmp_eq_u32 s19, 0
    s_cbranch_scc0 pubs_65
    buffer_store_dword v10, v6, s[4:7], s59 offen
    s_branch pubd_66
pubs_65:
    buffer_wbl2 sc1
    s_waitcnt vmcnt(0)
    buffer_store_dword v10, v6, s[4:7], s59 offen sc1
pubd_66:
    s_mov_b64 exec, -1
    s_nop 0
    v_mfma_f32_32x32x16_bf16 v[76:91], a[8:11], v[28:31], v[76:91]
    v_mfma_f32_32x32x16_bf16 v[92:107], a[120:123], v[28:31], v[92:107]
    s_add_u32 s41, s43, 32768
    buffer_load_dwordx4 v[12:15], v1, s[4:7], s41 offen sc1
    v_mfma_f32_32x32x16_bf16 v[108:123], a[8:11], v[32:35], v[108:123]
    v_mfma_f32_32x32x16_bf16 v[124:139], a[120:123], v[32:35], v[124:139]
    s_add_u32 s41, s44, 32768
    buffer_load_dwordx4 v[16:19], v1, s[4:7], s41 offen sc1
    v_mfma_f32_32x32x16_bf16 v[76:91], a[12:15], v[36:39], v[76:91]
    v_mfma_f32_32x32x16_bf16 v[92:107], a[124:127], v[36:39], v[92:107]
    s_add_u32 s41, s43, 36864
    buffer_load_dwordx4 v[20:23], v1, s[4:7], s41 offen sc1
    v_mfma_f32_32x32x16_bf16 v[108:123], a[12:15], v[40:43], v[108:123]
    v_mfma_f32_32x32x16_bf16 v[124:139], a[124:127], v[40:43], v[124:139]
    s_add_u32 s41, s44, 36864
    buffer_load_dwordx4 v[24:27], v1, s[4:7], s41 offen sc1
    v_mfma_f32_32x32x16_bf16 v[76:91], a[16:19], v[44:47], v[76:91]
    v_mfma_f32_32x32x16_bf16 v[92:107], a[128:131], v[44:47], v[92:107]
    s_add_u32 s41, s43, 40960
    buffer_load_dwordx4 v[28:31], v1, s[4:7], s41 offen sc1
    v_mfma_f32_32x32x16_bf16 v[108:123], a[16:19], v[48:51], v[108:123]
    v_mfma_f32_32x32x16_bf16 v[124:139], a[128:131], v[48:51], v[124:139]
    s_add_u32 s41, s44, 40960
    buffer_load_dwordx4 v[32:35], v1, s[4:7], s41 offen sc1
    v_mfma_f32_32x32x16_bf16 v[76:91], a[20:23], v[52:55], v[76:91]
    v_mfma_f32_32x32x16_bf16 v[92:107], a[132:135], v[52:55], v[92:107]
    s_add_u32 s41, s43, 45056
    buffer_load_dwordx4 v[36:39], v1, s[4:7], s41 offen sc1
    v_mfma_f32_32x32x16_bf16 v[108:123], a[20:23], v[56:59], v[108:123]
    v_mfma_f32_32x32x16_bf16 v[124:139], a[132:135], v[56:59], v[124:139]
    s_add_u32 s41, s44, 45056
    buffer_load_dwordx4 v[40:43], v1, s[4:7], s41 offen sc1
    s_waitcnt vmcnt(11)
    v_mfma_f32_32x32x16_bf16 v[76:91], a[24:27], v[60:63], v[76:91]
    v_mfma_f32_32x32x16_bf16 v[92:107], a[136:139], v[60:63], v[92:107]
    s_add_u32 s41, s43, 49152
    buffer_load_dwordx4 v[44:47], v1, s[4:7], s41 offen sc1
    v_mfma_f32_32x32x16_bf16 v[108:123], a[24:27], v[64:67], v[108:123]
    v_mfma_f32_32x32x16_bf16 v[124:139], a[136:139], v[64:67], v[124:139]
    s_add_u32 s41, s44, 49152
    buffer_load_dwordx4 v[48:51], v1, s[4:7], s41 offen sc1
    s_waitcnt vmcnt(11)
    v_mfma_f32_32x32x16_bf16 v[76:91], a[28:31], v[68:71], v[76:91]
    v_mfma_f32_32x32x16_bf16 v[92:107], a[140:143], v[68:71], v[92:107]
    s_add_u32 s41, s43, 53248
    buffer_load_dwordx4 v[52:55], v1, s[4:7], s41 offen sc1
    v_mfma_f32_32x32x16_bf16 v[108:123], a[28:31], v[72:75], v[108:123]
    v_mfma_f32_32x32x16_bf16 v[124:139], a[140:143], v[72:75], v[124:139]
    s_add_u32 s41, s44, 53248
    buffer_load_dwordx4 v[56:59], v1, s[4:7], s41 offen sc1
    s_waitcnt vmcnt(10)
    v_mfma_f32_32x32x16_bf16 v[76:91], a[32:35], v[12:15], v[76:91]
    v_mfma_f32_32x32x16_bf16 v[92:107], a[144:147], v[12:15], v[92:107]
    v_mfma_f32_32x32x16_bf16 v[108:123], a[32:35], v[16:19], v[108:123]
    v_mfma_f32_32x32x16_bf16 v[124:139], a[144:147], v[16:19], v[124:139]
    s_waitcnt vmcnt(8)
    v_mfma_f32_32x32x16_bf16 v[76:91], a[36:39], v[20:23], v[76:91]
    v_mfma_f32_32x32x16_bf16 v[92:107], a[148:151], v[20:23], v[92:107]
    v_mfma_f32_32x32x16_bf16 v[108:123], a[36:39], v[24:27], v[108:123]
    v_mfma_f32_32x32x16_bf16 v[124:139], a[148:151], v[24:27], v[124:139]
    buffer_load_dword v9, v5, s[4:7], s42 offen sc1
    s_waitcnt vmcnt(7)
    v_mfma_f32_32x32x16_bf16 v[76:91], a[40:43], v[28:31], v[76:91]
    v_mfma_f32_32x32x16_bf16 v[92:107], a[152:155], v[28:31], v[92:107]
    v_mfma_f32_32x32x16_bf16 v[108:123], a[40:43], v[32:35], v[108:123]
    v_mfma_f32_32x32x16_bf16 v[124:139], a[152:155], v[32:35], v[124:139]
    s_waitcnt vmcnt(0)
    s_branch hbc_68
hbp_67:
    s_add_u32 s50, s50, 1
    s_cmp_gt_u32 s50, 0x40000
    s_cbranch_scc1 hbx_69
    buffer_load_dword v9, v5, s[4:7], s42 offen sc1
    s_waitcnt vmcnt(0)
hbc_68:
    v_cmp_eq_u32 vcc, 1, v9
    s_nop 0
    s_and_b32 s51, vcc_lo, 0x3fff3fff
    s_cmp_eq_u32 s51, 0x3fff3fff
    s_cbranch_scc0 hbp_67
hbx_69:
    s_cmp_eq_u32 s19, 0
    s_cbranch_scc1 hba_70
    buffer_inv sc1
    s_waitcnt vmcnt(0)
hba_70:
    v_and_b32 v5, 63, v5
    s_add_u32 s41, s52, 0
    buffer_load_dwordx4 v[60:63], v1, s[4:7], s41 offen sc1
    s_add_u32 s41, s53, 0
    buffer_load_dwordx4 v[64:67], v1, s[4:7], s41 offen sc1
    s_add_u32 s41, s52, 2048
    buffer_load_dwordx4 v[68:71], v1, s[4:7], s41 offen sc1
    s_add_u32 s41, s53, 2048
    buffer_load_dwordx4 v[72:75], v1, s[4:7], s41 offen sc1
    s_add_u32 s41, s52, 4096
    buffer_load_dwordx4 v[12:15], v1, s[4:7], s41 offen sc1
    s_add_u32 s41, s53, 4096
    buffer_load_dwordx4 v[16:19], v1, s[4:7], s41 offen sc1
    s_xor_b32 s40, s3, 1
    s_mul_i32 s41, s40, 12288
    s_add_u32 s41, s41, 81920
    v_add_u32 v213, s41, v1
    s_xor_b32 s40, s3, 2
    s_mul_i32 s41, s40, 12288
    s_add_u32 s41, s41, 86016
    v_add_u32 v214, s41, v1
    s_xor_b32 s40, s3, 3
    s_mul_i32 s41, s40, 12288
    s_add_u32 s41, s41, 90112
    v_add_u32 v215, s41, v1
    v_mfma_f32_32x32x16_bf16 v[76:91], a[44:47], v[36:39], v[76:91]
    v_mfma_f32_32x32x16_bf16 v[92:107], a[156:159], v[36:39], v[92:107]
    s_add_u32 s41, s52, 6144
    buffer_load_dwordx4 v[20:23], v1, s[4:7], s41 offen sc1
    v_mfma_f32_32x32x16_bf16 v[108:123], a[44:47], v[40:43], v[108:123]
    v_mfma_f32_32x32x16_bf16 v[124:139], a[156:159], v[40:43], v[124:139]
    s_add_u32 s41, s53, 6144
    buffer_load_dwordx4 v[24:27], v1, s[4:7], s41 offen sc1
    v_mfma_f32_32x32x16_bf16 v[76:91], a[48:51], v[44:47], v[76:91]
    v_mfma_f32_32x32x16_bf16 v[92:107], a[160:163], v[44:47], v[92:107]
    s_add_u32 s41, s52, 8192
    buffer_load_dwordx4 v[28:31], v1, s[4:7], s41 offen sc1
    v_mfma_f32_32x32x16_bf16 v[108:123], a[48:51], v[48:51], v[108:123]
    v_mfma_f32_32x32x16_bf16 v[124:139], a[160:163], v[48:51], v[124:139]
    s_add_u32 s41, s53, 8192
    buffer_load_dwordx4 v[32:35], v1, s[4:7], s41 offen sc1
    v_mfma_f32_32x32x16_bf16 v[76:91], a[52:55], v[52:55], v[76:91]
    v_mfma_f32_32x32x16_bf16 v[92:107], a[164:167], v[52:55], v[92:107]
    s_add_u32 s41, s52, 10240
    buffer_load_dwordx4 v[36:39], v1, s[4:7], s41 offen sc1
    v_mfma_f32_32x32x16_bf16 v[108:123], a[52:55], v[56:59], v[108:123]
    v_mfma_f32_32x32x16_bf16 v[124:139], a[164:167], v[56:59], v[124:139]
    s_add_u32 s41, s53, 10240
    buffer_load_dwordx4 v[40:43], v1, s[4:7], s41 offen sc1
    s_waitcnt vmcnt(10)
    v_mfma_f32_32x32x16_bf16 v[76:91], a[56:59], v[60:63], v[76:91]
    v_mfma_f32_32x32x16_bf16 v[92:107], a[168:171], v[60:63], v[92:107]
    s_add_u32 s41, s52, 12288
    buffer_load_dwordx4 v[44:47], v1, s[4:7], s41 offen sc1
    v_mfma_f32_32x32x16_bf16 v[108:123], a[56:59], v[64:67], v[108:123]
    v_mfma_f32_32x32x16_bf16 v[124:139], a[168:171], v[64:67], v[124:139]
    s_add_u32 s41, s53, 12288
    buffer_load_dwordx4 v[48:51], v1, s[4:7], s41 offen sc1
    s_waitcnt vmcnt(10)
    v_mfma_f32_32x32x16_bf16 v[76:91], a[60:63], v[68:71], v[76:91]
    v_mfma_f32_32x32x16_bf16 v[92:107], a[172:175], v[68:71], v[92:107]
    s_add_u32 s41, s52, 14336
    buffer_load_dwordx4 v[52:55], v1, s[4:7], s41 offen sc1
    v_mfma_f32_32x32x16_bf16 v[108:123], a[60:63], v[72:75], v[108:123]
    v_mfma_f32_32x32x16_bf16 v[124:139], a[172:175], v[72:75], v[124:139]
    s_add_u32 s41, s53, 14336
    buffer_load_dwordx4 v[56:59], v1, s[4:7], s41 offen sc1
    s_waitcnt vmcnt(10)
    v_mfma_f32_32x32x16_bf16 v[76:91], a[64:67], v[12:15], v[76:91]
    v_mfma_f32_32x32x16_bf16 v[92:107], a[176:179], v[12:15], v[92:107]
    s_add_u32 s41, s52, 16384
    buffer_load_dwordx4 v[60:63], v1, s[4:7], s41 offen sc1
    v_mfma_f32_32x32x16_bf16 v[108:123], a[64:67], v[16:19], v[108:123]
    v_mfma_f32_32x32x16_bf16 v[124:139], a[176:179], v[16:19], v[124:139]
    s_add_u32 s41, s53, 16384
    buffer_load_dwordx4 v[64:67], v1, s[4:7], s41 offen sc1
    s_waitcnt vmcnt(10)
    v_mfma_f32_32x32x16_bf16 v[76:91], a[68:71], v[20:23], v[76:91]
    v_mfma_f32_32x32x16_bf16 v[92:107], a[180:183], v[20:23], v[92:107]
    s_add_u32 s41, s52, 18432
    buffer_load_dwordx4 v[68:71], v1, s[4:7], s41 offen sc1
    v_mfma_f32_32x32x16_bf16 v[108:123], a[68:71], v[24:27], v[108:123]
    v_mfma_f32_32x32x16_bf16 v[124:139], a[180:183], v[24:27], v[124:139]
    s_add_u32 s41, s53, 18432
    buffer_load_dwordx4 v[72:75], v1, s[4:7], s41 offen sc1
    s_waitcnt vmcnt(10)
    v_mfma_f32_32x32x16_bf16 v[76:91], a[72:75], v[28:31], v[76:91]
    v_mfma_f32_32x32x16_bf16 v[92:107], a[184:187], v[28:31], v[92:107]
    s_add_u32 s41, s52, 20480
    buffer_load_dwordx4 v[12:15], v1, s[4:7], s41 offen sc1
    v_mfma_f32_32x32x16_bf16 v[108:123], a[72:75], v[32:35], v[108:123]
    v_mfma_f32_32x32x16_bf16 v[124:139], a[184:187], v[32:35], v[124:139]
    s_add_u32 s41, s53, 20480
    buffer_load_dwordx4 v[16:19], v1, s[4:7], s41 offen sc1
    s_waitcnt vmcnt(10)
    v_mfma_f32_32x32x16_bf16 v[76:91], a[76:79], v[36:39], v[76:91]
    v_mfma_f32_32x32x16_bf16 v[92:107], a[188:191], v[36:39], v[92:107]
    s_add_u32 s41, s52, 22528
    buffer_load_dwordx4 v[20:23], v1, s[4:7], s41 offen sc1
    v_mfma_f32_32x32x16_bf16 v[108:123], a[76:79], v[40:43], v[108:123]
    v_mfma_f32_32x32x16_bf16 v[124:139], a[188:191], v[40:43], v[124:139]
    s_add_u32 s41, s53, 22528
    buffer_load_dwordx4 v[24:27], v1, s[4:7], s41 offen sc1
    s_waitcnt vmcnt(10)
    v_mfma_f32_32x32x16_bf16 v[92:107], a[192:195], v[44:47], v[92:107]
    v_mfma_f32_32x32x16_bf16 v[108:123], a[80:83], v[48:51], v[108:123]
    s_add_u32 s41, s52, 24576
    buffer_load_dwordx4 v[28:31], v1, s[4:7], s41 offen sc1
    v_mfma_f32_32x32x16_bf16 v[124:139], a[192:195], v[48:51], v[124:139]
    s_add_u32 s41, s53, 24576
    buffer_load_dwordx4 v[32:35], v1, s[4:7], s41 offen sc1
    s_waitcnt vmcnt(10)
    v_mfma_f32_32x32x16_bf16 v[92:107], a[196:199], v[52:55], v[92:107]
    v_mfma_f32_32x32x16_bf16 v[108:123], a[84:87], v[56:59], v[108:123]
    s_add_u32 s41, s52, 26624
    buffer_load_dwordx4 v[36:39], v1, s[4:7], s41 offen sc1
    v_mfma_f32_32x32x16_bf16 v[124:139], a[196:199], v[56:59], v[124:139]
    s_add_u32 s41, s53, 26624
    buffer_load_dwordx4 v[40:43], v1, s[4:7], s41 offen sc1
    s_waitcnt vmcnt(10)
    v_mfma_f32_32x32x16_bf16 v[92:107], a[200:203], v[60:63], v[92:107]
    v_mfma_f32_32x32x16_bf16 v[108:123], a[88:91], v[64:67], v[108:123]
    v_mfma_f32_32x32x16_bf16 v[124:139], a[200:203], v[64:67], v[124:139]
    s_waitcnt vmcnt(8)
    v_mfma_f32_32x32x16_bf16 v[92:107], a[204:207], v[68:71], v[92:107]
    v_mfma_f32_32x32x16_bf16 v[108:123], a[92:95], v[72:75], v[108:123]
    v_mfma_f32_32x32x16_bf16 v[124:139], a[204:207], v[72:75], v[124:139]
    s_waitcnt vmcnt(6)
    v_mfma_f32_32x32x16_bf16 v[92:107], a[208:211], v[12:15], v[92:107]
    v_mfma_f32_32x32x16_bf16 v[108:123], a[96:99], v[16:19], v[108:123]
    v_mfma_f32_32x32x16_bf16 v[124:139], a[208:211], v[16:19], v[124:139]
    s_waitcnt vmcnt(4)
    v_mfma_f32_32x32x16_bf16 v[92:107], a[212:215], v[20:23], v[92:107]
    v_mfma_f32_32x32x16_bf16 v[108:123], a[100:103], v[24:27], v[108:123]
    v_mfma_f32_32x32x16_bf16 v[124:139], a[212:215], v[24:27], v[124:139]
    s_waitcnt vmcnt(2)
    v_mfma_f32_32x32x16_bf16 v[92:107], a[216:219], v[28:31], v[92:107]
    v_mfma_f32_32x32x16_bf16 v[108:123], a[104:107], v[32:35], v[108:123]
    v_mfma_f32_32x32x16_bf16 v[124:139], a[216:219], v[32:35], v[124:139]
    s_waitcnt vmcnt(0)
    v_mfma_f32_32x32x16_bf16 v[92:107], a[220:223], v[36:39], v[92:107]
    v_mfma_f32_32x32x16_bf16 v[108:123], a[108:111], v[40:43], v[108:123]
    v_mfma_f32_32x32x16_bf16 v[124:139], a[220:223], v[40:43], v[124:139]
    v_mfma_f32_32x32x16_bf16 v[76:91], a[80:83], v[44:47], v[76:91]
    v_mfma_f32_32x32x16_bf16 v[76:91], a[84:87], v[52:55], v[76:91]
    v_mfma_f32_32x32x16_bf16 v[76:91], a[88:91], v[60:63], v[76:91]
    s_nop 6
    ds_write_b128 v213, v[92:95] offset:0
    ds_write_b128 v213, v[96:99] offset:1024
    v_mfma_f32_32x32x16_bf16 v[76:91], a[92:95], v[68:71], v[76:91]
    ds_write_b128 v213, v[100:103] offset:2048
    ds_write_b128 v213, v[104:107] offset:3072
    v_mfma_f32_32x32x16_bf16 v[76:91], a[96:99], v[12:15], v[76:91]
    ds_write_b128 v214, v[108:111] offset:0
    ds_write_b128 v214, v[112:115] offset:1024
    v_mfma_f32_32x32x16_bf16 v[76:91], a[100:103], v[20:23], v[76:91]
    ds_write_b128 v214, v[116:119] offset:2048
    ds_write_b128 v214, v[120:123] offset:3072
    v_mfma_f32_32x32x16_bf16 v[76:91], a[104:107], v[28:31], v[76:91]
    ds_write_b128 v215, v[124:127] offset:0
    ds_write_b128 v215, v[128:131] offset:1024
    v_mfma_f32_32x32x16_bf16 v[76:91], a[108:111], v[36:39], v[76:91]
    ds_write_b128 v215, v[132:135] offset:2048
    ds_write_b128 v215, v[136:139] offset:3072
    s_waitcnt lgkmcnt(0)
    s_barrier
    s_mul_i32 s41, s3, 12288
    s_add_u32 s41, s41, 81920
    v_add_u32 v212, s41, v1
    ds_read_b128 v[12:15], v212 offset:0
    ds_read_b128 v[16:19], v212 offset:1024
    ds_read_b128 v[20:23], v212 offset:2048
    ds_read_b128 v[24:27], v212 offset:3072
    ds_read_b128 v[28:31], v212 offset:4096
    ds_read_b128 v[32:35], v212 offset:5120
    ds_read_b128 v[36:39], v212 offset:6144
    ds_read_b128 v[40:43], v212 offset:7168
    ds_read_b128 v[44:47], v212 offset:8192
    ds_read_b128 v[48:51], v212 offset:9216
    ds_read_b128 v[52:55], v212 offset:10240
    ds_read_b128 v[56:59], v212 offset:11264
    s_waitcnt lgkmcnt(8)
    v_pk_add_f32 v[76:77], v[76:77], v[12:13]
    v_pk_add_f32 v[78:79], v[78:79], v[14:15]
    v_pk_add_f32 v[80:81], v[80:81], v[16:17]
    v_pk_add_f32 v[82:83], v[82:83], v[18:19]
    v_pk_add_f32 v[84:85], v[84:85], v[20:21]
    v_pk_add_f32 v[86:87], v[86:87], v[22:23]
    v_pk_add_f32 v[88:89], v[88:89], v[24:25]
    v_pk_add_f32 v[90:91], v[90:91], v[26:27]
    s_waitcnt lgkmcnt(4)
    v_pk_add_f32 v[76:77], v[76:77], v[28:29]
    v_pk_add_f32 v[78:79], v[78:79], v[30:31]
    v_pk_add_f32 v[80:81], v[80:81], v[32:33]
    v_pk_add_f32 v[82:83], v[82:83], v[34:35]
    v_pk_add_f32 v[84:85], v[84:85], v[36:37]
    v_pk_add_f32 v[86:87], v[86:87], v[38:39]
    v_pk_add_f32 v[88:89], v[88:89], v[40:41]
    v_pk_add_f32 v[90:91], v[90:91], v[42:43]
    s_waitcnt lgkmcnt(0)
    v_pk_add_f32 v[76:77], v[76:77], v[44:45]
    v_pk_add_f32 v[78:79], v[78:79], v[46:47]
    v_pk_add_f32 v[80:81], v[80:81], v[48:49]
    v_pk_add_f32 v[82:83], v[82:83], v[50:51]
    v_pk_add_f32 v[84:85], v[84:85], v[52:53]
    v_pk_add_f32 v[86:87], v[86:87], v[54:55]
    v_pk_add_f32 v[88:89], v[88:89], v[56:57]
    v_pk_add_f32 v[90:91], v[90:91], v[58:59]
    v_cvt_pk_bf16_f32 v164, v76, v77
    v_cvt_pk_bf16_f32 v165, v78, v79
    v_cvt_pk_bf16_f32 v166, v80, v81
    v_cvt_pk_bf16_f32 v167, v82, v83
    v_cvt_pk_bf16_f32 v168, v84, v85
    v_cvt_pk_bf16_f32 v169, v86, v87
    v_cvt_pk_bf16_f32 v170, v88, v89
    v_cvt_pk_bf16_f32 v171, v90, v91
    s_mov_b32 s28, s38
    s_and_b32 s29, s39, 0xffff
    s_mov_b32 s30, 0x1c0000
    s_mov_b32 s31, 0x00020000
    v_permlane32_swap_b32 v164, v166
    v_permlane32_swap_b32 v165, v167
    v_permlane32_swap_b32 v168, v170
    v_permlane32_swap_b32 v169, v171
    v_mul_u32_u24 v11, 896, v2
    v_lshl_add_u32 v11, v3, 4, v11
    s_mul_i32 s42, s79, 28672
    s_lshl_b32 s43, s78, 6
    s_add_u32 s42, s42, s43
    buffer_store_dwordx4 v[164:167], v11, s[28:31], s42 offen
    buffer_store_dwordx4 v[168:171], v11, s[28:31], s42 offen offset:32
    s_endpgm
idle1:
    s_cmp_eq_u32 s19, 0
    s_cbranch_scc0 main_done
    s_sub_u32 s42, s101, 112
    s_mul_i32 s40, s42, 43008
    s_mul_i32 s41, s16, 688128
    s_add_u32 s40, s40, s41
    s_add_u32 s40, s40, 33554432
    v_lshlrev_b32 v11, 7, v0
    buffer_load_dword v12, v11, s[4:7], s40 offen sc1
    s_add_u32 s40, s40, 8192
    buffer_load_dword v13, v11, s[4:7], s40 offen sc1
    s_add_u32 s40, s40, 8192
    buffer_load_dword v14, v11, s[4:7], s40 offen sc1
    s_add_u32 s40, s40, 8192
    buffer_load_dword v15, v11, s[4:7], s40 offen sc1
    s_add_u32 s40, s40, 8192
    buffer_load_dword v16, v11, s[4:7], s40 offen sc1
    s_add_u32 s40, s40, 2048
    buffer_load_dword v17, v11, s[4:7], s40 offen sc1
    s_add_u32 s40, s40, 2048
main_done:
    s_endpgm
code_end:
.section .rodata,"a"
.p2align 6
.amdhsa_kernel interleave_layers__sliding_block__mixer_channel_mlp__prompt_kernel
  .amdhsa_next_free_vgpr 512
  .amdhsa_next_free_sgpr 102
  .amdhsa_accum_offset 256
  .amdhsa_group_segment_fixed_size 0
  .amdhsa_kernarg_size 88
  .amdhsa_user_sgpr_count 2
  .amdhsa_user_sgpr_kernarg_segment_ptr 1
  .amdhsa_system_sgpr_workgroup_id_x 1
.end_amdhsa_kernel
```
